```python
import torch

def _softmax(x, axis=-1):
    return torch.softmax(x, dim=axis)

def _gelu(x):
    return torch.nn.functional.gelu(x, approximate='tanh')

def _silu(x):
    return torch.nn.functional.silu(x)

def _sigmoid(x):
    return torch.sigmoid(x)

def _layernorm(x, axis=-1, eps=1e-05):
    m = x.mean(dim=axis, keepdim=True)
    v = x.var(dim=axis, keepdim=True, unbiased=False)
    return (x - m) / torch.sqrt(v + eps)

def _scatter_add(tgt, idx, src, axis=0):
    return tgt.clone().index_add_(axis, idx, src)

def _segment_sum(src, seg, n):
    out = torch.zeros((n,) + src.shape[1:], dtype=src.dtype)
    return out.index_add_(0, seg, src)

def _pad(x, pw):
    flat = tuple((v for pair in reversed(pw) for v in pair))
    return torch.nn.functional.pad(x, flat)
kernel_name = 'sequential_preLN__sliding_block__mixer_gmlp__prompt'

def setup_inputs():

    _w = lambda a: (lambda t: t.to(torch.bfloat16) if t.is_floating_point() else t)(torch.as_tensor(a))

    def _A_setup():
        B, S, D = (1, 2048, 448)
        return {'x': _w((lambda *s: torch.randn(*s, dtype=torch.bfloat16) * 0.05)(B, S, D)), 'wqkv': _w((lambda *s: torch.randn(*s, dtype=torch.bfloat16) * 0.05)(D, 3 * D)), 'wo': _w((lambda *s: torch.randn(*s, dtype=torch.bfloat16) * 0.05)(D, D))}
    _A_in = _A_setup()

    def _B_setup():
        B, S, D, F = (1, 2048, 448, 1792)
        Fh = F // 2
        return {'x': _w((lambda *s: torch.randn(*s, dtype=torch.bfloat16) * 0.05)(B, S, D)), 'w_in': _w((lambda *s: torch.randn(*s, dtype=torch.bfloat16) * 0.4)(D, 2 * Fh)), 'w_sp': _w(0.01 * (lambda *s: torch.randn(*s, dtype=torch.bfloat16) * 0.4)(S, S)), 'b_sp': _w(1.0 + 0.01 * (lambda *s: torch.randn(*s, dtype=torch.bfloat16) * 0.05)(S)), 'w_out': _w((lambda *s: torch.randn(*s, dtype=torch.bfloat16) * 0.05)(Fh, D))}
    _B_in = _B_setup()
    return {'A_x': _A_in['x'], 'A_wqkv': _A_in['wqkv'], 'A_wo': _A_in['wo'], 'B_x': _B_in['x'], 'B_w_in': _B_in['w_in'], 'B_w_sp': _B_in['w_sp'], 'B_b_sp': _B_in['b_sp'], 'B_w_out': _B_in['w_out']}

def reference(A_x, A_wqkv, A_wo, B_x, B_w_in, B_w_sp, B_b_sp, B_w_out):

    def _A_ref(x, wqkv, wo):
        B, S, D = x.shape
        H = 16
        Dh = D // H
        W = 256
        qkv = (lambda x, *d: x.permute(*d))((x @ wqkv).reshape(B, S, 3, H, Dh), 2, 0, 3, 1, 4)
        q, k, v = (qkv[0], qkv[1], qkv[2])
        scores = torch.einsum('bhqd,bhkd->bhqk', q, k) * Dh ** (-0.5)
        idx = torch.arange(S)
        mask = (idx[:, None] - idx[None, :] >= 0) & (idx[:, None] - idx[None, :] < W)
        scores = torch.where(mask[None, None], scores, -1000000000.0)
        p = _softmax(scores, axis=-1)
        o = torch.einsum('bhqk,bhkd->bhqd', p, v)
        return (lambda x, *d: x.permute(*d))(o, 0, 2, 1, 3).reshape(B, S, D) @ wo

    def _B_ref(x, w_in, w_sp, b_sp, w_out):
        B, S, D = x.shape
        F = w_in.shape[-1]
        Fh = F // 2
        z = _gelu(torch.einsum('bsd,df->bsf', x, w_in))
        z1 = z[..., :Fh].clone()
        z2 = _layernorm(z[..., Fh:], axis=-1)
        g = torch.einsum('ts,bsf->btf', w_sp, z2) + b_sp[None, :, None]
        return torch.einsum('bsf,fd->bsd', z1 * g, w_out)
    x = A_x
    h = x + _A_ref(_layernorm(x, axis=-1), A_wqkv, A_wo)
    h2 = h + _B_ref(_layernorm(h, axis=-1), B_w_in, B_w_sp, B_b_sp, B_w_out)
    return h2
```

```asm
; @launch grid=(256,1,1) block=(256,1,1) lds=163840
.amdgcn_target "amdgcn-amd-amdhsa--gfx950"
.text
.set CODE_SLICE, ((L_code_end - sequential_preLN__sliding_block__mixer_gmlp__prompt_kernel + 32*128 - 1) / (32*128)) * 128
.set CODE_BYTES, L_code_end - sequential_preLN__sliding_block__mixer_gmlp__prompt_kernel - 32
.globl sequential_preLN__sliding_block__mixer_gmlp__prompt_kernel
.p2align 8
.type sequential_preLN__sliding_block__mixer_gmlp__prompt_kernel,@function
sequential_preLN__sliding_block__mixer_gmlp__prompt_kernel:
  s_getpc_b64 s[4:5]
  s_load_dwordx16 s[48:63], s[0:1], 0
  s_load_dwordx4 s[64:67], s[0:1], 64
  s_load_dwordx2 s[68:69], s[0:1], 80
  s_cmp_ge_u32 s2, 256
  s_cbranch_scc1 L_end
  s_lshr_b32 s47, s2, 3
  s_mul_i32 s6, s47, CODE_SLICE
  v_lshlrev_b32 v5, 4, v0
  v_cmp_gt_u32 vcc, CODE_SLICE, v5
  s_mov_b64 s[70:71], vcc
  v_add_u32 v5, s6, v5
  v_cmp_gt_u32 vcc, CODE_BYTES, v5
  s_and_b64 vcc, vcc, s[70:71]
  s_and_saveexec_b64 s[6:7], vcc
  global_load_dwordx4 v[252:255], v5, s[4:5]
  s_mov_b64 exec, s[6:7]
  v_and_b32 v1, 63, v0
  v_lshrrev_b32 v5, 6, v0
  v_lshlrev_b32 v2, 4, v1
  v_and_b32 v3, 31, v1
  v_lshrrev_b32 v4, 5, v1
  v_readfirstlane_b32 s45, v5
  s_and_b32 s46, s2, 7
  v_mul_u32_u24 v15, 896, v4
  v_lshlrev_b32 v16, 4, v3
  v_add_u32 v15, v15, v16
  v_cmp_gt_u32 vcc, 28, v3
  v_mov_b32 v16, 0x7ffffff0
  s_nop 0
  v_cndmask_b32 v19, v16, v15, vcc
  v_lshrrev_b32 v15, 3, v1
  v_and_b32 v16, 7, v1
  v_lshrrev_b32 v17, 4, v1
  v_xor_b32 v18, v16, v17
  v_lshlrev_b32 v18, 4, v18
  v_mul_u32_u24 v15, 896, v15
  v_add_u32 v13, v15, v18
  v_add_u32 v17, 4, v17
  v_xor_b32 v18, v16, v17
  v_lshlrev_b32 v18, 4, v18
  v_add_u32 v14, v15, v18
  v_lshrrev_b32 v15, 3, v1
  v_lshrrev_b32 v16, 4, v1
  v_lshrrev_b32 v17, 2, v1
  v_xor_b32 v16, v16, v17
  v_and_b32 v16, 1, v16
  v_mul_u32_u24 v16, 896, v16
  v_mul_u32_u24 v15, 2688, v15
  v_and_b32 v18, 3, v1
  v_lshlrev_b32 v18, 4, v18
  v_add3_u32 v10, v15, v16, v18
  v_add_u32 v10, 896, v10
  v_mul_u32_u24 v17, 2688, v17
  v_add_u32 v11, v17, v18
  s_waitcnt lgkmcnt(0)
  s_load_dword s44, s[68:69], 0
  s_mov_b32 s8, s48
  s_and_b32 s9, s49, 0xffff
  s_mov_b32 s10, 1835008
  s_mov_b32 s11, 0x20000
  s_mov_b32 s12, s50
  s_and_b32 s13, s51, 0xffff
  s_mov_b32 s14, 1204224
  s_mov_b32 s15, 0x20000
  s_mov_b32 s40, s68
  s_and_b32 s41, s69, 0xffff
  s_mov_b32 s42, 268435456
  s_mov_b32 s43, 0x20000
  s_mov_b32 s16, s52
  s_and_b32 s17, s53, 0xffff
  s_mov_b32 s18, 401408
  s_mov_b32 s19, 0x20000
  s_mov_b32 s20, s56
  s_and_b32 s21, s57, 0xffff
  s_mov_b32 s22, 1605632
  s_mov_b32 s23, 0x20000
  s_mov_b32 s24, s58
  s_and_b32 s25, s59, 0xffff
  s_mov_b32 s26, 8388608
  s_mov_b32 s27, 0x20000
  s_mov_b32 s28, s60
  s_and_b32 s29, s61, 0xffff
  s_mov_b32 s30, 4096
  s_mov_b32 s31, 0x20000
  s_mov_b32 s32, s62
  s_and_b32 s33, s63, 0xffff
  s_mov_b32 s34, 802816
  s_mov_b32 s35, 0x20000
  s_mov_b32 s36, s64
  s_and_b32 s37, s65, 0xffff
  s_mov_b32 s38, 1835008
  s_mov_b32 s39, 0x20000
  s_lshr_b32 s50, s46, 1
  s_lshl_b32 s50, s50, 2
  s_lshr_b32 s51, s47, 3
  s_add_u32 s48, s50, s51
  s_and_b32 s50, s46, 1
  s_lshl_b32 s50, s50, 3
  s_and_b32 s71, s47, 7
  s_add_u32 s49, s50, s71
  s_lshl_b32 s58, s48, 2
  s_add_u32 s58, s58, s45
  s_mul_i32 s52, s58, 28672
  s_lshl_b32 s50, s48, 7
  s_lshl_b32 s70, s49, 3
  s_add_u32 s50, s50, s70
  s_lshl_b32 s70, s45, 1
  s_add_u32 s59, s50, s70
  s_mul_i32 s50, s59, 896
  buffer_load_dwordx4 v[20:23], v19, s[8:11], s50 offen
  buffer_load_dwordx4 v[24:27], v19, s[8:11], s50 offen offset:448
  s_lshl_b32 s51, s51, 1
  s_add_u32 s51, s51, s49
  s_mul_i32 s50, s51, 37
  s_lshr_b32 s50, s50, 8
  s_mul_i32 s50, s50, 7
  s_sub_u32 s51, s51, s50
  s_lshl_b32 s62, s51, 7
  s_lshl_b32 s54, s45, 14
  s_add_u32 s54, s54, 86016
  s_mul_i32 s53, s49, 56
  s_mul_i32 s50, s45, 43008
  s_add_u32 s53, s53, s50
  s_lshl_b32 s55, s45, 11
  s_add_u32 s57, s52, s62
  s_mul_i32 s61, s62, 1344
  s_add_u32 s61, s61, s53
  s_add_u32 m0, s54, 0
  s_add_u32 s56, s57, 0
  buffer_load_dwordx4 v13, s[8:11], s56 offen lds
  s_add_u32 m0, s54, 1024
  s_add_u32 s56, s57, 7168
  buffer_load_dwordx4 v14, s[8:11], s56 offen lds
  s_add_u32 m0, s54, 2048
  s_add_u32 s56, s57, 14336
  buffer_load_dwordx4 v13, s[8:11], s56 offen lds
  s_add_u32 m0, s54, 3072
  s_add_u32 s56, s57, 21504
  buffer_load_dwordx4 v14, s[8:11], s56 offen lds
  s_add_u32 m0, s55, 0
  s_add_u32 s56, s61, 0
  buffer_load_dwordx4 v10, s[12:15], s56 offen lds
  s_add_u32 m0, s55, 1024
  s_add_u32 s56, s61, 21504
  buffer_load_dwordx4 v10, s[12:15], s56 offen lds
  s_add_u32 s63, s62, 128
  s_cmp_ge_u32 s63, 896
  s_cselect_b32 s71, 896, 0
  s_sub_u32 s63, s63, s71
  s_add_u32 s57, s52, s63
  s_mul_i32 s61, s63, 1344
  s_add_u32 s61, s61, s53
  s_add_u32 m0, s54, 4096
  s_add_u32 s56, s57, 0
  buffer_load_dwordx4 v13, s[8:11], s56 offen lds
  s_add_u32 m0, s54, 5120
  s_add_u32 s56, s57, 7168
  buffer_load_dwordx4 v14, s[8:11], s56 offen lds
  s_add_u32 m0, s54, 6144
  s_add_u32 s56, s57, 14336
  buffer_load_dwordx4 v13, s[8:11], s56 offen lds
  s_add_u32 m0, s54, 7168
  s_add_u32 s56, s57, 21504
  buffer_load_dwordx4 v14, s[8:11], s56 offen lds
  s_add_u32 m0, s55, 8192
  s_add_u32 s56, s61, 0
  buffer_load_dwordx4 v10, s[12:15], s56 offen lds
  s_add_u32 m0, s55, 9216
  s_add_u32 s56, s61, 21504
  buffer_load_dwordx4 v10, s[12:15], s56 offen lds
  v_mov_b32 v32, 0x3f803f80
  v_mov_b32 v33, 0x3f803f80
  v_mov_b32 v34, 0x3f803f80
  v_mov_b32 v35, 0x3f803f80
  v_mov_b32 v36, 0
  v_mov_b32 v37, 0
  v_lshrrev_b32 v15, 1, v3
  v_and_b32 v15, 7, v15
  v_xor_b32 v15, v15, v4
  v_lshlrev_b32 v15, 4, v15
  v_lshlrev_b32 v40, 7, v3
  v_add_u32 v40, v40, v15
  v_add_u32 v40, s54, v40
  v_xor_b32 v41, 32, v40
  v_xor_b32 v42, 64, v40
  v_xor_b32 v43, 96, v40
  v_lshrrev_b32 v15, 2, v1
  v_and_b32 v15, 3, v15
  v_mul_u32_u24 v16, 8, v4
  v_add_u32 v15, v15, v16
  v_mul_u32_u24 v15, 128, v15
  v_lshrrev_b32 v16, 4, v1
  v_and_b32 v16, 1, v16
  v_lshlrev_b32 v16, 5, v16
  v_add_u32 v15, v15, v16
  v_and_b32 v16, 3, v1
  v_lshlrev_b32 v16, 3, v16
  v_add_u32 v44, v15, v16
  v_lshrrev_b32 v15, 3, v1
  v_and_b32 v15, 1, v15
  v_lshlrev_b32 v15, 6, v15
  v_xor_b32 v16, 64, v15
  v_add_u32 v45, v44, v16
  v_add_u32 v44, v44, v15
  v_lshrrev_b32 v15, 2, v1
  v_and_b32 v15, 3, v15
  v_mul_u32_u24 v16, 8, v4
  v_add_u32 v15, v15, v16
  v_mul_u32_u24 v15, 64, v15
  v_lshrrev_b32 v16, 4, v1
  v_and_b32 v16, 1, v16
  v_lshlrev_b32 v16, 5, v16
  v_add_u32 v15, v15, v16
  v_and_b32 v16, 3, v1
  v_lshlrev_b32 v16, 3, v16
  v_add_u32 v46, v15, v16
  v_add_u32 v46, 57344, v46
  s_waitcnt vmcnt(12)
  v_dot2_f32_bf16 v36, v20, v32, v36
  v_dot2_f32_bf16 v37, v20, v20, v37
  v_dot2_f32_bf16 v36, v21, v32, v36
  v_dot2_f32_bf16 v37, v21, v21, v37
  v_dot2_f32_bf16 v36, v22, v32, v36
  v_dot2_f32_bf16 v37, v22, v22, v37
  v_dot2_f32_bf16 v36, v23, v32, v36
  v_dot2_f32_bf16 v37, v23, v23, v37
  v_dot2_f32_bf16 v36, v24, v32, v36
  v_dot2_f32_bf16 v37, v24, v24, v37
  v_dot2_f32_bf16 v36, v25, v32, v36
  v_dot2_f32_bf16 v37, v25, v25, v37
  v_dot2_f32_bf16 v36, v26, v32, v36
  v_dot2_f32_bf16 v37, v26, v26, v37
  v_dot2_f32_bf16 v36, v27, v32, v36
  v_dot2_f32_bf16 v37, v27, v27, v37
  s_nop 1
  v_add_f32_dpp v36, v36, v36 row_ror:8 row_mask:0xf bank_mask:0xf
  v_add_f32_dpp v37, v37, v37 row_ror:8 row_mask:0xf bank_mask:0xf
  s_nop 0
  v_add_f32_dpp v36, v36, v36 row_ror:4 row_mask:0xf bank_mask:0xf
  v_add_f32_dpp v37, v37, v37 row_ror:4 row_mask:0xf bank_mask:0xf
  s_nop 0
  v_add_f32_dpp v36, v36, v36 row_ror:2 row_mask:0xf bank_mask:0xf
  v_add_f32_dpp v37, v37, v37 row_ror:2 row_mask:0xf bank_mask:0xf
  s_nop 0
  v_add_f32_dpp v36, v36, v36 row_ror:1 row_mask:0xf bank_mask:0xf
  v_add_f32_dpp v37, v37, v37 row_ror:1 row_mask:0xf bank_mask:0xf
  v_mov_b32 v38, v36
  v_mov_b32 v39, v37
  s_nop 0
  v_permlane16_swap_b32 v36, v38
  v_permlane16_swap_b32 v37, v39
  v_add_f32 v36, v36, v38
  v_add_f32 v37, v37, v39
  v_mul_f32 v36, 0x3b124925, v36
  v_mul_f32 v37, 0x3b124925, v37
  v_fma_f32 v37, -v36, v36, v37
  v_max_f32 v37, 0, v37
  v_add_f32 v37, 0x3727c5ac, v37
  v_rsq_f32 v37, v37
  s_waitcnt lgkmcnt(0)
  s_add_u32 s44, s44, 1
  v_mov_b32 v20, v36
  v_mov_b32 v22, s44
  v_mov_b32 v23, s44
  v_mov_b32 v21, v37
  v_lshlrev_b32 v38, 4, v4
  s_lshl_b32 s50, s59, 4
  s_add_u32 s50, s50, 786432
  s_mov_b32 exec_lo, 1
  s_mov_b32 exec_hi, 1
  buffer_store_dwordx4 v[20:23], v38, s[40:43], s50 offen sc1
  s_mov_b64 exec, -1
  s_waitcnt vmcnt(7)
  s_barrier
  ds_read_b128 a[0:3], v40 offset:0
  ds_read_b128 a[4:7], v41 offset:0
  ds_read_b128 a[8:11], v42 offset:0
  ds_read_b128 a[12:15], v43 offset:0
  ds_read_b64_tr_b16 v[112:113], v44 offset:0
  ds_read_b64_tr_b16 v[114:115], v44 offset:512
  ds_read_b64_tr_b16 v[116:117], v45 offset:0
  ds_read_b64_tr_b16 v[118:119], v45 offset:512
  s_waitcnt lgkmcnt(0)
  v_mfma_f32_32x32x16_bf16 v[48:63], v[112:115], a[0:3], 0
  ds_read_b64_tr_b16 v[120:121], v44 offset:2048
  ds_read_b64_tr_b16 v[122:123], v44 offset:2560
  ds_read_b64_tr_b16 v[124:125], v45 offset:2048
  v_mfma_f32_32x32x16_bf16 v[64:79], a[0:3], v[116:119], 0
  ds_read_b64_tr_b16 v[126:127], v45 offset:2560
  s_add_u32 s64, s63, 128
  s_cmp_ge_u32 s64, 896
  s_cselect_b32 s71, 896, 0
  s_sub_u32 s64, s64, s71
  s_add_u32 s57, s52, s64
  s_mul_i32 s61, s64, 1344
  s_add_u32 s61, s61, s53
  v_mfma_f32_32x32x16_bf16 v[80:95], v[112:115], v[32:35], 0
  v_mfma_f32_32x32x16_bf16 v[96:111], v[32:35], v[116:119], 0
  s_add_u32 m0, s54, 8192
  s_add_u32 s56, s57, 0
  buffer_load_dwordx4 v13, s[8:11], s56 offen lds
  s_waitcnt lgkmcnt(0)
  v_mfma_f32_32x32x16_bf16 v[48:63], v[120:123], a[4:7], v[48:63]
  ds_read_b64_tr_b16 v[112:113], v44 offset:4096
  ds_read_b64_tr_b16 v[114:115], v44 offset:4608
  ds_read_b64_tr_b16 v[116:117], v45 offset:4096
  v_mfma_f32_32x32x16_bf16 v[64:79], a[4:7], v[124:127], v[64:79]
  ds_read_b64_tr_b16 v[118:119], v45 offset:4608
  s_add_u32 m0, s54, 9216
  s_add_u32 s56, s57, 7168
  buffer_load_dwordx4 v14, s[8:11], s56 offen lds
  v_mfma_f32_32x32x16_bf16 v[80:95], v[120:123], v[32:35], v[80:95]
  v_mfma_f32_32x32x16_bf16 v[96:111], v[32:35], v[124:127], v[96:111]
  s_add_u32 m0, s54, 10240
  s_add_u32 s56, s57, 14336
  buffer_load_dwordx4 v13, s[8:11], s56 offen lds
  s_waitcnt lgkmcnt(0)
  v_mfma_f32_32x32x16_bf16 v[48:63], v[112:115], a[8:11], v[48:63]
  ds_read_b64_tr_b16 v[120:121], v44 offset:6144
  ds_read_b64_tr_b16 v[122:123], v44 offset:6656
  ds_read_b64_tr_b16 v[124:125], v45 offset:6144
  v_mfma_f32_32x32x16_bf16 v[64:79], a[8:11], v[116:119], v[64:79]
  ds_read_b64_tr_b16 v[126:127], v45 offset:6656
  s_add_u32 m0, s54, 11264
  s_add_u32 s56, s57, 21504
  buffer_load_dwordx4 v14, s[8:11], s56 offen lds
  v_mfma_f32_32x32x16_bf16 v[80:95], v[112:115], v[32:35], v[80:95]
  v_mfma_f32_32x32x16_bf16 v[96:111], v[32:35], v[116:119], v[96:111]
  s_add_u32 m0, s55, 16384
  s_add_u32 s56, s61, 0
  buffer_load_dwordx4 v10, s[12:15], s56 offen lds
  s_waitcnt lgkmcnt(0)
  v_mfma_f32_32x32x16_bf16 v[48:63], v[120:123], a[12:15], v[48:63]
  s_waitcnt vmcnt(6)
  s_barrier
  ds_read_b128 a[16:19], v40 offset:4096
  ds_read_b128 a[20:23], v41 offset:4096
  v_mfma_f32_32x32x16_bf16 v[64:79], a[12:15], v[124:127], v[64:79]
  ds_read_b128 a[24:27], v42 offset:4096
  ds_read_b128 a[28:31], v43 offset:4096
  ds_read_b64_tr_b16 v[112:113], v44 offset:8192
  v_mfma_f32_32x32x16_bf16 v[80:95], v[120:123], v[32:35], v[80:95]
  ds_read_b64_tr_b16 v[114:115], v44 offset:8704
  ds_read_b64_tr_b16 v[116:117], v45 offset:8192
  ds_read_b64_tr_b16 v[118:119], v45 offset:8704
  v_mfma_f32_32x32x16_bf16 v[96:111], v[32:35], v[124:127], v[96:111]
  s_add_u32 m0, s55, 17408
  s_add_u32 s56, s61, 21504
  buffer_load_dwordx4 v10, s[12:15], s56 offen lds
  s_waitcnt lgkmcnt(0)
  v_mfma_f32_32x32x16_bf16 v[48:63], v[112:115], a[16:19], v[48:63]
  ds_read_b64_tr_b16 v[120:121], v44 offset:10240
  ds_read_b64_tr_b16 v[122:123], v44 offset:10752
  ds_read_b64_tr_b16 v[124:125], v45 offset:10240
  v_mfma_f32_32x32x16_bf16 v[64:79], a[16:19], v[116:119], v[64:79]
  ds_read_b64_tr_b16 v[126:127], v45 offset:10752
  s_add_u32 s65, s64, 128
  s_cmp_ge_u32 s65, 896
  s_cselect_b32 s71, 896, 0
  s_sub_u32 s65, s65, s71
  s_add_u32 s57, s52, s65
  s_mul_i32 s61, s65, 1344
  s_add_u32 s61, s61, s53
  v_mfma_f32_32x32x16_bf16 v[80:95], v[112:115], v[32:35], v[80:95]
  v_mfma_f32_32x32x16_bf16 v[96:111], v[32:35], v[116:119], v[96:111]
  s_add_u32 m0, s54, 12288
  s_add_u32 s56, s57, 0
  buffer_load_dwordx4 v13, s[8:11], s56 offen lds
  s_waitcnt lgkmcnt(0)
  v_mfma_f32_32x32x16_bf16 v[48:63], v[120:123], a[20:23], v[48:63]
  ds_read_b64_tr_b16 v[112:113], v44 offset:12288
  ds_read_b64_tr_b16 v[114:115], v44 offset:12800
  ds_read_b64_tr_b16 v[116:117], v45 offset:12288
  v_mfma_f32_32x32x16_bf16 v[64:79], a[20:23], v[124:127], v[64:79]
  ds_read_b64_tr_b16 v[118:119], v45 offset:12800
  s_add_u32 m0, s54, 13312
  s_add_u32 s56, s57, 7168
  buffer_load_dwordx4 v14, s[8:11], s56 offen lds
  v_mfma_f32_32x32x16_bf16 v[80:95], v[120:123], v[32:35], v[80:95]
  v_mfma_f32_32x32x16_bf16 v[96:111], v[32:35], v[124:127], v[96:111]
  s_add_u32 m0, s54, 14336
  s_add_u32 s56, s57, 14336
  buffer_load_dwordx4 v13, s[8:11], s56 offen lds
  s_waitcnt lgkmcnt(0)
  v_mfma_f32_32x32x16_bf16 v[48:63], v[112:115], a[24:27], v[48:63]
  ds_read_b64_tr_b16 v[120:121], v44 offset:14336
  ds_read_b64_tr_b16 v[122:123], v44 offset:14848
  ds_read_b64_tr_b16 v[124:125], v45 offset:14336
  v_mfma_f32_32x32x16_bf16 v[64:79], a[24:27], v[116:119], v[64:79]
  ds_read_b64_tr_b16 v[126:127], v45 offset:14848
  s_add_u32 m0, s54, 15360
  s_add_u32 s56, s57, 21504
  buffer_load_dwordx4 v14, s[8:11], s56 offen lds
  v_mfma_f32_32x32x16_bf16 v[80:95], v[112:115], v[32:35], v[80:95]
  v_mfma_f32_32x32x16_bf16 v[96:111], v[32:35], v[116:119], v[96:111]
  s_add_u32 m0, s55, 24576
  s_add_u32 s56, s61, 0
  buffer_load_dwordx4 v10, s[12:15], s56 offen lds
  s_waitcnt lgkmcnt(0)
  v_mfma_f32_32x32x16_bf16 v[48:63], v[120:123], a[28:31], v[48:63]
  s_waitcnt vmcnt(5)
  s_barrier
  ds_read_b128 a[32:35], v40 offset:8192
  ds_read_b128 a[36:39], v41 offset:8192
  v_mfma_f32_32x32x16_bf16 v[64:79], a[28:31], v[124:127], v[64:79]
  ds_read_b128 a[40:43], v42 offset:8192
  ds_read_b128 a[44:47], v43 offset:8192
  ds_read_b64_tr_b16 v[112:113], v44 offset:16384
  v_mfma_f32_32x32x16_bf16 v[80:95], v[120:123], v[32:35], v[80:95]
  ds_read_b64_tr_b16 v[114:115], v44 offset:16896
  ds_read_b64_tr_b16 v[116:117], v45 offset:16384
  ds_read_b64_tr_b16 v[118:119], v45 offset:16896
  v_mfma_f32_32x32x16_bf16 v[96:111], v[32:35], v[124:127], v[96:111]
  s_add_u32 m0, s55, 25600
  s_add_u32 s56, s61, 21504
  buffer_load_dwordx4 v10, s[12:15], s56 offen lds
  s_waitcnt lgkmcnt(0)
  v_mfma_f32_32x32x16_bf16 v[48:63], v[112:115], a[32:35], v[48:63]
  ds_read_b64_tr_b16 v[120:121], v44 offset:18432
  ds_read_b64_tr_b16 v[122:123], v44 offset:18944
  ds_read_b64_tr_b16 v[124:125], v45 offset:18432
  v_mfma_f32_32x32x16_bf16 v[64:79], a[32:35], v[116:119], v[64:79]
  ds_read_b64_tr_b16 v[126:127], v45 offset:18944
  s_add_u32 s66, s65, 128
  s_cmp_ge_u32 s66, 896
  s_cselect_b32 s71, 896, 0
  s_sub_u32 s66, s66, s71
  s_add_u32 s57, s52, s66
  s_mul_i32 s61, s66, 1344
  s_add_u32 s61, s61, s53
  v_mfma_f32_32x32x16_bf16 v[80:95], v[112:115], v[32:35], v[80:95]
  v_mfma_f32_32x32x16_bf16 v[96:111], v[32:35], v[116:119], v[96:111]
  s_add_u32 m0, s54, 0
  s_add_u32 s56, s57, 0
  buffer_load_dwordx4 v13, s[8:11], s56 offen lds
  s_waitcnt lgkmcnt(0)
  v_mfma_f32_32x32x16_bf16 v[48:63], v[120:123], a[36:39], v[48:63]
  ds_read_b64_tr_b16 v[112:113], v44 offset:20480
  ds_read_b64_tr_b16 v[114:115], v44 offset:20992
  ds_read_b64_tr_b16 v[116:117], v45 offset:20480
  v_mfma_f32_32x32x16_bf16 v[64:79], a[36:39], v[124:127], v[64:79]
  ds_read_b64_tr_b16 v[118:119], v45 offset:20992
  s_add_u32 m0, s54, 1024
  s_add_u32 s56, s57, 7168
  buffer_load_dwordx4 v14, s[8:11], s56 offen lds
  v_mfma_f32_32x32x16_bf16 v[80:95], v[120:123], v[32:35], v[80:95]
  v_mfma_f32_32x32x16_bf16 v[96:111], v[32:35], v[124:127], v[96:111]
  s_add_u32 m0, s54, 2048
  s_add_u32 s56, s57, 14336
  buffer_load_dwordx4 v13, s[8:11], s56 offen lds
  s_waitcnt lgkmcnt(0)
  v_mfma_f32_32x32x16_bf16 v[48:63], v[112:115], a[40:43], v[48:63]
  ds_read_b64_tr_b16 v[120:121], v44 offset:22528
  ds_read_b64_tr_b16 v[122:123], v44 offset:23040
  ds_read_b64_tr_b16 v[124:125], v45 offset:22528
  v_mfma_f32_32x32x16_bf16 v[64:79], a[40:43], v[116:119], v[64:79]
  ds_read_b64_tr_b16 v[126:127], v45 offset:23040
  s_add_u32 m0, s54, 3072
  s_add_u32 s56, s57, 21504
  buffer_load_dwordx4 v14, s[8:11], s56 offen lds
  v_mfma_f32_32x32x16_bf16 v[80:95], v[112:115], v[32:35], v[80:95]
  v_mfma_f32_32x32x16_bf16 v[96:111], v[32:35], v[116:119], v[96:111]
  s_add_u32 m0, s55, 32768
  s_add_u32 s56, s61, 0
  buffer_load_dwordx4 v10, s[12:15], s56 offen lds
  s_waitcnt lgkmcnt(0)
  v_mfma_f32_32x32x16_bf16 v[48:63], v[120:123], a[44:47], v[48:63]
  s_waitcnt vmcnt(5)
  s_barrier
  ds_read_b128 a[48:51], v40 offset:12288
  ds_read_b128 a[52:55], v41 offset:12288
  v_mfma_f32_32x32x16_bf16 v[64:79], a[44:47], v[124:127], v[64:79]
  ds_read_b128 a[56:59], v42 offset:12288
  ds_read_b128 a[60:63], v43 offset:12288
  ds_read_b64_tr_b16 v[112:113], v44 offset:24576
  v_mfma_f32_32x32x16_bf16 v[80:95], v[120:123], v[32:35], v[80:95]
  ds_read_b64_tr_b16 v[114:115], v44 offset:25088
  ds_read_b64_tr_b16 v[116:117], v45 offset:24576
  ds_read_b64_tr_b16 v[118:119], v45 offset:25088
  v_mfma_f32_32x32x16_bf16 v[96:111], v[32:35], v[124:127], v[96:111]
  s_add_u32 m0, s55, 33792
  s_add_u32 s56, s61, 21504
  buffer_load_dwordx4 v10, s[12:15], s56 offen lds
  s_waitcnt lgkmcnt(0)
  v_mfma_f32_32x32x16_bf16 v[48:63], v[112:115], a[48:51], v[48:63]
  ds_read_b64_tr_b16 v[120:121], v44 offset:26624
  ds_read_b64_tr_b16 v[122:123], v44 offset:27136
  ds_read_b64_tr_b16 v[124:125], v45 offset:26624
  v_mfma_f32_32x32x16_bf16 v[64:79], a[48:51], v[116:119], v[64:79]
  ds_read_b64_tr_b16 v[126:127], v45 offset:27136
  s_add_u32 s67, s66, 128
  s_cmp_ge_u32 s67, 896
  s_cselect_b32 s71, 896, 0
  s_sub_u32 s67, s67, s71
  s_add_u32 s57, s52, s67
  s_mul_i32 s61, s67, 1344
  s_add_u32 s61, s61, s53
  v_mfma_f32_32x32x16_bf16 v[80:95], v[112:115], v[32:35], v[80:95]
  v_mfma_f32_32x32x16_bf16 v[96:111], v[32:35], v[116:119], v[96:111]
  s_add_u32 m0, s54, 4096
  s_add_u32 s56, s57, 0
  buffer_load_dwordx4 v13, s[8:11], s56 offen lds
  s_waitcnt lgkmcnt(0)
  v_mfma_f32_32x32x16_bf16 v[48:63], v[120:123], a[52:55], v[48:63]
  ds_read_b64_tr_b16 v[112:113], v44 offset:28672
  ds_read_b64_tr_b16 v[114:115], v44 offset:29184
  ds_read_b64_tr_b16 v[116:117], v45 offset:28672
  v_mfma_f32_32x32x16_bf16 v[64:79], a[52:55], v[124:127], v[64:79]
  ds_read_b64_tr_b16 v[118:119], v45 offset:29184
  s_add_u32 m0, s54, 5120
  s_add_u32 s56, s57, 7168
  buffer_load_dwordx4 v14, s[8:11], s56 offen lds
  v_mfma_f32_32x32x16_bf16 v[80:95], v[120:123], v[32:35], v[80:95]
  v_mfma_f32_32x32x16_bf16 v[96:111], v[32:35], v[124:127], v[96:111]
  s_add_u32 m0, s54, 6144
  s_add_u32 s56, s57, 14336
  buffer_load_dwordx4 v13, s[8:11], s56 offen lds
  s_waitcnt lgkmcnt(0)
  v_mfma_f32_32x32x16_bf16 v[48:63], v[112:115], a[56:59], v[48:63]
  ds_read_b64_tr_b16 v[120:121], v44 offset:30720
  ds_read_b64_tr_b16 v[122:123], v44 offset:31232
  ds_read_b64_tr_b16 v[124:125], v45 offset:30720
  v_mfma_f32_32x32x16_bf16 v[64:79], a[56:59], v[116:119], v[64:79]
  ds_read_b64_tr_b16 v[126:127], v45 offset:31232
  s_add_u32 m0, s54, 7168
  s_add_u32 s56, s57, 21504
  buffer_load_dwordx4 v14, s[8:11], s56 offen lds
  v_mfma_f32_32x32x16_bf16 v[80:95], v[112:115], v[32:35], v[80:95]
  v_mfma_f32_32x32x16_bf16 v[96:111], v[32:35], v[116:119], v[96:111]
  s_add_u32 m0, s55, 40960
  s_add_u32 s56, s61, 0
  buffer_load_dwordx4 v10, s[12:15], s56 offen lds
  s_waitcnt lgkmcnt(0)
  v_mfma_f32_32x32x16_bf16 v[48:63], v[120:123], a[60:63], v[48:63]
  s_waitcnt vmcnt(5)
  s_barrier
  ds_read_b128 a[64:67], v40 offset:0
  ds_read_b128 a[68:71], v41 offset:0
  v_mfma_f32_32x32x16_bf16 v[64:79], a[60:63], v[124:127], v[64:79]
  ds_read_b128 a[72:75], v42 offset:0
  ds_read_b128 a[76:79], v43 offset:0
  ds_read_b64_tr_b16 v[112:113], v44 offset:32768
  v_mfma_f32_32x32x16_bf16 v[80:95], v[120:123], v[32:35], v[80:95]
  ds_read_b64_tr_b16 v[114:115], v44 offset:33280
  ds_read_b64_tr_b16 v[116:117], v45 offset:32768
  ds_read_b64_tr_b16 v[118:119], v45 offset:33280
  v_mfma_f32_32x32x16_bf16 v[96:111], v[32:35], v[124:127], v[96:111]
  s_add_u32 m0, s55, 41984
  s_add_u32 s56, s61, 21504
  buffer_load_dwordx4 v10, s[12:15], s56 offen lds
  s_waitcnt lgkmcnt(0)
  v_mfma_f32_32x32x16_bf16 v[48:63], v[112:115], a[64:67], v[48:63]
  ds_read_b64_tr_b16 v[120:121], v44 offset:34816
  ds_read_b64_tr_b16 v[122:123], v44 offset:35328
  ds_read_b64_tr_b16 v[124:125], v45 offset:34816
  v_mfma_f32_32x32x16_bf16 v[64:79], a[64:67], v[116:119], v[64:79]
  ds_read_b64_tr_b16 v[126:127], v45 offset:35328
  s_add_u32 s68, s67, 128
  s_cmp_ge_u32 s68, 896
  s_cselect_b32 s71, 896, 0
  s_sub_u32 s68, s68, s71
  s_add_u32 s57, s52, s68
  s_mul_i32 s61, s68, 1344
  s_add_u32 s61, s61, s53
  v_mfma_f32_32x32x16_bf16 v[80:95], v[112:115], v[32:35], v[80:95]
  v_mfma_f32_32x32x16_bf16 v[96:111], v[32:35], v[116:119], v[96:111]
  s_add_u32 m0, s54, 8192
  s_add_u32 s56, s57, 0
  buffer_load_dwordx4 v13, s[8:11], s56 offen lds
  s_waitcnt lgkmcnt(0)
  v_mfma_f32_32x32x16_bf16 v[48:63], v[120:123], a[68:71], v[48:63]
  ds_read_b64_tr_b16 v[112:113], v44 offset:36864
  ds_read_b64_tr_b16 v[114:115], v44 offset:37376
  ds_read_b64_tr_b16 v[116:117], v45 offset:36864
  v_mfma_f32_32x32x16_bf16 v[64:79], a[68:71], v[124:127], v[64:79]
  ds_read_b64_tr_b16 v[118:119], v45 offset:37376
  s_add_u32 m0, s54, 9216
  s_add_u32 s56, s57, 7168
  buffer_load_dwordx4 v14, s[8:11], s56 offen lds
  v_mfma_f32_32x32x16_bf16 v[80:95], v[120:123], v[32:35], v[80:95]
  v_mfma_f32_32x32x16_bf16 v[96:111], v[32:35], v[124:127], v[96:111]
  s_add_u32 m0, s54, 10240
  s_add_u32 s56, s57, 14336
  buffer_load_dwordx4 v13, s[8:11], s56 offen lds
  s_waitcnt lgkmcnt(0)
  v_mfma_f32_32x32x16_bf16 v[48:63], v[112:115], a[72:75], v[48:63]
  ds_read_b64_tr_b16 v[120:121], v44 offset:38912
  ds_read_b64_tr_b16 v[122:123], v44 offset:39424
  ds_read_b64_tr_b16 v[124:125], v45 offset:38912
  v_mfma_f32_32x32x16_bf16 v[64:79], a[72:75], v[116:119], v[64:79]
  ds_read_b64_tr_b16 v[126:127], v45 offset:39424
  s_add_u32 m0, s54, 11264
  s_add_u32 s56, s57, 21504
  buffer_load_dwordx4 v14, s[8:11], s56 offen lds
  v_mfma_f32_32x32x16_bf16 v[80:95], v[112:115], v[32:35], v[80:95]
  v_mfma_f32_32x32x16_bf16 v[96:111], v[32:35], v[116:119], v[96:111]
  s_add_u32 m0, s55, 49152
  s_add_u32 s56, s61, 0
  buffer_load_dwordx4 v10, s[12:15], s56 offen lds
  s_waitcnt lgkmcnt(0)
  v_mfma_f32_32x32x16_bf16 v[48:63], v[120:123], a[76:79], v[48:63]
  s_waitcnt vmcnt(5)
  s_barrier
  ds_read_b128 a[80:83], v40 offset:4096
  ds_read_b128 a[84:87], v41 offset:4096
  v_mfma_f32_32x32x16_bf16 v[64:79], a[76:79], v[124:127], v[64:79]
  ds_read_b128 a[88:91], v42 offset:4096
  ds_read_b128 a[92:95], v43 offset:4096
  ds_read_b64_tr_b16 v[112:113], v44 offset:40960
  v_mfma_f32_32x32x16_bf16 v[80:95], v[120:123], v[32:35], v[80:95]
  ds_read_b64_tr_b16 v[114:115], v44 offset:41472
  ds_read_b64_tr_b16 v[116:117], v45 offset:40960
  ds_read_b64_tr_b16 v[118:119], v45 offset:41472
  v_mfma_f32_32x32x16_bf16 v[96:111], v[32:35], v[124:127], v[96:111]
  s_add_u32 m0, s55, 50176
  s_add_u32 s56, s61, 21504
  buffer_load_dwordx4 v10, s[12:15], s56 offen lds
  s_waitcnt lgkmcnt(0)
  v_mfma_f32_32x32x16_bf16 v[48:63], v[112:115], a[80:83], v[48:63]
  ds_read_b64_tr_b16 v[120:121], v44 offset:43008
  ds_read_b64_tr_b16 v[122:123], v44 offset:43520
  ds_read_b64_tr_b16 v[124:125], v45 offset:43008
  ds_read_b64_tr_b16 v[126:127], v45 offset:43520
  v_mfma_f32_32x32x16_bf16 v[64:79], a[80:83], v[116:119], v[64:79]
  s_mul_i32 s61, s62, 1344
  s_add_u32 s61, s61, s53
  s_lshr_b32 s56, s55, 1
  s_add_u32 m0, s56, 57344
  s_nop 0
  buffer_load_dwordx4 v11, s[12:15], s61 offen lds
  v_mfma_f32_32x32x16_bf16 v[80:95], v[112:115], v[32:35], v[80:95]
  s_mul_i32 s61, s63, 1344
  s_add_u32 s61, s61, s53
  s_lshr_b32 s56, s55, 1
  s_add_u32 m0, s56, 61440
  s_nop 0
  buffer_load_dwordx4 v11, s[12:15], s61 offen lds
  v_mfma_f32_32x32x16_bf16 v[96:111], v[32:35], v[116:119], v[96:111]
  v_lshlrev_b32 v38, 4, v3
  s_lshl_b32 s50, s58, 9
  s_add_u32 s60, s50, 786432
  buffer_load_dwordx4 v[128:131], v38, s[40:43], s60 offen sc1
  s_waitcnt lgkmcnt(0)
  v_mfma_f32_32x32x16_bf16 v[48:63], v[120:123], a[84:87], v[48:63]
  ds_read_b64_tr_b16 v[112:113], v44 offset:45056
  ds_read_b64_tr_b16 v[114:115], v44 offset:45568
  ds_read_b64_tr_b16 v[116:117], v45 offset:45056
  ds_read_b64_tr_b16 v[118:119], v45 offset:45568
  v_mfma_f32_32x32x16_bf16 v[64:79], a[84:87], v[124:127], v[64:79]
  s_mul_i32 s61, s64, 1344
  s_add_u32 s61, s61, s53
  s_lshr_b32 s56, s55, 1
  s_add_u32 m0, s56, 65536
  s_nop 0
  buffer_load_dwordx4 v11, s[12:15], s61 offen lds
  v_mfma_f32_32x32x16_bf16 v[80:95], v[120:123], v[32:35], v[80:95]
  v_mfma_f32_32x32x16_bf16 v[96:111], v[32:35], v[124:127], v[96:111]
  s_mul_i32 s61, s65, 1344
  s_add_u32 s61, s61, s53
  s_lshr_b32 s56, s55, 1
  s_add_u32 m0, s56, 69632
  s_nop 0
  buffer_load_dwordx4 v11, s[12:15], s61 offen lds
  s_waitcnt lgkmcnt(0)
  v_mfma_f32_32x32x16_bf16 v[48:63], v[112:115], a[88:91], v[48:63]
  ds_read_b64_tr_b16 v[120:121], v44 offset:47104
  v_mfma_f32_32x32x16_bf16 v[64:79], a[88:91], v[116:119], v[64:79]
  ds_read_b64_tr_b16 v[122:123], v44 offset:47616
  v_mfma_f32_32x32x16_bf16 v[80:95], v[112:115], v[32:35], v[80:95]
  ds_read_b64_tr_b16 v[124:125], v45 offset:47104
  v_mfma_f32_32x32x16_bf16 v[96:111], v[32:35], v[116:119], v[96:111]
  ds_read_b64_tr_b16 v[126:127], v45 offset:47616
  s_waitcnt lgkmcnt(0)
  v_mfma_f32_32x32x16_bf16 v[48:63], v[120:123], a[92:95], v[48:63]
  s_waitcnt vmcnt(5)
  s_barrier
  ds_read_b128 a[96:99], v40 offset:8192
  v_mfma_f32_32x32x16_bf16 v[64:79], a[92:95], v[124:127], v[64:79]
  ds_read_b128 a[100:103], v41 offset:8192
  ds_read_b128 a[104:107], v42 offset:8192
  v_mfma_f32_32x32x16_bf16 v[80:95], v[120:123], v[32:35], v[80:95]
  ds_read_b128 a[108:111], v43 offset:8192
  ds_read_b64_tr_b16 v[112:113], v44 offset:49152
  ds_read_b64_tr_b16 v[114:115], v44 offset:49664
  v_mfma_f32_32x32x16_bf16 v[96:111], v[32:35], v[124:127], v[96:111]
  ds_read_b64_tr_b16 v[116:117], v45 offset:49152
  ds_read_b64_tr_b16 v[118:119], v45 offset:49664
  s_waitcnt lgkmcnt(0)
  v_mfma_f32_32x32x16_bf16 v[48:63], v[112:115], a[96:99], v[48:63]
  ds_read_b64_tr_b16 v[120:121], v44 offset:51200
  ds_read_b64_tr_b16 v[122:123], v44 offset:51712
  ds_read_b64_tr_b16 v[124:125], v45 offset:51200
  ds_read_b64_tr_b16 v[126:127], v45 offset:51712
  v_mfma_f32_32x32x16_bf16 v[64:79], a[96:99], v[116:119], v[64:79]
  s_mul_i32 s61, s66, 1344
  s_add_u32 s61, s61, s53
  s_lshr_b32 s56, s55, 1
  s_add_u32 m0, s56, 73728
  s_nop 0
  buffer_load_dwordx4 v11, s[12:15], s61 offen lds
  v_mfma_f32_32x32x16_bf16 v[80:95], v[112:115], v[32:35], v[80:95]
  v_mfma_f32_32x32x16_bf16 v[96:111], v[32:35], v[116:119], v[96:111]
  s_mul_i32 s61, s67, 1344
  s_add_u32 s61, s61, s53
  s_lshr_b32 s56, s55, 1
  s_add_u32 m0, s56, 77824
  s_nop 0
  buffer_load_dwordx4 v11, s[12:15], s61 offen lds
  s_waitcnt lgkmcnt(0)
  v_mfma_f32_32x32x16_bf16 v[48:63], v[120:123], a[100:103], v[48:63]
  ds_read_b64_tr_b16 v[112:113], v44 offset:53248
  ds_read_b64_tr_b16 v[114:115], v44 offset:53760
  ds_read_b64_tr_b16 v[116:117], v45 offset:53248
  v_mfma_f32_32x32x16_bf16 v[64:79], a[100:103], v[124:127], v[64:79]
  ds_read_b64_tr_b16 v[118:119], v45 offset:53760
  v_mfma_f32_32x32x16_bf16 v[80:95], v[120:123], v[32:35], v[80:95]
  s_mul_i32 s61, s68, 1344
  s_add_u32 s61, s61, s53
  s_lshr_b32 s56, s55, 1
  s_add_u32 m0, s56, 81920
  s_nop 0
  buffer_load_dwordx4 v11, s[12:15], s61 offen lds
  v_mfma_f32_32x32x16_bf16 v[96:111], v[32:35], v[124:127], v[96:111]
  s_waitcnt lgkmcnt(0)
  v_mfma_f32_32x32x16_bf16 v[48:63], v[112:115], a[104:107], v[48:63]
  ds_read_b64_tr_b16 v[120:121], v44 offset:55296
  v_mfma_f32_32x32x16_bf16 v[64:79], a[104:107], v[116:119], v[64:79]
  ds_read_b64_tr_b16 v[122:123], v44 offset:55808
  v_mfma_f32_32x32x16_bf16 v[80:95], v[112:115], v[32:35], v[80:95]
  ds_read_b64_tr_b16 v[124:125], v45 offset:55296
  v_mfma_f32_32x32x16_bf16 v[96:111], v[32:35], v[116:119], v[96:111]
  ds_read_b64_tr_b16 v[126:127], v45 offset:55808
  s_waitcnt lgkmcnt(0)
  v_mfma_f32_32x32x16_bf16 v[48:63], v[120:123], a[108:111], v[48:63]
  v_mfma_f32_32x32x16_bf16 v[64:79], a[108:111], v[124:127], v[64:79]
  v_mfma_f32_32x32x16_bf16 v[80:95], v[120:123], v[32:35], v[80:95]
  v_mfma_f32_32x32x16_bf16 v[96:111], v[32:35], v[124:127], v[96:111]
  s_waitcnt vmcnt(5)
  s_mov_b32 s70, 0
L_sg_1:
  v_cmp_ne_u32 vcc, s44, v130
  s_cbranch_vccz L_sgd_2
  v_lshlrev_b32 v38, 4, v3
  buffer_load_dwordx4 v[128:131], v38, s[40:43], s60 offen sc1
  s_waitcnt vmcnt(0)
  s_add_u32 s70, s70, 1
  s_cmp_lt_u32 s70, 20000
  s_cbranch_scc1 L_sg_1
L_sgd_2:
  v_mul_f32 v47, v128, v129
  v_lshlrev_b32 v39, 2, v3
  s_lshl_b32 s57, s45, 8
  s_add_u32 s57, s57, 151552
  v_add_u32 v38, s57, v39
  ds_write_b32 v38, v129
  ds_write_b32 v38, v47 offset:128
  v_lshlrev_b32 v38, 4, v4
  v_add_u32 v38, s57, v38
  s_waitcnt lgkmcnt(0)
  ds_read_b128 v[132:135], v38 offset:0
  ds_read_b128 v[148:151], v38 offset:128
  ds_read_b128 v[136:139], v38 offset:32
  ds_read_b128 v[152:155], v38 offset:160
  ds_read_b128 v[140:143], v38 offset:64
  ds_read_b128 v[156:159], v38 offset:192
  ds_read_b128 v[144:147], v38 offset:96
  ds_read_b128 v[160:163], v38 offset:224
  v_cmp_eq_u32 vcc, 0, v4
  s_nop 1
  v_cndmask_b32 v165, 0, -1, vcc
  v_cmp_gt_u32 vcc, 28, v3
  s_nop 1
  v_cndmask_b32 v166, 0, -1, vcc
  v_cmp_eq_u32 vcc, 28, v3
  s_nop 1
  v_cndmask_b32 v167, 0, v32, vcc
  v_pk_fma_f32 v[48:49], v[128:129], v[80:81], v[48:49] op_sel_hi:[0,1,1] neg_lo:[1,0,0] neg_hi:[1,0,0]
  v_pk_fma_f32 v[50:51], v[128:129], v[82:83], v[50:51] op_sel_hi:[0,1,1] neg_lo:[1,0,0] neg_hi:[1,0,0]
  v_pk_fma_f32 v[52:53], v[128:129], v[84:85], v[52:53] op_sel_hi:[0,1,1] neg_lo:[1,0,0] neg_hi:[1,0,0]
  v_pk_fma_f32 v[54:55], v[128:129], v[86:87], v[54:55] op_sel_hi:[0,1,1] neg_lo:[1,0,0] neg_hi:[1,0,0]
  v_pk_fma_f32 v[56:57], v[128:129], v[88:89], v[56:57] op_sel_hi:[0,1,1] neg_lo:[1,0,0] neg_hi:[1,0,0]
  v_pk_fma_f32 v[58:59], v[128:129], v[90:91], v[58:59] op_sel_hi:[0,1,1] neg_lo:[1,0,0] neg_hi:[1,0,0]
  v_pk_fma_f32 v[60:61], v[128:129], v[92:93], v[60:61] op_sel_hi:[0,1,1] neg_lo:[1,0,0] neg_hi:[1,0,0]
  v_pk_fma_f32 v[62:63], v[128:129], v[94:95], v[62:63] op_sel_hi:[0,1,1] neg_lo:[1,0,0] neg_hi:[1,0,0]
  v_pk_mul_f32 v[48:49], v[48:49], v[128:129] op_sel:[0,1] op_sel_hi:[1,1]
  v_pk_mul_f32 v[50:51], v[50:51], v[128:129] op_sel:[0,1] op_sel_hi:[1,1]
  v_pk_mul_f32 v[52:53], v[52:53], v[128:129] op_sel:[0,1] op_sel_hi:[1,1]
  v_pk_mul_f32 v[54:55], v[54:55], v[128:129] op_sel:[0,1] op_sel_hi:[1,1]
  v_pk_mul_f32 v[56:57], v[56:57], v[128:129] op_sel:[0,1] op_sel_hi:[1,1]
  v_pk_mul_f32 v[58:59], v[58:59], v[128:129] op_sel:[0,1] op_sel_hi:[1,1]
  v_pk_mul_f32 v[60:61], v[60:61], v[128:129] op_sel:[0,1] op_sel_hi:[1,1]
  v_pk_mul_f32 v[62:63], v[62:63], v[128:129] op_sel:[0,1] op_sel_hi:[1,1]
  v_cvt_pk_bf16_f32 v168, v48, v49
  v_cvt_pk_bf16_f32 v169, v50, v51
  v_cvt_pk_bf16_f32 v170, v52, v53
  v_cvt_pk_bf16_f32 v171, v54, v55
  v_cvt_pk_bf16_f32 v172, v56, v57
  v_cvt_pk_bf16_f32 v173, v58, v59
  v_cvt_pk_bf16_f32 v174, v60, v61
  v_cvt_pk_bf16_f32 v175, v62, v63
  v_and_b32 v174, v174, v165
  v_and_b32 v175, v175, v165
  s_lshl_b32 s56, s49, 6
  s_add_u32 s56, s56, s58
  s_lshl_b32 s56, s56, 12
  s_add_u32 s56, s56, 1048576
  buffer_store_dwordx4 v[168:171], v2, s[40:43], s56 offen offset:0 sc1
  buffer_store_dwordx4 v[172:175], v2, s[40:43], s56 offen offset:1024 sc1
  s_waitcnt lgkmcnt(0)
  v_pk_mul_f32 v[148:149], v[148:149], v[96:97]
  v_pk_fma_f32 v[64:65], v[64:65], v[132:133], v[148:149] neg_lo:[0,0,1] neg_hi:[0,0,1]
  v_pk_mul_f32 v[150:151], v[150:151], v[98:99]
  v_pk_fma_f32 v[66:67], v[66:67], v[134:135], v[150:151] neg_lo:[0,0,1] neg_hi:[0,0,1]
  v_pk_mul_f32 v[152:153], v[152:153], v[100:101]
  v_pk_fma_f32 v[68:69], v[68:69], v[136:137], v[152:153] neg_lo:[0,0,1] neg_hi:[0,0,1]
  v_pk_mul_f32 v[154:155], v[154:155], v[102:103]
  v_pk_fma_f32 v[70:71], v[70:71], v[138:139], v[154:155] neg_lo:[0,0,1] neg_hi:[0,0,1]
  v_pk_mul_f32 v[156:157], v[156:157], v[104:105]
  v_pk_fma_f32 v[72:73], v[72:73], v[140:141], v[156:157] neg_lo:[0,0,1] neg_hi:[0,0,1]
  v_pk_mul_f32 v[158:159], v[158:159], v[106:107]
  v_pk_fma_f32 v[74:75], v[74:75], v[142:143], v[158:159] neg_lo:[0,0,1] neg_hi:[0,0,1]
  v_pk_mul_f32 v[160:161], v[160:161], v[108:109]
  v_pk_fma_f32 v[76:77], v[76:77], v[144:145], v[160:161] neg_lo:[0,0,1] neg_hi:[0,0,1]
  v_pk_mul_f32 v[162:163], v[162:163], v[110:111]
  v_pk_fma_f32 v[78:79], v[78:79], v[146:147], v[162:163] neg_lo:[0,0,1] neg_hi:[0,0,1]
  v_cvt_pk_bf16_f32 v176, v64, v65
  v_cvt_pk_bf16_f32 v177, v66, v67
  v_cvt_pk_bf16_f32 v178, v68, v69
  v_cvt_pk_bf16_f32 v179, v70, v71
  v_cvt_pk_bf16_f32 v180, v72, v73
  v_cvt_pk_bf16_f32 v181, v74, v75
  v_cvt_pk_bf16_f32 v182, v76, v77
  v_cvt_pk_bf16_f32 v183, v78, v79
  v_and_or_b32 v176, v176, v166, v167
  v_and_or_b32 v177, v177, v166, v167
  v_and_or_b32 v178, v178, v166, v167
  v_and_or_b32 v179, v179, v166, v167
  v_and_or_b32 v180, v180, v166, v167
  v_and_or_b32 v181, v181, v166, v167
  v_and_or_b32 v182, v182, v166, v167
  v_and_or_b32 v183, v183, v166, v167
  buffer_store_dwordx4 v[176:179], v2, s[40:43], s56 offen offset:2048 sc1
  buffer_store_dwordx4 v[180:183], v2, s[40:43], s56 offen offset:3072 sc1
  s_waitcnt vmcnt(4)
  s_barrier
  s_lshl_b32 s50, s45, 12
  s_add_u32 s50, s50, 135168
  v_add_u32 v38, s50, v2
  ds_write_b128 v38, v[168:171] offset:0
  ds_write_b128 v38, v[172:175] offset:1024
  ds_write_b128 v38, v[176:179] offset:2048
  ds_write_b128 v38, v[180:183] offset:3072
  ds_read_b64_tr_b16 v[80:81], v46 offset:0
  ds_read_b64_tr_b16 v[82:83], v46 offset:256
  ds_read_b64_tr_b16 v[84:85], v46 offset:1024
  ds_read_b64_tr_b16 v[86:87], v46 offset:1280
  s_lshl_b32 s59, s49, 7
  s_lshl_b32 s56, s48, 2
  s_add_u32 s59, s59, s56
  s_add_u32 s59, s59, 4096
  s_waitcnt lgkmcnt(2)
  v_mfma_f32_32x32x16_bf16 v[48:63], v[80:83], a[0:3], 0
  ds_read_b64_tr_b16 v[88:89], v46 offset:2048
  v_mfma_f32_32x32x16_bf16 v[64:79], v[80:83], v[32:35], 0
  ds_read_b64_tr_b16 v[90:91], v46 offset:2304
  s_waitcnt lgkmcnt(2)
  v_mfma_f32_32x32x16_bf16 v[48:63], v[84:87], a[4:7], v[48:63]
  ds_read_b64_tr_b16 v[92:93], v46 offset:3072
  v_mfma_f32_32x32x16_bf16 v[64:79], v[84:87], v[32:35], v[64:79]
  ds_read_b64_tr_b16 v[94:95], v46 offset:3328
  s_waitcnt lgkmcnt(2)
  v_mfma_f32_32x32x16_bf16 v[48:63], v[88:91], a[8:11], v[48:63]
  ds_read_b64_tr_b16 v[80:81], v46 offset:4096
  v_mfma_f32_32x32x16_bf16 v[64:79], v[88:91], v[32:35], v[64:79]
  ds_read_b64_tr_b16 v[82:83], v46 offset:4352
  s_waitcnt lgkmcnt(2)
  v_mfma_f32_32x32x16_bf16 v[48:63], v[92:95], a[12:15], v[48:63]
  ds_read_b64_tr_b16 v[84:85], v46 offset:5120
  v_mfma_f32_32x32x16_bf16 v[64:79], v[92:95], v[32:35], v[64:79]
  ds_read_b64_tr_b16 v[86:87], v46 offset:5376
  s_waitcnt lgkmcnt(2)
  v_mfma_f32_32x32x16_bf16 v[48:63], v[80:83], a[16:19], v[48:63]
  ds_read_b64_tr_b16 v[88:89], v46 offset:6144
  v_mfma_f32_32x32x16_bf16 v[64:79], v[80:83], v[32:35], v[64:79]
  ds_read_b64_tr_b16 v[90:91], v46 offset:6400
  s_waitcnt lgkmcnt(2)
  v_mfma_f32_32x32x16_bf16 v[48:63], v[84:87], a[20:23], v[48:63]
  ds_read_b64_tr_b16 v[92:93], v46 offset:7168
  v_mfma_f32_32x32x16_bf16 v[64:79], v[84:87], v[32:35], v[64:79]
  ds_read_b64_tr_b16 v[94:95], v46 offset:7424
  s_waitcnt lgkmcnt(2)
  v_mfma_f32_32x32x16_bf16 v[48:63], v[88:91], a[24:27], v[48:63]
  ds_read_b64_tr_b16 v[80:81], v46 offset:8192
  v_mfma_f32_32x32x16_bf16 v[64:79], v[88:91], v[32:35], v[64:79]
  ds_read_b64_tr_b16 v[82:83], v46 offset:8448
  s_waitcnt lgkmcnt(2)
  v_mfma_f32_32x32x16_bf16 v[48:63], v[92:95], a[28:31], v[48:63]
  ds_read_b64_tr_b16 v[84:85], v46 offset:9216
  v_mfma_f32_32x32x16_bf16 v[64:79], v[92:95], v[32:35], v[64:79]
  ds_read_b64_tr_b16 v[86:87], v46 offset:9472
  s_waitcnt lgkmcnt(2)
  v_mfma_f32_32x32x16_bf16 v[48:63], v[80:83], a[32:35], v[48:63]
  ds_read_b64_tr_b16 v[88:89], v46 offset:10240
  v_mfma_f32_32x32x16_bf16 v[64:79], v[80:83], v[32:35], v[64:79]
  ds_read_b64_tr_b16 v[90:91], v46 offset:10496
  s_waitcnt lgkmcnt(2)
  v_mfma_f32_32x32x16_bf16 v[48:63], v[84:87], a[36:39], v[48:63]
  ds_read_b64_tr_b16 v[92:93], v46 offset:11264
  v_mfma_f32_32x32x16_bf16 v[64:79], v[84:87], v[32:35], v[64:79]
  ds_read_b64_tr_b16 v[94:95], v46 offset:11520
  s_waitcnt lgkmcnt(2)
  v_mfma_f32_32x32x16_bf16 v[48:63], v[88:91], a[40:43], v[48:63]
  ds_read_b64_tr_b16 v[80:81], v46 offset:12288
  v_mfma_f32_32x32x16_bf16 v[64:79], v[88:91], v[32:35], v[64:79]
  ds_read_b64_tr_b16 v[82:83], v46 offset:12544
  s_waitcnt lgkmcnt(2)
  v_mfma_f32_32x32x16_bf16 v[48:63], v[92:95], a[44:47], v[48:63]
  ds_read_b64_tr_b16 v[84:85], v46 offset:13312
  v_mfma_f32_32x32x16_bf16 v[64:79], v[92:95], v[32:35], v[64:79]
  ds_read_b64_tr_b16 v[86:87], v46 offset:13568
  s_waitcnt lgkmcnt(2)
  v_mfma_f32_32x32x16_bf16 v[48:63], v[80:83], a[48:51], v[48:63]
  ds_read_b64_tr_b16 v[88:89], v46 offset:14336
  v_mfma_f32_32x32x16_bf16 v[64:79], v[80:83], v[32:35], v[64:79]
  ds_read_b64_tr_b16 v[90:91], v46 offset:14592
  s_waitcnt vmcnt(0)
  s_barrier
  s_cmp_lg_u32 s45, 0
  s_cbranch_scc1 L_nf_3
  v_mov_b32 v5, s44
  v_mov_b32 v6, 0
  s_mov_b64 exec, 1
  buffer_store_dword v5, v6, s[40:43], s59 offen sc1
  s_mov_b64 exec, -1
L_nf_3:
  s_waitcnt lgkmcnt(2)
  v_mfma_f32_32x32x16_bf16 v[48:63], v[84:87], a[52:55], v[48:63]
  ds_read_b64_tr_b16 v[92:93], v46 offset:15360
  v_mfma_f32_32x32x16_bf16 v[64:79], v[84:87], v[32:35], v[64:79]
  ds_read_b64_tr_b16 v[94:95], v46 offset:15616
  s_waitcnt lgkmcnt(2)
  v_mfma_f32_32x32x16_bf16 v[48:63], v[88:91], a[56:59], v[48:63]
  ds_read_b64_tr_b16 v[80:81], v46 offset:16384
  v_mfma_f32_32x32x16_bf16 v[64:79], v[88:91], v[32:35], v[64:79]
  ds_read_b64_tr_b16 v[82:83], v46 offset:16640
  s_waitcnt lgkmcnt(2)
  v_mfma_f32_32x32x16_bf16 v[48:63], v[92:95], a[60:63], v[48:63]
  ds_read_b64_tr_b16 v[84:85], v46 offset:17408
  v_mfma_f32_32x32x16_bf16 v[64:79], v[92:95], v[32:35], v[64:79]
  ds_read_b64_tr_b16 v[86:87], v46 offset:17664
  s_waitcnt lgkmcnt(2)
  v_mfma_f32_32x32x16_bf16 v[48:63], v[80:83], a[64:67], v[48:63]
  ds_read_b64_tr_b16 v[88:89], v46 offset:18432
  v_mfma_f32_32x32x16_bf16 v[64:79], v[80:83], v[32:35], v[64:79]
  ds_read_b64_tr_b16 v[90:91], v46 offset:18688
  s_waitcnt lgkmcnt(2)
  v_mfma_f32_32x32x16_bf16 v[48:63], v[84:87], a[68:71], v[48:63]
  ds_read_b64_tr_b16 v[92:93], v46 offset:19456
  v_mfma_f32_32x32x16_bf16 v[64:79], v[84:87], v[32:35], v[64:79]
  ds_read_b64_tr_b16 v[94:95], v46 offset:19712
  s_waitcnt lgkmcnt(2)
  v_mfma_f32_32x32x16_bf16 v[48:63], v[88:91], a[72:75], v[48:63]
  ds_read_b64_tr_b16 v[80:81], v46 offset:20480
  v_mfma_f32_32x32x16_bf16 v[64:79], v[88:91], v[32:35], v[64:79]
  ds_read_b64_tr_b16 v[82:83], v46 offset:20736
  s_waitcnt lgkmcnt(2)
  v_mfma_f32_32x32x16_bf16 v[48:63], v[92:95], a[76:79], v[48:63]
  ds_read_b64_tr_b16 v[84:85], v46 offset:21504
  v_mfma_f32_32x32x16_bf16 v[64:79], v[92:95], v[32:35], v[64:79]
  ds_read_b64_tr_b16 v[86:87], v46 offset:21760
  s_waitcnt lgkmcnt(2)
  v_mfma_f32_32x32x16_bf16 v[48:63], v[80:83], a[80:83], v[48:63]
  ds_read_b64_tr_b16 v[88:89], v46 offset:22528
  v_mfma_f32_32x32x16_bf16 v[64:79], v[80:83], v[32:35], v[64:79]
  ds_read_b64_tr_b16 v[90:91], v46 offset:22784
  s_waitcnt lgkmcnt(2)
  v_mfma_f32_32x32x16_bf16 v[48:63], v[84:87], a[84:87], v[48:63]
  ds_read_b64_tr_b16 v[92:93], v46 offset:23552
  v_mfma_f32_32x32x16_bf16 v[64:79], v[84:87], v[32:35], v[64:79]
  ds_read_b64_tr_b16 v[94:95], v46 offset:23808
  s_waitcnt lgkmcnt(2)
  v_mfma_f32_32x32x16_bf16 v[48:63], v[88:91], a[88:91], v[48:63]
  ds_read_b64_tr_b16 v[80:81], v46 offset:24576
  v_mfma_f32_32x32x16_bf16 v[64:79], v[88:91], v[32:35], v[64:79]
  ds_read_b64_tr_b16 v[82:83], v46 offset:24832
  s_waitcnt lgkmcnt(2)
  v_mfma_f32_32x32x16_bf16 v[48:63], v[92:95], a[92:95], v[48:63]
  ds_read_b64_tr_b16 v[84:85], v46 offset:25600
  v_mfma_f32_32x32x16_bf16 v[64:79], v[92:95], v[32:35], v[64:79]
  ds_read_b64_tr_b16 v[86:87], v46 offset:25856
  s_waitcnt lgkmcnt(2)
  v_mfma_f32_32x32x16_bf16 v[48:63], v[80:83], a[96:99], v[48:63]
  ds_read_b64_tr_b16 v[88:89], v46 offset:26624
  v_mfma_f32_32x32x16_bf16 v[64:79], v[80:83], v[32:35], v[64:79]
  ds_read_b64_tr_b16 v[90:91], v46 offset:26880
  s_waitcnt lgkmcnt(2)
  v_mfma_f32_32x32x16_bf16 v[48:63], v[84:87], a[100:103], v[48:63]
  ds_read_b64_tr_b16 v[92:93], v46 offset:27648
  v_mfma_f32_32x32x16_bf16 v[64:79], v[84:87], v[32:35], v[64:79]
  ds_read_b64_tr_b16 v[94:95], v46 offset:27904
  s_waitcnt lgkmcnt(2)
  v_mfma_f32_32x32x16_bf16 v[48:63], v[88:91], a[104:107], v[48:63]
  v_mfma_f32_32x32x16_bf16 v[64:79], v[88:91], v[32:35], v[64:79]
  s_waitcnt lgkmcnt(0)
  v_mfma_f32_32x32x16_bf16 v[48:63], v[92:95], a[108:111], v[48:63]
  v_mfma_f32_32x32x16_bf16 v[64:79], v[92:95], v[32:35], v[64:79]
  v_mul_f32 v96, 0x3e8b97f6, v129
  v_lshlrev_b32 v98, 2, v4
  v_sub_u32 v98, v3, v98
  v_mov_b32 v99, 0xf149f2ca
  v_cmp_le_i32 vcc, 0, v98
  s_nop 1
  v_cndmask_b32 v108, v99, 0, vcc
  v_cndmask_b32 v132, 0, v99, vcc
  v_cmp_le_i32 vcc, 1, v98
  s_nop 1
  v_cndmask_b32 v109, v99, 0, vcc
  v_cndmask_b32 v133, 0, v99, vcc
  v_cmp_le_i32 vcc, 2, v98
  s_nop 1
  v_cndmask_b32 v110, v99, 0, vcc
  v_cndmask_b32 v134, 0, v99, vcc
  v_cmp_le_i32 vcc, 3, v98
  s_nop 1
  v_cndmask_b32 v111, v99, 0, vcc
  v_cndmask_b32 v135, 0, v99, vcc
  v_cmp_le_i32 vcc, 8, v98
  s_nop 1
  v_cndmask_b32 v112, v99, 0, vcc
  v_cndmask_b32 v136, 0, v99, vcc
  v_cmp_le_i32 vcc, 9, v98
  s_nop 1
  v_cndmask_b32 v113, v99, 0, vcc
  v_cndmask_b32 v137, 0, v99, vcc
  v_cmp_le_i32 vcc, 10, v98
  s_nop 1
  v_cndmask_b32 v114, v99, 0, vcc
  v_cndmask_b32 v138, 0, v99, vcc
  v_cmp_le_i32 vcc, 11, v98
  s_nop 1
  v_cndmask_b32 v115, v99, 0, vcc
  v_cndmask_b32 v139, 0, v99, vcc
  v_cmp_le_i32 vcc, 16, v98
  s_nop 1
  v_cndmask_b32 v116, v99, 0, vcc
  v_cndmask_b32 v140, 0, v99, vcc
  v_cmp_le_i32 vcc, 17, v98
  s_nop 1
  v_cndmask_b32 v117, v99, 0, vcc
  v_cndmask_b32 v141, 0, v99, vcc
  v_cmp_le_i32 vcc, 18, v98
  s_nop 1
  v_cndmask_b32 v118, v99, 0, vcc
  v_cndmask_b32 v142, 0, v99, vcc
  v_cmp_le_i32 vcc, 19, v98
  s_nop 1
  v_cndmask_b32 v119, v99, 0, vcc
  v_cndmask_b32 v143, 0, v99, vcc
  v_cmp_le_i32 vcc, 24, v98
  s_nop 1
  v_cndmask_b32 v120, v99, 0, vcc
  v_cndmask_b32 v144, 0, v99, vcc
  v_cmp_le_i32 vcc, 25, v98
  s_nop 1
  v_cndmask_b32 v121, v99, 0, vcc
  v_cndmask_b32 v145, 0, v99, vcc
  v_cmp_le_i32 vcc, 26, v98
  s_nop 1
  v_cndmask_b32 v122, v99, 0, vcc
  v_cndmask_b32 v146, 0, v99, vcc
  v_cmp_le_i32 vcc, 27, v98
  s_nop 1
  v_cndmask_b32 v123, v99, 0, vcc
  v_cndmask_b32 v147, 0, v99, vcc
  v_pk_fma_f32 v[48:49], v[128:129], v[64:65], v[48:49] op_sel_hi:[0,1,1] neg_lo:[1,0,0] neg_hi:[1,0,0]
  v_pk_fma_f32 v[50:51], v[128:129], v[66:67], v[50:51] op_sel_hi:[0,1,1] neg_lo:[1,0,0] neg_hi:[1,0,0]
  v_pk_fma_f32 v[52:53], v[128:129], v[68:69], v[52:53] op_sel_hi:[0,1,1] neg_lo:[1,0,0] neg_hi:[1,0,0]
  v_pk_fma_f32 v[54:55], v[128:129], v[70:71], v[54:55] op_sel_hi:[0,1,1] neg_lo:[1,0,0] neg_hi:[1,0,0]
  v_pk_fma_f32 v[56:57], v[128:129], v[72:73], v[56:57] op_sel_hi:[0,1,1] neg_lo:[1,0,0] neg_hi:[1,0,0]
  v_pk_fma_f32 v[58:59], v[128:129], v[74:75], v[58:59] op_sel_hi:[0,1,1] neg_lo:[1,0,0] neg_hi:[1,0,0]
  v_pk_fma_f32 v[60:61], v[128:129], v[76:77], v[60:61] op_sel_hi:[0,1,1] neg_lo:[1,0,0] neg_hi:[1,0,0]
  v_pk_fma_f32 v[62:63], v[128:129], v[78:79], v[62:63] op_sel_hi:[0,1,1] neg_lo:[1,0,0] neg_hi:[1,0,0]
  v_pk_mul_f32 v[48:49], v[48:49], v[96:97] op_sel_hi:[1,0]
  v_pk_mul_f32 v[50:51], v[50:51], v[96:97] op_sel_hi:[1,0]
  v_pk_mul_f32 v[52:53], v[52:53], v[96:97] op_sel_hi:[1,0]
  v_pk_mul_f32 v[54:55], v[54:55], v[96:97] op_sel_hi:[1,0]
  v_pk_mul_f32 v[56:57], v[56:57], v[96:97] op_sel_hi:[1,0]
  v_pk_mul_f32 v[58:59], v[58:59], v[96:97] op_sel_hi:[1,0]
  v_pk_mul_f32 v[60:61], v[60:61], v[96:97] op_sel_hi:[1,0]
  v_pk_mul_f32 v[62:63], v[62:63], v[96:97] op_sel_hi:[1,0]
  v_cvt_pk_bf16_f32 v100, v48, v49
  v_cvt_pk_bf16_f32 v101, v50, v51
  v_cvt_pk_bf16_f32 v102, v52, v53
  v_cvt_pk_bf16_f32 v103, v54, v55
  v_cvt_pk_bf16_f32 v104, v56, v57
  v_cvt_pk_bf16_f32 v105, v58, v59
  v_cvt_pk_bf16_f32 v106, v60, v61
  v_cvt_pk_bf16_f32 v107, v62, v63
  v_and_b32 v106, v106, v165
  v_and_b32 v107, v107, v165
  s_lshl_b32 s59, s49, 7
  s_add_u32 s59, s59, 4096
  s_sub_i32 s56, s48, 1
  s_max_i32 s56, s56, 0
  s_sub_i32 s57, s48, 2
  s_max_i32 s57, s57, 0
  s_lshl_b32 s56, s56, 2
  s_lshl_b32 s57, s57, 2
  v_mov_b32 v9, s56
  v_mov_b32 v38, s57
  v_cmp_eq_u32 vcc, 0, v4
  s_nop 1
  v_cndmask_b32 v9, v38, v9, vcc
  s_cmp_lg_u32 s45, 0
  s_cbranch_scc1 L_po_6
  buffer_load_dword v5, v9, s[40:43], s59 offen sc1
  s_sleep 1
  buffer_load_dword v6, v9, s[40:43], s59 offen sc1
  s_sleep 1
  buffer_load_dword v7, v9, s[40:43], s59 offen sc1
  s_sleep 1
  buffer_load_dword v8, v9, s[40:43], s59 offen sc1
  s_mov_b32 s70, 0
L_poll_4:
  s_waitcnt vmcnt(3)
  v_cmp_ne_u32 vcc, s44, v5
  s_cbranch_vccz L_pd_5
  buffer_load_dword v5, v9, s[40:43], s59 offen sc1
  s_waitcnt vmcnt(3)
  v_cmp_ne_u32 vcc, s44, v6
  s_cbranch_vccz L_pd_5
  buffer_load_dword v6, v9, s[40:43], s59 offen sc1
  s_waitcnt vmcnt(3)
  v_cmp_ne_u32 vcc, s44, v7
  s_cbranch_vccz L_pd_5
  buffer_load_dword v7, v9, s[40:43], s59 offen sc1
  s_waitcnt vmcnt(3)
  v_cmp_ne_u32 vcc, s44, v8
  s_cbranch_vccz L_pd_5
  buffer_load_dword v8, v9, s[40:43], s59 offen sc1
  s_add_u32 s70, s70, 1
  s_cmp_lt_u32 s70, 20000
  s_cbranch_scc1 L_poll_4
  s_branch L_pd_5
L_po_6:
  s_waitcnt vmcnt(0)
L_pd_5:
  s_barrier
  s_lshl_b32 s59, s49, 18
  s_add_u32 s59, s59, 1048576
  s_lshl_b32 s56, s48, 2
  s_lshl_b32 s57, s45, 1
  s_add_u32 s56, s56, s57
  s_add_i32 s56, s56, -8
  s_max_i32 s56, s56, 0
  s_lshl_b32 s56, s56, 12
  s_add_u32 s56, s56, s59
  s_lshl_b32 s57, s45, 13
  s_add_u32 s57, s57, 102400
  s_add_u32 m0, s57, 0
  s_add_u32 s50, s56, 0
  buffer_load_dwordx4 v2, s[40:43], s50 offen sc1 lds
  s_add_u32 m0, s57, 1024
  s_add_u32 s50, s56, 1024
  buffer_load_dwordx4 v2, s[40:43], s50 offen sc1 lds
  s_add_u32 m0, s57, 2048
  s_add_u32 s50, s56, 2048
  buffer_load_dwordx4 v2, s[40:43], s50 offen sc1 lds
  s_add_u32 m0, s57, 3072
  s_add_u32 s50, s56, 3072
  buffer_load_dwordx4 v2, s[40:43], s50 offen sc1 lds
  s_lshl_b32 s56, s48, 2
  s_lshl_b32 s57, s45, 1
  s_add_u32 s56, s56, s57
  s_add_i32 s56, s56, -7
  s_max_i32 s56, s56, 0
  s_lshl_b32 s56, s56, 12
  s_add_u32 s56, s56, s59
  s_lshl_b32 s57, s45, 13
  s_add_u32 s57, s57, 106496
  s_add_u32 m0, s57, 0
  s_add_u32 s50, s56, 0
  buffer_load_dwordx4 v2, s[40:43], s50 offen sc1 lds
  s_add_u32 m0, s57, 1024
  s_add_u32 s50, s56, 1024
  buffer_load_dwordx4 v2, s[40:43], s50 offen sc1 lds
  s_add_u32 m0, s57, 2048
  s_add_u32 s50, s56, 2048
  buffer_load_dwordx4 v2, s[40:43], s50 offen sc1 lds
  s_add_u32 m0, s57, 3072
  s_add_u32 s50, s56, 3072
  buffer_load_dwordx4 v2, s[40:43], s50 offen sc1 lds
  s_lshl_b32 s50, s45, 12
  s_add_u32 s50, s50, 102400
  v_add_u32 v48, s50, v2
  s_sub_i32 s60, 8, s58
  s_max_i32 s60, s60, 0
  v_mov_b32 v50, 0xf149f2ca
  v_mov_b32 v51, 0xf149f2ca
  s_waitcnt vmcnt(0)
  s_barrier
  v_mov_b32 v232, 0xf149f2ca
  v_mov_b32 v233, 0xf149f2ca
  v_mov_b32 v234, 0xf149f2ca
  v_mov_b32 v235, 0xf149f2ca
  v_mov_b32 v236, 0xf149f2ca
  v_mov_b32 v237, 0xf149f2ca
  v_mov_b32 v238, 0xf149f2ca
  v_mov_b32 v239, 0xf149f2ca
  v_mov_b32 v240, 0xf149f2ca
  v_mov_b32 v241, 0xf149f2ca
  v_mov_b32 v242, 0xf149f2ca
  v_mov_b32 v243, 0xf149f2ca
  v_mov_b32 v244, 0xf149f2ca
  v_mov_b32 v245, 0xf149f2ca
  v_mov_b32 v246, 0xf149f2ca
  v_mov_b32 v247, 0xf149f2ca
  s_cmp_gt_u32 s60, 0
  s_cbranch_scc1 L_abr_7
  ds_read_b128 v[200:203], v48 offset:0
  ds_read_b128 v[204:207], v48 offset:1024
  ds_read_b128 v[208:211], v48 offset:4096
  ds_read_b128 v[212:215], v48 offset:5120
  s_waitcnt lgkmcnt(2)
  v_mfma_f32_32x32x16_bf16 v[52:67], v[200:203], v[100:103], v[132:147]
  v_mfma_f32_32x32x16_bf16 v[52:67], v[204:207], v[104:107], v[52:67]
  s_waitcnt lgkmcnt(0)
  v_mfma_f32_32x32x16_bf16 v[68:83], v[208:211], v[100:103], 0
  ds_read_b128 v[200:203], v48 offset:8192
  ds_read_b128 v[204:207], v48 offset:9216
  s_lshl_b32 s69, s47, 2
  s_add_u32 s69, s69, s45
  s_mul_i32 s69, s69, 3136
  v_lshlrev_b32 v251, 6, v1
  buffer_load_dword v252, v251, s[16:19], s69 offen
  s_nop 2
  v_max3_f32 v50, v52, v53, v50
  v_max3_f32 v51, v54, v55, v51
  v_mfma_f32_32x32x16_bf16 v[68:83], v[212:215], v[104:107], v[68:83]
  v_max3_f32 v50, v56, v57, v50
  v_max3_f32 v51, v58, v59, v51
  v_max3_f32 v50, v60, v61, v50
  v_max3_f32 v51, v62, v63, v51
  v_max3_f32 v50, v64, v65, v50
  v_max3_f32 v51, v66, v67, v51
  s_waitcnt lgkmcnt(0)
  v_mfma_f32_32x32x16_bf16 v[52:67], v[200:203], v[100:103], 0
  ds_read_b128 v[208:211], v48 offset:12288
  ds_read_b128 v[212:215], v48 offset:13312
  s_nop 1
  v_max3_f32 v50, v68, v69, v50
  v_max3_f32 v51, v70, v71, v51
  v_max3_f32 v50, v72, v73, v50
  v_mfma_f32_32x32x16_bf16 v[52:67], v[204:207], v[104:107], v[52:67]
  v_max3_f32 v51, v74, v75, v51
  v_max3_f32 v50, v76, v77, v50
  v_max3_f32 v51, v78, v79, v51
  v_max3_f32 v50, v80, v81, v50
  v_max3_f32 v51, v82, v83, v51
  s_waitcnt lgkmcnt(0)
  v_mfma_f32_32x32x16_bf16 v[68:83], v[208:211], v[100:103], 0
  ds_read_b128 v[200:203], v48 offset:16384
  ds_read_b128 v[204:207], v48 offset:17408
  s_nop 2
  v_max3_f32 v50, v52, v53, v50
  v_max3_f32 v51, v54, v55, v51
  v_max3_f32 v50, v56, v57, v50
  v_mfma_f32_32x32x16_bf16 v[68:83], v[212:215], v[104:107], v[68:83]
  v_max3_f32 v51, v58, v59, v51
  v_max3_f32 v50, v60, v61, v50
  v_max3_f32 v51, v62, v63, v51
  v_max3_f32 v50, v64, v65, v50
  v_max3_f32 v51, v66, v67, v51
  s_waitcnt lgkmcnt(0)
  v_mfma_f32_32x32x16_bf16 v[52:67], v[200:203], v[100:103], 0
  ds_read_b128 v[208:211], v48 offset:20480
  ds_read_b128 v[212:215], v48 offset:21504
  s_nop 2
  v_max3_f32 v50, v68, v69, v50
  v_max3_f32 v51, v70, v71, v51
  v_max3_f32 v50, v72, v73, v50
  v_mfma_f32_32x32x16_bf16 v[52:67], v[204:207], v[104:107], v[52:67]
  v_max3_f32 v51, v74, v75, v51
  v_max3_f32 v50, v76, v77, v50
  v_max3_f32 v51, v78, v79, v51
  v_max3_f32 v50, v80, v81, v50
  v_max3_f32 v51, v82, v83, v51
  s_waitcnt lgkmcnt(0)
  v_mfma_f32_32x32x16_bf16 v[68:83], v[208:211], v[100:103], 0
  ds_read_b128 v[200:203], v48 offset:24576
  ds_read_b128 v[204:207], v48 offset:25600
  s_lshl_b32 s69, s47, 2
  s_add_u32 s69, s69, s45
  s_mul_i32 s69, s69, 12544
  v_lshlrev_b32 v251, 6, v1
  buffer_load_dword v252, v251, s[20:23], s69 offen
  v_max3_f32 v50, v52, v53, v50
  v_max3_f32 v51, v54, v55, v51
  v_mfma_f32_32x32x16_bf16 v[68:83], v[212:215], v[104:107], v[68:83]
  v_max3_f32 v50, v56, v57, v50
  v_max3_f32 v51, v58, v59, v51
  v_max3_f32 v50, v60, v61, v50
  v_max3_f32 v51, v62, v63, v51
  v_max3_f32 v50, v64, v65, v50
  v_max3_f32 v51, v66, v67, v51
  s_waitcnt lgkmcnt(0)
  v_mfma_f32_32x32x16_bf16 v[52:67], v[200:203], v[100:103], 0
  ds_read_b128 v[208:211], v48 offset:28672
  ds_read_b128 v[212:215], v48 offset:29696
  s_nop 1
  v_max3_f32 v50, v68, v69, v50
  v_max3_f32 v51, v70, v71, v51
  v_max3_f32 v50, v72, v73, v50
  v_mfma_f32_32x32x16_bf16 v[52:67], v[204:207], v[104:107], v[52:67]
  v_max3_f32 v51, v74, v75, v51
  v_max3_f32 v50, v76, v77, v50
  v_max3_f32 v51, v78, v79, v51
  v_max3_f32 v50, v80, v81, v50
  v_max3_f32 v51, v82, v83, v51
  s_waitcnt lgkmcnt(0)
  v_mfma_f32_32x32x16_bf16 v[68:83], v[208:211], v[100:103], 0
  ds_read_b128 v[200:203], v48 offset:32768
  ds_read_b128 v[204:207], v48 offset:33792
  s_nop 2
  v_max3_f32 v50, v52, v53, v50
  v_max3_f32 v51, v54, v55, v51
  v_max3_f32 v50, v56, v57, v50
  v_mfma_f32_32x32x16_bf16 v[68:83], v[212:215], v[104:107], v[68:83]
  v_max3_f32 v51, v58, v59, v51
  v_max3_f32 v50, v60, v61, v50
  v_max3_f32 v51, v62, v63, v51
  v_max3_f32 v50, v64, v65, v50
  v_max3_f32 v51, v66, v67, v51
  s_waitcnt lgkmcnt(0)
  v_mfma_f32_32x32x16_bf16 v[52:67], v[200:203], v[100:103], v[108:123]
  s_nop 4
  v_max3_f32 v50, v68, v69, v50
  v_max3_f32 v51, v70, v71, v51
  v_max3_f32 v50, v72, v73, v50
  v_max3_f32 v51, v74, v75, v51
  v_mfma_f32_32x32x16_bf16 v[52:67], v[204:207], v[104:107], v[52:67]
  v_max3_f32 v50, v76, v77, v50
  v_max3_f32 v51, v78, v79, v51
  v_max3_f32 v50, v80, v81, v50
  v_max3_f32 v51, v82, v83, v51
  s_nop 7
  v_max3_f32 v50, v52, v53, v50
  v_max3_f32 v51, v54, v55, v51
  v_max3_f32 v50, v56, v57, v50
  v_max3_f32 v51, v58, v59, v51
  v_max3_f32 v50, v60, v61, v50
  v_max3_f32 v51, v62, v63, v51
  v_max3_f32 v50, v64, v65, v50
  v_max3_f32 v51, v66, v67, v51
  v_max_f32 v50, v50, v51
  v_mov_b32 v38, v50
  s_nop 1
  v_permlane32_swap_b32 v50, v38
  v_max_f32 v50, v50, v38
  v_sub_f32 v148, 0, v50
  v_sub_f32 v149, 0, v50
  v_sub_f32 v150, 0, v50
  v_sub_f32 v151, 0, v50
  v_sub_f32 v152, 0, v50
  v_sub_f32 v153, 0, v50
  v_sub_f32 v154, 0, v50
  v_sub_f32 v155, 0, v50
  v_sub_f32 v156, 0, v50
  v_sub_f32 v157, 0, v50
  v_sub_f32 v158, 0, v50
  v_sub_f32 v159, 0, v50
  v_sub_f32 v160, 0, v50
  v_sub_f32 v161, 0, v50
  v_sub_f32 v162, 0, v50
  v_sub_f32 v163, 0, v50
  v_pk_add_f32 v[108:109], v[108:109], v[148:149]
  v_pk_add_f32 v[132:133], v[132:133], v[148:149]
  v_pk_add_f32 v[110:111], v[110:111], v[148:149]
  v_pk_add_f32 v[134:135], v[134:135], v[148:149]
  v_pk_add_f32 v[112:113], v[112:113], v[148:149]
  v_pk_add_f32 v[136:137], v[136:137], v[148:149]
  v_pk_add_f32 v[114:115], v[114:115], v[148:149]
  v_pk_add_f32 v[138:139], v[138:139], v[148:149]
  v_pk_add_f32 v[116:117], v[116:117], v[148:149]
  v_pk_add_f32 v[140:141], v[140:141], v[148:149]
  v_pk_add_f32 v[118:119], v[118:119], v[148:149]
  v_pk_add_f32 v[142:143], v[142:143], v[148:149]
  v_pk_add_f32 v[120:121], v[120:121], v[148:149]
  v_pk_add_f32 v[144:145], v[144:145], v[148:149]
  v_pk_add_f32 v[122:123], v[122:123], v[148:149]
  v_pk_add_f32 v[146:147], v[146:147], v[148:149]
  ds_read_b128 v[200:203], v48 offset:0
  ds_read_b128 v[204:207], v48 offset:1024
  ds_read_b128 v[208:211], v48 offset:4096
  ds_read_b128 v[212:215], v48 offset:5120
  s_waitcnt lgkmcnt(2)
  v_mfma_f32_32x32x16_bf16 v[52:67], v[200:203], v[100:103], v[132:147]
  v_mfma_f32_32x32x16_bf16 v[52:67], v[204:207], v[104:107], v[52:67]
  s_waitcnt lgkmcnt(0)
  v_mfma_f32_32x32x16_bf16 v[68:83], v[208:211], v[100:103], v[148:163]
  ds_read_b128 v[216:219], v48 offset:2048
  ds_read_b128 v[220:223], v48 offset:3072
  ds_read_b128 v[200:203], v48 offset:8192
  ds_read_b128 v[204:207], v48 offset:9216
  s_nop 5
  v_exp_f32 v52, v52
  v_exp_f32 v53, v53
  v_exp_f32 v54, v54
  v_exp_f32 v55, v55
  v_cvt_pk_bf16_f32 v184, v52, v53
  v_exp_f32 v56, v56
  v_exp_f32 v57, v57
  v_cvt_pk_bf16_f32 v185, v54, v55
  v_exp_f32 v58, v58
  v_exp_f32 v59, v59
  v_cvt_pk_bf16_f32 v186, v56, v57
  v_mfma_f32_32x32x16_bf16 v[68:83], v[212:215], v[104:107], v[68:83]
  v_exp_f32 v60, v60
  s_add_u32 s69, s69, 4096
  buffer_load_dword v252, v251, s[20:23], s69 offen
  v_exp_f32 v61, v61
  v_cvt_pk_bf16_f32 v187, v58, v59
  v_exp_f32 v62, v62
  v_exp_f32 v63, v63
  v_cvt_pk_bf16_f32 v188, v60, v61
  v_exp_f32 v64, v64
  v_exp_f32 v65, v65
  v_cvt_pk_bf16_f32 v189, v62, v63
  v_exp_f32 v66, v66
  v_exp_f32 v67, v67
  v_cvt_pk_bf16_f32 v190, v64, v65
  v_cvt_pk_bf16_f32 v191, v66, v67
  s_waitcnt lgkmcnt(0)
  v_mfma_f32_32x32x16_bf16 v[52:67], v[200:203], v[100:103], v[148:163]
  ds_read_b128 v[224:227], v48 offset:6144
  ds_read_b128 v[228:231], v48 offset:7168
  ds_read_b128 v[208:211], v48 offset:12288
  ds_read_b128 v[212:215], v48 offset:13312
  v_exp_f32 v68, v68
  v_exp_f32 v69, v69
  v_exp_f32 v70, v70
  v_exp_f32 v71, v71
  v_mfma_f32_32x32x16_bf16 v[52:67], v[204:207], v[104:107], v[52:67]
  v_cvt_pk_bf16_f32 v192, v68, v69
  v_exp_f32 v72, v72
  v_exp_f32 v73, v73
  v_cvt_pk_bf16_f32 v193, v70, v71
  v_exp_f32 v74, v74
  v_exp_f32 v75, v75
  v_mfma_f32_32x32x16_bf16 v[168:183], v[216:219], v[184:187], 0
  v_cvt_pk_bf16_f32 v194, v72, v73
  v_exp_f32 v76, v76
  v_exp_f32 v77, v77
  v_cvt_pk_bf16_f32 v195, v74, v75
  v_exp_f32 v78, v78
  v_exp_f32 v79, v79
  v_cvt_pk_bf16_f32 v196, v76, v77
  v_mfma_f32_32x32x16_bf16 v[168:183], v[220:223], v[188:191], v[168:183]
  v_exp_f32 v80, v80
  v_exp_f32 v81, v81
  v_cvt_pk_bf16_f32 v197, v78, v79
  v_exp_f32 v82, v82
  v_exp_f32 v83, v83
  v_cvt_pk_bf16_f32 v198, v80, v81
  v_cvt_pk_bf16_f32 v199, v82, v83
  s_waitcnt lgkmcnt(0)
  v_mfma_f32_32x32x16_bf16 v[68:83], v[208:211], v[100:103], v[148:163]
  ds_read_b128 v[216:219], v48 offset:10240
  ds_read_b128 v[220:223], v48 offset:11264
  ds_read_b128 v[200:203], v48 offset:16384
  ds_read_b128 v[204:207], v48 offset:17408
  v_exp_f32 v52, v52
  v_exp_f32 v53, v53
  v_exp_f32 v54, v54
  v_exp_f32 v55, v55
  v_mfma_f32_32x32x16_bf16 v[68:83], v[212:215], v[104:107], v[68:83]
  v_cvt_pk_bf16_f32 v184, v52, v53
  v_exp_f32 v56, v56
  v_exp_f32 v57, v57
  v_cvt_pk_bf16_f32 v185, v54, v55
  v_exp_f32 v58, v58
  v_exp_f32 v59, v59
  v_cvt_pk_bf16_f32 v186, v56, v57
  v_mfma_f32_32x32x16_bf16 v[168:183], v[224:227], v[192:195], v[168:183]
  v_exp_f32 v60, v60
  s_add_u32 s69, s69, 4096
  buffer_load_dword v252, v251, s[20:23], s69 offen
  v_exp_f32 v61, v61
  v_cvt_pk_bf16_f32 v187, v58, v59
  v_exp_f32 v62, v62
  v_exp_f32 v63, v63
  v_mfma_f32_32x32x16_bf16 v[168:183], v[228:231], v[196:199], v[168:183]
  v_cvt_pk_bf16_f32 v188, v60, v61
  v_exp_f32 v64, v64
  v_exp_f32 v65, v65
  v_cvt_pk_bf16_f32 v189, v62, v63
  v_exp_f32 v66, v66
  v_exp_f32 v67, v67
  v_cvt_pk_bf16_f32 v190, v64, v65
  v_cvt_pk_bf16_f32 v191, v66, v67
  s_waitcnt lgkmcnt(0)
  v_mfma_f32_32x32x16_bf16 v[52:67], v[200:203], v[100:103], v[148:163]
  ds_read_b128 v[224:227], v48 offset:14336
  ds_read_b128 v[228:231], v48 offset:15360
  ds_read_b128 v[208:211], v48 offset:20480
  ds_read_b128 v[212:215], v48 offset:21504
  v_exp_f32 v68, v68
  v_exp_f32 v69, v69
  v_exp_f32 v70, v70
  v_exp_f32 v71, v71
  v_mfma_f32_32x32x16_bf16 v[52:67], v[204:207], v[104:107], v[52:67]
  v_cvt_pk_bf16_f32 v192, v68, v69
  v_exp_f32 v72, v72
  v_exp_f32 v73, v73
  v_cvt_pk_bf16_f32 v193, v70, v71
  v_exp_f32 v74, v74
  v_exp_f32 v75, v75
  v_mfma_f32_32x32x16_bf16 v[168:183], v[216:219], v[184:187], v[168:183]
  v_cvt_pk_bf16_f32 v194, v72, v73
  v_exp_f32 v76, v76
  v_exp_f32 v77, v77
  v_cvt_pk_bf16_f32 v195, v74, v75
  v_exp_f32 v78, v78
  v_exp_f32 v79, v79
  v_cvt_pk_bf16_f32 v196, v76, v77
  v_mfma_f32_32x32x16_bf16 v[168:183], v[220:223], v[188:191], v[168:183]
  v_exp_f32 v80, v80
  v_exp_f32 v81, v81
  v_cvt_pk_bf16_f32 v197, v78, v79
  v_exp_f32 v82, v82
  v_exp_f32 v83, v83
  v_cvt_pk_bf16_f32 v198, v80, v81
  v_cvt_pk_bf16_f32 v199, v82, v83
  s_waitcnt lgkmcnt(0)
  v_mfma_f32_32x32x16_bf16 v[68:83], v[208:211], v[100:103], v[148:163]
  ds_read_b128 v[216:219], v48 offset:18432
  ds_read_b128 v[220:223], v48 offset:19456
  ds_read_b128 v[200:203], v48 offset:24576
  ds_read_b128 v[204:207], v48 offset:25600
  v_exp_f32 v52, v52
  v_exp_f32 v53, v53
  v_exp_f32 v54, v54
  v_exp_f32 v55, v55
  v_mfma_f32_32x32x16_bf16 v[68:83], v[212:215], v[104:107], v[68:83]
  v_cvt_pk_bf16_f32 v184, v52, v53
  v_exp_f32 v56, v56
  v_exp_f32 v57, v57
  v_cvt_pk_bf16_f32 v185, v54, v55
  v_exp_f32 v58, v58
  v_exp_f32 v59, v59
  v_cvt_pk_bf16_f32 v186, v56, v57
  v_mfma_f32_32x32x16_bf16 v[168:183], v[224:227], v[192:195], v[168:183]
  v_exp_f32 v60, v60
  s_add_u32 s69, s69, 4096
  buffer_load_dword v252, v251, s[20:23], s69 offen
  v_exp_f32 v61, v61
  v_cvt_pk_bf16_f32 v187, v58, v59
  v_exp_f32 v62, v62
  v_exp_f32 v63, v63
  v_mfma_f32_32x32x16_bf16 v[168:183], v[228:231], v[196:199], v[168:183]
  v_cvt_pk_bf16_f32 v188, v60, v61
  v_exp_f32 v64, v64
  v_exp_f32 v65, v65
  v_cvt_pk_bf16_f32 v189, v62, v63
  v_exp_f32 v66, v66
  v_exp_f32 v67, v67
  v_cvt_pk_bf16_f32 v190, v64, v65
  v_cvt_pk_bf16_f32 v191, v66, v67
  s_waitcnt lgkmcnt(0)
  v_mfma_f32_32x32x16_bf16 v[52:67], v[200:203], v[100:103], v[148:163]
  ds_read_b128 v[224:227], v48 offset:22528
  ds_read_b128 v[228:231], v48 offset:23552
  ds_read_b128 v[208:211], v48 offset:28672
  ds_read_b128 v[212:215], v48 offset:29696
  v_exp_f32 v68, v68
  v_exp_f32 v69, v69
  v_exp_f32 v70, v70
  v_exp_f32 v71, v71
  v_mfma_f32_32x32x16_bf16 v[52:67], v[204:207], v[104:107], v[52:67]
  v_cvt_pk_bf16_f32 v192, v68, v69
  v_exp_f32 v72, v72
  v_exp_f32 v73, v73
  v_cvt_pk_bf16_f32 v193, v70, v71
  v_exp_f32 v74, v74
  v_exp_f32 v75, v75
  v_mfma_f32_32x32x16_bf16 v[168:183], v[216:219], v[184:187], v[168:183]
  v_cvt_pk_bf16_f32 v194, v72, v73
  v_exp_f32 v76, v76
  v_exp_f32 v77, v77
  v_cvt_pk_bf16_f32 v195, v74, v75
  v_exp_f32 v78, v78
  v_exp_f32 v79, v79
  v_cvt_pk_bf16_f32 v196, v76, v77
  v_mfma_f32_32x32x16_bf16 v[168:183], v[220:223], v[188:191], v[168:183]
  v_exp_f32 v80, v80
  v_exp_f32 v81, v81
  v_cvt_pk_bf16_f32 v197, v78, v79
  v_exp_f32 v82, v82
  v_exp_f32 v83, v83
  v_cvt_pk_bf16_f32 v198, v80, v81
  v_cvt_pk_bf16_f32 v199, v82, v83
  s_waitcnt lgkmcnt(0)
  v_mfma_f32_32x32x16_bf16 v[68:83], v[208:211], v[100:103], v[148:163]
  ds_read_b128 v[216:219], v48 offset:26624
  ds_read_b128 v[220:223], v48 offset:27648
  ds_read_b128 v[200:203], v48 offset:32768
  ds_read_b128 v[204:207], v48 offset:33792
  v_exp_f32 v52, v52
  v_exp_f32 v53, v53
  v_exp_f32 v54, v54
  v_exp_f32 v55, v55
  v_mfma_f32_32x32x16_bf16 v[68:83], v[212:215], v[104:107], v[68:83]
  v_cvt_pk_bf16_f32 v184, v52, v53
  v_exp_f32 v56, v56
  v_exp_f32 v57, v57
  v_cvt_pk_bf16_f32 v185, v54, v55
  v_exp_f32 v58, v58
  v_exp_f32 v59, v59
  v_mfma_f32_32x32x16_bf16 v[168:183], v[224:227], v[192:195], v[168:183]
  v_cvt_pk_bf16_f32 v186, v56, v57
  v_exp_f32 v60, v60
  v_exp_f32 v61, v61
  v_cvt_pk_bf16_f32 v187, v58, v59
  v_exp_f32 v62, v62
  v_exp_f32 v63, v63
  v_cvt_pk_bf16_f32 v188, v60, v61
  v_mfma_f32_32x32x16_bf16 v[168:183], v[228:231], v[196:199], v[168:183]
  v_exp_f32 v64, v64
  v_exp_f32 v65, v65
  v_cvt_pk_bf16_f32 v189, v62, v63
  v_exp_f32 v66, v66
  v_exp_f32 v67, v67
  v_cvt_pk_bf16_f32 v190, v64, v65
  v_cvt_pk_bf16_f32 v191, v66, v67
  s_waitcnt lgkmcnt(0)
  v_mfma_f32_32x32x16_bf16 v[52:67], v[200:203], v[100:103], v[108:123]
  ds_read_b128 v[224:227], v48 offset:30720
  ds_read_b128 v[228:231], v48 offset:31744
  v_exp_f32 v68, v68
  v_exp_f32 v69, v69
  v_exp_f32 v70, v70
  v_exp_f32 v71, v71
  v_cvt_pk_bf16_f32 v192, v68, v69
  v_mfma_f32_32x32x16_bf16 v[52:67], v[204:207], v[104:107], v[52:67]
  v_exp_f32 v72, v72
  v_exp_f32 v73, v73
  v_cvt_pk_bf16_f32 v193, v70, v71
  v_exp_f32 v74, v74
  v_exp_f32 v75, v75
  v_cvt_pk_bf16_f32 v194, v72, v73
  v_mfma_f32_32x32x16_bf16 v[168:183], v[216:219], v[184:187], v[168:183]
  v_exp_f32 v76, v76
  v_exp_f32 v77, v77
  v_cvt_pk_bf16_f32 v195, v74, v75
  v_exp_f32 v78, v78
  v_exp_f32 v79, v79
  v_cvt_pk_bf16_f32 v196, v76, v77
  v_mfma_f32_32x32x16_bf16 v[168:183], v[220:223], v[188:191], v[168:183]
  v_exp_f32 v80, v80
  v_exp_f32 v81, v81
  v_cvt_pk_bf16_f32 v197, v78, v79
  v_exp_f32 v82, v82
  v_exp_f32 v83, v83
  v_cvt_pk_bf16_f32 v198, v80, v81
  v_cvt_pk_bf16_f32 v199, v82, v83
  s_waitcnt lgkmcnt(0)
  v_mfma_f32_32x32x16_bf16 v[168:183], v[224:227], v[192:195], v[168:183]
  ds_read_b128 v[216:219], v48 offset:34816
  ds_read_b128 v[220:223], v48 offset:35840
  v_exp_f32 v52, v52
  v_exp_f32 v53, v53
  v_exp_f32 v54, v54
  v_exp_f32 v55, v55
  v_cvt_pk_bf16_f32 v184, v52, v53
  v_exp_f32 v56, v56
  v_exp_f32 v57, v57
  v_cvt_pk_bf16_f32 v185, v54, v55
  v_exp_f32 v58, v58
  v_exp_f32 v59, v59
  v_cvt_pk_bf16_f32 v186, v56, v57
  v_mfma_f32_32x32x16_bf16 v[168:183], v[228:231], v[196:199], v[168:183]
  v_exp_f32 v60, v60
  v_exp_f32 v61, v61
  v_cvt_pk_bf16_f32 v187, v58, v59
  v_exp_f32 v62, v62
  v_exp_f32 v63, v63
  v_cvt_pk_bf16_f32 v188, v60, v61
  v_exp_f32 v64, v64
  v_exp_f32 v65, v65
  v_cvt_pk_bf16_f32 v189, v62, v63
  v_exp_f32 v66, v66
  v_exp_f32 v67, v67
  v_cvt_pk_bf16_f32 v190, v64, v65
  v_cvt_pk_bf16_f32 v191, v66, v67
  s_waitcnt lgkmcnt(0)
  v_mfma_f32_32x32x16_bf16 v[168:183], v[216:219], v[184:187], v[168:183]
  v_mfma_f32_32x32x16_bf16 v[168:183], v[220:223], v[188:191], v[168:183]
  s_branch L_ajn_8
L_abr_7:
  ds_read_b128 v[200:203], v48 offset:0
  ds_read_b128 v[204:207], v48 offset:1024
  ds_read_b128 v[208:211], v48 offset:4096
  ds_read_b128 v[212:215], v48 offset:5120
  s_waitcnt lgkmcnt(2)
  s_cmp_gt_u32 s60, 0
  s_cbranch_scc1 L_m_9
  v_mfma_f32_32x32x16_bf16 v[52:67], v[200:203], v[100:103], v[132:147]
  s_branch L_m_10
L_m_9:
  v_mfma_f32_32x32x16_bf16 v[52:67], v[200:203], v[100:103], v[232:247]
L_m_10:
  v_mfma_f32_32x32x16_bf16 v[52:67], v[204:207], v[104:107], v[52:67]
  s_waitcnt lgkmcnt(0)
  s_cmp_gt_u32 s60, 1
  s_cbranch_scc1 L_m_11
  v_mfma_f32_32x32x16_bf16 v[68:83], v[208:211], v[100:103], 0
  s_branch L_m_12
L_m_11:
  v_mfma_f32_32x32x16_bf16 v[68:83], v[208:211], v[100:103], v[232:247]
L_m_12:
  ds_read_b128 v[200:203], v48 offset:8192
  ds_read_b128 v[204:207], v48 offset:9216
  s_lshl_b32 s69, s47, 2
  s_add_u32 s69, s69, s45
  s_mul_i32 s69, s69, 3136
  v_lshlrev_b32 v251, 6, v1
  buffer_load_dword v252, v251, s[16:19], s69 offen
  s_nop 0
  v_max3_f32 v50, v52, v53, v50
  v_max3_f32 v51, v54, v55, v51
  v_mfma_f32_32x32x16_bf16 v[68:83], v[212:215], v[104:107], v[68:83]
  v_max3_f32 v50, v56, v57, v50
  v_max3_f32 v51, v58, v59, v51
  v_max3_f32 v50, v60, v61, v50
  v_max3_f32 v51, v62, v63, v51
  v_max3_f32 v50, v64, v65, v50
  v_max3_f32 v51, v66, v67, v51
  s_waitcnt lgkmcnt(0)
  s_cmp_gt_u32 s60, 2
  s_cbranch_scc1 L_m_13
  v_mfma_f32_32x32x16_bf16 v[52:67], v[200:203], v[100:103], 0
  s_branch L_m_14
L_m_13:
  v_mfma_f32_32x32x16_bf16 v[52:67], v[200:203], v[100:103], v[232:247]
L_m_14:
  ds_read_b128 v[208:211], v48 offset:12288
  ds_read_b128 v[212:215], v48 offset:13312
  v_max3_f32 v50, v68, v69, v50
  v_max3_f32 v51, v70, v71, v51
  v_max3_f32 v50, v72, v73, v50
  v_mfma_f32_32x32x16_bf16 v[52:67], v[204:207], v[104:107], v[52:67]
  v_max3_f32 v51, v74, v75, v51
  v_max3_f32 v50, v76, v77, v50
  v_max3_f32 v51, v78, v79, v51
  v_max3_f32 v50, v80, v81, v50
  v_max3_f32 v51, v82, v83, v51
  s_waitcnt lgkmcnt(0)
  s_cmp_gt_u32 s60, 3
  s_cbranch_scc1 L_m_15
  v_mfma_f32_32x32x16_bf16 v[68:83], v[208:211], v[100:103], 0
  s_branch L_m_16
L_m_15:
  v_mfma_f32_32x32x16_bf16 v[68:83], v[208:211], v[100:103], v[232:247]
L_m_16:
  ds_read_b128 v[200:203], v48 offset:16384
  ds_read_b128 v[204:207], v48 offset:17408
  s_nop 0
  v_max3_f32 v50, v52, v53, v50
  v_max3_f32 v51, v54, v55, v51
  v_max3_f32 v50, v56, v57, v50
  v_mfma_f32_32x32x16_bf16 v[68:83], v[212:215], v[104:107], v[68:83]
  v_max3_f32 v51, v58, v59, v51
  v_max3_f32 v50, v60, v61, v50
  v_max3_f32 v51, v62, v63, v51
  v_max3_f32 v50, v64, v65, v50
  v_max3_f32 v51, v66, v67, v51
  s_waitcnt lgkmcnt(0)
  s_cmp_gt_u32 s60, 4
  s_cbranch_scc1 L_m_17
  v_mfma_f32_32x32x16_bf16 v[52:67], v[200:203], v[100:103], 0
  s_branch L_m_18
L_m_17:
  v_mfma_f32_32x32x16_bf16 v[52:67], v[200:203], v[100:103], v[232:247]
L_m_18:
  ds_read_b128 v[208:211], v48 offset:20480
  ds_read_b128 v[212:215], v48 offset:21504
  s_nop 0
  v_max3_f32 v50, v68, v69, v50
  v_max3_f32 v51, v70, v71, v51
  v_max3_f32 v50, v72, v73, v50
  v_mfma_f32_32x32x16_bf16 v[52:67], v[204:207], v[104:107], v[52:67]
  v_max3_f32 v51, v74, v75, v51
  v_max3_f32 v50, v76, v77, v50
  v_max3_f32 v51, v78, v79, v51
  v_max3_f32 v50, v80, v81, v50
  v_max3_f32 v51, v82, v83, v51
  s_waitcnt lgkmcnt(0)
  s_cmp_gt_u32 s60, 5
  s_cbranch_scc1 L_m_19
  v_mfma_f32_32x32x16_bf16 v[68:83], v[208:211], v[100:103], 0
  s_branch L_m_20
L_m_19:
  v_mfma_f32_32x32x16_bf16 v[68:83], v[208:211], v[100:103], v[232:247]
L_m_20:
  ds_read_b128 v[200:203], v48 offset:24576
  ds_read_b128 v[204:207], v48 offset:25600
  s_lshl_b32 s69, s47, 2
  s_add_u32 s69, s69, s45
  s_mul_i32 s69, s69, 12544
  v_lshlrev_b32 v251, 6, v1
  buffer_load_dword v252, v251, s[20:23], s69 offen
  v_max3_f32 v50, v52, v53, v50
  v_max3_f32 v51, v54, v55, v51
  v_mfma_f32_32x32x16_bf16 v[68:83], v[212:215], v[104:107], v[68:83]
  v_max3_f32 v50, v56, v57, v50
  v_max3_f32 v51, v58, v59, v51
  v_max3_f32 v50, v60, v61, v50
  v_max3_f32 v51, v62, v63, v51
  v_max3_f32 v50, v64, v65, v50
  v_max3_f32 v51, v66, v67, v51
  s_waitcnt lgkmcnt(0)
  s_cmp_gt_u32 s60, 6
  s_cbranch_scc1 L_m_21
  v_mfma_f32_32x32x16_bf16 v[52:67], v[200:203], v[100:103], 0
  s_branch L_m_22
L_m_21:
  v_mfma_f32_32x32x16_bf16 v[52:67], v[200:203], v[100:103], v[232:247]
L_m_22:
  ds_read_b128 v[208:211], v48 offset:28672
  ds_read_b128 v[212:215], v48 offset:29696
  v_max3_f32 v50, v68, v69, v50
  v_max3_f32 v51, v70, v71, v51
  v_max3_f32 v50, v72, v73, v50
  v_mfma_f32_32x32x16_bf16 v[52:67], v[204:207], v[104:107], v[52:67]
  v_max3_f32 v51, v74, v75, v51
  v_max3_f32 v50, v76, v77, v50
  v_max3_f32 v51, v78, v79, v51
  v_max3_f32 v50, v80, v81, v50
  v_max3_f32 v51, v82, v83, v51
  s_waitcnt lgkmcnt(0)
  s_cmp_gt_u32 s60, 7
  s_cbranch_scc1 L_m_23
  v_mfma_f32_32x32x16_bf16 v[68:83], v[208:211], v[100:103], 0
  s_branch L_m_24
L_m_23:
  v_mfma_f32_32x32x16_bf16 v[68:83], v[208:211], v[100:103], v[232:247]
L_m_24:
  ds_read_b128 v[200:203], v48 offset:32768
  ds_read_b128 v[204:207], v48 offset:33792
  s_nop 0
  v_max3_f32 v50, v52, v53, v50
  v_max3_f32 v51, v54, v55, v51
  v_max3_f32 v50, v56, v57, v50
  v_mfma_f32_32x32x16_bf16 v[68:83], v[212:215], v[104:107], v[68:83]
  v_max3_f32 v51, v58, v59, v51
  v_max3_f32 v50, v60, v61, v50
  v_max3_f32 v51, v62, v63, v51
  v_max3_f32 v50, v64, v65, v50
  v_max3_f32 v51, v66, v67, v51
  s_waitcnt lgkmcnt(0)
  v_mfma_f32_32x32x16_bf16 v[52:67], v[200:203], v[100:103], v[108:123]
  s_nop 4
  v_max3_f32 v50, v68, v69, v50
  v_max3_f32 v51, v70, v71, v51
  v_max3_f32 v50, v72, v73, v50
  v_max3_f32 v51, v74, v75, v51
  v_mfma_f32_32x32x16_bf16 v[52:67], v[204:207], v[104:107], v[52:67]
  v_max3_f32 v50, v76, v77, v50
  v_max3_f32 v51, v78, v79, v51
  v_max3_f32 v50, v80, v81, v50
  v_max3_f32 v51, v82, v83, v51
  s_nop 7
  v_max3_f32 v50, v52, v53, v50
  v_max3_f32 v51, v54, v55, v51
  v_max3_f32 v50, v56, v57, v50
  v_max3_f32 v51, v58, v59, v51
  v_max3_f32 v50, v60, v61, v50
  v_max3_f32 v51, v62, v63, v51
  v_max3_f32 v50, v64, v65, v50
  v_max3_f32 v51, v66, v67, v51
  v_max_f32 v50, v50, v51
  v_mov_b32 v38, v50
  s_nop 1
  v_permlane32_swap_b32 v50, v38
  v_max_f32 v50, v50, v38
  v_sub_f32 v148, 0, v50
  v_sub_f32 v149, 0, v50
  v_sub_f32 v150, 0, v50
  v_sub_f32 v151, 0, v50
  v_sub_f32 v152, 0, v50
  v_sub_f32 v153, 0, v50
  v_sub_f32 v154, 0, v50
  v_sub_f32 v155, 0, v50
  v_sub_f32 v156, 0, v50
  v_sub_f32 v157, 0, v50
  v_sub_f32 v158, 0, v50
  v_sub_f32 v159, 0, v50
  v_sub_f32 v160, 0, v50
  v_sub_f32 v161, 0, v50
  v_sub_f32 v162, 0, v50
  v_sub_f32 v163, 0, v50
  v_pk_add_f32 v[108:109], v[108:109], v[148:149]
  v_pk_add_f32 v[132:133], v[132:133], v[148:149]
  v_pk_add_f32 v[110:111], v[110:111], v[148:149]
  v_pk_add_f32 v[134:135], v[134:135], v[148:149]
  v_pk_add_f32 v[112:113], v[112:113], v[148:149]
  v_pk_add_f32 v[136:137], v[136:137], v[148:149]
  v_pk_add_f32 v[114:115], v[114:115], v[148:149]
  v_pk_add_f32 v[138:139], v[138:139], v[148:149]
  v_pk_add_f32 v[116:117], v[116:117], v[148:149]
  v_pk_add_f32 v[140:141], v[140:141], v[148:149]
  v_pk_add_f32 v[118:119], v[118:119], v[148:149]
  v_pk_add_f32 v[142:143], v[142:143], v[148:149]
  v_pk_add_f32 v[120:121], v[120:121], v[148:149]
  v_pk_add_f32 v[144:145], v[144:145], v[148:149]
  v_pk_add_f32 v[122:123], v[122:123], v[148:149]
  v_pk_add_f32 v[146:147], v[146:147], v[148:149]
  ds_read_b128 v[200:203], v48 offset:0
  ds_read_b128 v[204:207], v48 offset:1024
  ds_read_b128 v[208:211], v48 offset:4096
  ds_read_b128 v[212:215], v48 offset:5120
  s_waitcnt lgkmcnt(2)
  s_cmp_gt_u32 s60, 0
  s_cbranch_scc1 L_m_25
  v_mfma_f32_32x32x16_bf16 v[52:67], v[200:203], v[100:103], v[132:147]
  s_branch L_m_26
L_m_25:
  v_mfma_f32_32x32x16_bf16 v[52:67], v[200:203], v[100:103], v[232:247]
L_m_26:
  v_mfma_f32_32x32x16_bf16 v[52:67], v[204:207], v[104:107], v[52:67]
  s_waitcnt lgkmcnt(0)
  s_cmp_gt_u32 s60, 1
  s_cbranch_scc1 L_m_27
  v_mfma_f32_32x32x16_bf16 v[68:83], v[208:211], v[100:103], v[148:163]
  s_branch L_m_28
L_m_27:
  v_mfma_f32_32x32x16_bf16 v[68:83], v[208:211], v[100:103], v[232:247]
L_m_28:
  ds_read_b128 v[216:219], v48 offset:2048
  ds_read_b128 v[220:223], v48 offset:3072
  ds_read_b128 v[200:203], v48 offset:8192
  ds_read_b128 v[204:207], v48 offset:9216
  s_nop 3
  v_exp_f32 v52, v52
  v_exp_f32 v53, v53
  v_exp_f32 v54, v54
  v_exp_f32 v55, v55
  v_cvt_pk_bf16_f32 v184, v52, v53
  v_exp_f32 v56, v56
  v_exp_f32 v57, v57
  v_cvt_pk_bf16_f32 v185, v54, v55
  v_exp_f32 v58, v58
  v_exp_f32 v59, v59
  v_cvt_pk_bf16_f32 v186, v56, v57
  v_mfma_f32_32x32x16_bf16 v[68:83], v[212:215], v[104:107], v[68:83]
  v_exp_f32 v60, v60
  s_add_u32 s69, s69, 4096
  buffer_load_dword v252, v251, s[20:23], s69 offen
  v_exp_f32 v61, v61
  v_cvt_pk_bf16_f32 v187, v58, v59
  v_exp_f32 v62, v62
  v_exp_f32 v63, v63
  v_cvt_pk_bf16_f32 v188, v60, v61
  v_exp_f32 v64, v64
  v_exp_f32 v65, v65
  v_cvt_pk_bf16_f32 v189, v62, v63
  v_exp_f32 v66, v66
  v_exp_f32 v67, v67
  v_cvt_pk_bf16_f32 v190, v64, v65
  v_cvt_pk_bf16_f32 v191, v66, v67
  s_waitcnt lgkmcnt(0)
  s_cmp_gt_u32 s60, 2
  s_cbranch_scc1 L_m_29
  v_mfma_f32_32x32x16_bf16 v[52:67], v[200:203], v[100:103], v[148:163]
  s_branch L_m_30
L_m_29:
  v_mfma_f32_32x32x16_bf16 v[52:67], v[200:203], v[100:103], v[232:247]
L_m_30:
  ds_read_b128 v[224:227], v48 offset:6144
  ds_read_b128 v[228:231], v48 offset:7168
  ds_read_b128 v[208:211], v48 offset:12288
  ds_read_b128 v[212:215], v48 offset:13312
  v_exp_f32 v68, v68
  v_exp_f32 v69, v69
  v_exp_f32 v70, v70
  v_exp_f32 v71, v71
  v_mfma_f32_32x32x16_bf16 v[52:67], v[204:207], v[104:107], v[52:67]
  v_cvt_pk_bf16_f32 v192, v68, v69
  v_exp_f32 v72, v72
  v_exp_f32 v73, v73
  v_cvt_pk_bf16_f32 v193, v70, v71
  v_exp_f32 v74, v74
  v_exp_f32 v75, v75
  v_mfma_f32_32x32x16_bf16 v[168:183], v[216:219], v[184:187], 0
  v_cvt_pk_bf16_f32 v194, v72, v73
  v_exp_f32 v76, v76
  v_exp_f32 v77, v77
  v_cvt_pk_bf16_f32 v195, v74, v75
  v_exp_f32 v78, v78
  v_exp_f32 v79, v79
  v_cvt_pk_bf16_f32 v196, v76, v77
  v_mfma_f32_32x32x16_bf16 v[168:183], v[220:223], v[188:191], v[168:183]
  v_exp_f32 v80, v80
  v_exp_f32 v81, v81
  v_cvt_pk_bf16_f32 v197, v78, v79
  v_exp_f32 v82, v82
  v_exp_f32 v83, v83
  v_cvt_pk_bf16_f32 v198, v80, v81
  v_cvt_pk_bf16_f32 v199, v82, v83
  s_waitcnt lgkmcnt(0)
  s_cmp_gt_u32 s60, 3
  s_cbranch_scc1 L_m_31
  v_mfma_f32_32x32x16_bf16 v[68:83], v[208:211], v[100:103], v[148:163]
  s_branch L_m_32
L_m_31:
  v_mfma_f32_32x32x16_bf16 v[68:83], v[208:211], v[100:103], v[232:247]
L_m_32:
  ds_read_b128 v[216:219], v48 offset:10240
  ds_read_b128 v[220:223], v48 offset:11264
  ds_read_b128 v[200:203], v48 offset:16384
  ds_read_b128 v[204:207], v48 offset:17408
  v_exp_f32 v52, v52
  v_exp_f32 v53, v53
  v_exp_f32 v54, v54
  v_exp_f32 v55, v55
  v_mfma_f32_32x32x16_bf16 v[68:83], v[212:215], v[104:107], v[68:83]
  v_cvt_pk_bf16_f32 v184, v52, v53
  v_exp_f32 v56, v56
  v_exp_f32 v57, v57
  v_cvt_pk_bf16_f32 v185, v54, v55
  v_exp_f32 v58, v58
  v_exp_f32 v59, v59
  v_cvt_pk_bf16_f32 v186, v56, v57
  v_mfma_f32_32x32x16_bf16 v[168:183], v[224:227], v[192:195], v[168:183]
  v_exp_f32 v60, v60
  s_add_u32 s69, s69, 4096
  buffer_load_dword v252, v251, s[20:23], s69 offen
  v_exp_f32 v61, v61
  v_cvt_pk_bf16_f32 v187, v58, v59
  v_exp_f32 v62, v62
  v_exp_f32 v63, v63
  v_mfma_f32_32x32x16_bf16 v[168:183], v[228:231], v[196:199], v[168:183]
  v_cvt_pk_bf16_f32 v188, v60, v61
  v_exp_f32 v64, v64
  v_exp_f32 v65, v65
  v_cvt_pk_bf16_f32 v189, v62, v63
  v_exp_f32 v66, v66
  v_exp_f32 v67, v67
  v_cvt_pk_bf16_f32 v190, v64, v65
  v_cvt_pk_bf16_f32 v191, v66, v67
  s_waitcnt lgkmcnt(0)
  s_cmp_gt_u32 s60, 4
  s_cbranch_scc1 L_m_33
  v_mfma_f32_32x32x16_bf16 v[52:67], v[200:203], v[100:103], v[148:163]
  s_branch L_m_34
L_m_33:
  v_mfma_f32_32x32x16_bf16 v[52:67], v[200:203], v[100:103], v[232:247]
L_m_34:
  ds_read_b128 v[224:227], v48 offset:14336
  ds_read_b128 v[228:231], v48 offset:15360
  ds_read_b128 v[208:211], v48 offset:20480
  ds_read_b128 v[212:215], v48 offset:21504
  v_exp_f32 v68, v68
  v_exp_f32 v69, v69
  v_exp_f32 v70, v70
  v_exp_f32 v71, v71
  v_mfma_f32_32x32x16_bf16 v[52:67], v[204:207], v[104:107], v[52:67]
  v_cvt_pk_bf16_f32 v192, v68, v69
  v_exp_f32 v72, v72
  v_exp_f32 v73, v73
  v_cvt_pk_bf16_f32 v193, v70, v71
  v_exp_f32 v74, v74
  v_exp_f32 v75, v75
  v_mfma_f32_32x32x16_bf16 v[168:183], v[216:219], v[184:187], v[168:183]
  v_cvt_pk_bf16_f32 v194, v72, v73
  v_exp_f32 v76, v76
  v_exp_f32 v77, v77
  v_cvt_pk_bf16_f32 v195, v74, v75
  v_exp_f32 v78, v78
  v_exp_f32 v79, v79
  v_cvt_pk_bf16_f32 v196, v76, v77
  v_mfma_f32_32x32x16_bf16 v[168:183], v[220:223], v[188:191], v[168:183]
  v_exp_f32 v80, v80
  v_exp_f32 v81, v81
  v_cvt_pk_bf16_f32 v197, v78, v79
  v_exp_f32 v82, v82
  v_exp_f32 v83, v83
  v_cvt_pk_bf16_f32 v198, v80, v81
  v_cvt_pk_bf16_f32 v199, v82, v83
  s_waitcnt lgkmcnt(0)
  s_cmp_gt_u32 s60, 5
  s_cbranch_scc1 L_m_35
  v_mfma_f32_32x32x16_bf16 v[68:83], v[208:211], v[100:103], v[148:163]
  s_branch L_m_36
L_m_35:
  v_mfma_f32_32x32x16_bf16 v[68:83], v[208:211], v[100:103], v[232:247]
L_m_36:
  ds_read_b128 v[216:219], v48 offset:18432
  ds_read_b128 v[220:223], v48 offset:19456
  ds_read_b128 v[200:203], v48 offset:24576
  ds_read_b128 v[204:207], v48 offset:25600
  v_exp_f32 v52, v52
  v_exp_f32 v53, v53
  v_exp_f32 v54, v54
  v_exp_f32 v55, v55
  v_mfma_f32_32x32x16_bf16 v[68:83], v[212:215], v[104:107], v[68:83]
  v_cvt_pk_bf16_f32 v184, v52, v53
  v_exp_f32 v56, v56
  v_exp_f32 v57, v57
  v_cvt_pk_bf16_f32 v185, v54, v55
  v_exp_f32 v58, v58
  v_exp_f32 v59, v59
  v_cvt_pk_bf16_f32 v186, v56, v57
  v_mfma_f32_32x32x16_bf16 v[168:183], v[224:227], v[192:195], v[168:183]
  v_exp_f32 v60, v60
  s_add_u32 s69, s69, 4096
  buffer_load_dword v252, v251, s[20:23], s69 offen
  v_exp_f32 v61, v61
  v_cvt_pk_bf16_f32 v187, v58, v59
  v_exp_f32 v62, v62
  v_exp_f32 v63, v63
  v_mfma_f32_32x32x16_bf16 v[168:183], v[228:231], v[196:199], v[168:183]
  v_cvt_pk_bf16_f32 v188, v60, v61
  v_exp_f32 v64, v64
  v_exp_f32 v65, v65
  v_cvt_pk_bf16_f32 v189, v62, v63
  v_exp_f32 v66, v66
  v_exp_f32 v67, v67
  v_cvt_pk_bf16_f32 v190, v64, v65
  v_cvt_pk_bf16_f32 v191, v66, v67
  s_waitcnt lgkmcnt(0)
  s_cmp_gt_u32 s60, 6
  s_cbranch_scc1 L_m_37
  v_mfma_f32_32x32x16_bf16 v[52:67], v[200:203], v[100:103], v[148:163]
  s_branch L_m_38
L_m_37:
  v_mfma_f32_32x32x16_bf16 v[52:67], v[200:203], v[100:103], v[232:247]
L_m_38:
  ds_read_b128 v[224:227], v48 offset:22528
  ds_read_b128 v[228:231], v48 offset:23552
  ds_read_b128 v[208:211], v48 offset:28672
  ds_read_b128 v[212:215], v48 offset:29696
  v_exp_f32 v68, v68
  v_exp_f32 v69, v69
  v_exp_f32 v70, v70
  v_exp_f32 v71, v71
  v_mfma_f32_32x32x16_bf16 v[52:67], v[204:207], v[104:107], v[52:67]
  v_cvt_pk_bf16_f32 v192, v68, v69
  v_exp_f32 v72, v72
  v_exp_f32 v73, v73
  v_cvt_pk_bf16_f32 v193, v70, v71
  v_exp_f32 v74, v74
  v_exp_f32 v75, v75
  v_mfma_f32_32x32x16_bf16 v[168:183], v[216:219], v[184:187], v[168:183]
  v_cvt_pk_bf16_f32 v194, v72, v73
  v_exp_f32 v76, v76
  v_exp_f32 v77, v77
  v_cvt_pk_bf16_f32 v195, v74, v75
  v_exp_f32 v78, v78
  v_exp_f32 v79, v79
  v_cvt_pk_bf16_f32 v196, v76, v77
  v_mfma_f32_32x32x16_bf16 v[168:183], v[220:223], v[188:191], v[168:183]
  v_exp_f32 v80, v80
  v_exp_f32 v81, v81
  v_cvt_pk_bf16_f32 v197, v78, v79
  v_exp_f32 v82, v82
  v_exp_f32 v83, v83
  v_cvt_pk_bf16_f32 v198, v80, v81
  v_cvt_pk_bf16_f32 v199, v82, v83
  s_waitcnt lgkmcnt(0)
  s_cmp_gt_u32 s60, 7
  s_cbranch_scc1 L_m_39
  v_mfma_f32_32x32x16_bf16 v[68:83], v[208:211], v[100:103], v[148:163]
  s_branch L_m_40
L_m_39:
  v_mfma_f32_32x32x16_bf16 v[68:83], v[208:211], v[100:103], v[232:247]
L_m_40:
  ds_read_b128 v[216:219], v48 offset:26624
  ds_read_b128 v[220:223], v48 offset:27648
  ds_read_b128 v[200:203], v48 offset:32768
  ds_read_b128 v[204:207], v48 offset:33792
  v_exp_f32 v52, v52
  v_exp_f32 v53, v53
  v_exp_f32 v54, v54
  v_exp_f32 v55, v55
  v_mfma_f32_32x32x16_bf16 v[68:83], v[212:215], v[104:107], v[68:83]
  v_cvt_pk_bf16_f32 v184, v52, v53
  v_exp_f32 v56, v56
  v_exp_f32 v57, v57
  v_cvt_pk_bf16_f32 v185, v54, v55
  v_exp_f32 v58, v58
  v_exp_f32 v59, v59
  v_mfma_f32_32x32x16_bf16 v[168:183], v[224:227], v[192:195], v[168:183]
  v_cvt_pk_bf16_f32 v186, v56, v57
  v_exp_f32 v60, v60
  v_exp_f32 v61, v61
  v_cvt_pk_bf16_f32 v187, v58, v59
  v_exp_f32 v62, v62
  v_exp_f32 v63, v63
  v_cvt_pk_bf16_f32 v188, v60, v61
  v_mfma_f32_32x32x16_bf16 v[168:183], v[228:231], v[196:199], v[168:183]
  v_exp_f32 v64, v64
  v_exp_f32 v65, v65
  v_cvt_pk_bf16_f32 v189, v62, v63
  v_exp_f32 v66, v66
  v_exp_f32 v67, v67
  v_cvt_pk_bf16_f32 v190, v64, v65
  v_cvt_pk_bf16_f32 v191, v66, v67
  s_waitcnt lgkmcnt(0)
  v_mfma_f32_32x32x16_bf16 v[52:67], v[200:203], v[100:103], v[108:123]
  ds_read_b128 v[224:227], v48 offset:30720
  ds_read_b128 v[228:231], v48 offset:31744
  v_exp_f32 v68, v68
  v_exp_f32 v69, v69
  v_exp_f32 v70, v70
  v_exp_f32 v71, v71
  v_cvt_pk_bf16_f32 v192, v68, v69
  v_mfma_f32_32x32x16_bf16 v[52:67], v[204:207], v[104:107], v[52:67]
  v_exp_f32 v72, v72
  v_exp_f32 v73, v73
  v_cvt_pk_bf16_f32 v193, v70, v71
  v_exp_f32 v74, v74
  v_exp_f32 v75, v75
  v_cvt_pk_bf16_f32 v194, v72, v73
  v_mfma_f32_32x32x16_bf16 v[168:183], v[216:219], v[184:187], v[168:183]
  v_exp_f32 v76, v76
  v_exp_f32 v77, v77
  v_cvt_pk_bf16_f32 v195, v74, v75
  v_exp_f32 v78, v78
  v_exp_f32 v79, v79
  v_cvt_pk_bf16_f32 v196, v76, v77
  v_mfma_f32_32x32x16_bf16 v[168:183], v[220:223], v[188:191], v[168:183]
  v_exp_f32 v80, v80
  v_exp_f32 v81, v81
  v_cvt_pk_bf16_f32 v197, v78, v79
  v_exp_f32 v82, v82
  v_exp_f32 v83, v83
  v_cvt_pk_bf16_f32 v198, v80, v81
  v_cvt_pk_bf16_f32 v199, v82, v83
  s_waitcnt lgkmcnt(0)
  v_mfma_f32_32x32x16_bf16 v[168:183], v[224:227], v[192:195], v[168:183]
  ds_read_b128 v[216:219], v48 offset:34816
  ds_read_b128 v[220:223], v48 offset:35840
  v_exp_f32 v52, v52
  v_exp_f32 v53, v53
  v_exp_f32 v54, v54
  v_exp_f32 v55, v55
  v_cvt_pk_bf16_f32 v184, v52, v53
  v_exp_f32 v56, v56
  v_exp_f32 v57, v57
  v_cvt_pk_bf16_f32 v185, v54, v55
  v_exp_f32 v58, v58
  v_exp_f32 v59, v59
  v_cvt_pk_bf16_f32 v186, v56, v57
  v_mfma_f32_32x32x16_bf16 v[168:183], v[228:231], v[196:199], v[168:183]
  v_exp_f32 v60, v60
  v_exp_f32 v61, v61
  v_cvt_pk_bf16_f32 v187, v58, v59
  v_exp_f32 v62, v62
  v_exp_f32 v63, v63
  v_cvt_pk_bf16_f32 v188, v60, v61
  v_exp_f32 v64, v64
  v_exp_f32 v65, v65
  v_cvt_pk_bf16_f32 v189, v62, v63
  v_exp_f32 v66, v66
  v_exp_f32 v67, v67
  v_cvt_pk_bf16_f32 v190, v64, v65
  v_cvt_pk_bf16_f32 v191, v66, v67
  s_waitcnt lgkmcnt(0)
  v_mfma_f32_32x32x16_bf16 v[168:183], v[216:219], v[184:187], v[168:183]
  v_mfma_f32_32x32x16_bf16 v[168:183], v[220:223], v[188:191], v[168:183]
L_ajn_8:
  s_nop 11
  v_mov_b32 v38, v180
  v_mov_b32 v50, v180
  s_nop 1
  v_permlane32_swap_b32 v38, v50
  v_rcp_f32 v50, v50
  s_nop 0
  v_pk_mul_f32 v[168:169], v[168:169], v[50:51] op_sel_hi:[1,0]
  v_pk_mul_f32 v[170:171], v[170:171], v[50:51] op_sel_hi:[1,0]
  v_pk_mul_f32 v[172:173], v[172:173], v[50:51] op_sel_hi:[1,0]
  v_pk_mul_f32 v[174:175], v[174:175], v[50:51] op_sel_hi:[1,0]
  v_pk_mul_f32 v[176:177], v[176:177], v[50:51] op_sel_hi:[1,0]
  v_pk_mul_f32 v[178:179], v[178:179], v[50:51] op_sel_hi:[1,0]
  v_pk_mul_f32 v[180:181], v[180:181], v[50:51] op_sel_hi:[1,0]
  v_pk_mul_f32 v[182:183], v[182:183], v[50:51] op_sel_hi:[1,0]
  v_cvt_pk_bf16_f32 v184, v168, v169
  v_cvt_pk_bf16_f32 v185, v170, v171
  v_cvt_pk_bf16_f32 v186, v172, v173
  v_cvt_pk_bf16_f32 v187, v174, v175
  v_cvt_pk_bf16_f32 v188, v176, v177
  v_cvt_pk_bf16_f32 v189, v178, v179
  v_cvt_pk_bf16_f32 v190, v180, v181
  v_cvt_pk_bf16_f32 v191, v182, v183
  v_and_b32 v190, v190, v165
  v_and_b32 v191, v191, v165
  s_lshl_b32 s56, s58, 4
  s_add_u32 s56, s56, s49
  s_lshl_b32 s56, s56, 11
  s_add_u32 s56, s56, 5242880
  buffer_store_dwordx4 v[184:187], v2, s[40:43], s56 offen offset:0 sc1
  buffer_store_dwordx4 v[188:191], v2, s[40:43], s56 offen offset:1024 sc1
  s_lshl_b32 s59, s48, 7
  s_lshl_b32 s56, s49, 2
  s_add_u32 s59, s59, s56
  s_add_u32 s59, s59, 8192
  s_waitcnt vmcnt(0)
  s_barrier
  s_cmp_lg_u32 s45, 0
  s_cbranch_scc1 L_nf_41
  v_mov_b32 v5, s44
  v_mov_b32 v6, 0
  s_mov_b64 exec, 1
  buffer_store_dword v5, v6, s[40:43], s59 offen sc1
  s_mov_b64 exec, -1
L_nf_41:
  s_cmp_ge_u32 s47, 28
  s_cbranch_scc1 L_skipB
  s_mul_i32 s50, s47, 37
  s_lshr_b32 s50, s50, 8
  s_mul_i32 s51, s50, 7
  s_sub_u32 s49, s47, s51
  s_lshl_b32 s48, s46, 2
  s_add_u32 s48, s48, s50
  s_and_b32 s52, s45, 1
  s_lshl_b32 s50, s48, 1
  s_add_u32 s52, s52, s50
  s_lshr_b32 s53, s45, 1
  v_lshrrev_b32 v10, 3, v1
  v_mul_u32_u24 v10, 896, v10
  v_lshrrev_b32 v11, 4, v1
  v_and_b32 v11, 1, v11
  v_lshlrev_b32 v11, 2, v11
  v_and_b32 v12, 7, v1
  v_xor_b32 v12, v12, v11
  v_lshlrev_b32 v12, 4, v12
  v_add_u32 v14, v10, v12
  s_mov_b32 s54, 0
  s_lshl_b32 s55, s49, 7
  s_lshl_b32 s58, s52, 4
  s_mul_i32 s50, s53, 8
  s_add_u32 s58, s58, s50
  s_lshl_b32 s58, s58, 11
  s_add_u32 s58, s58, 5242880
  s_lshl_b32 s101, s49, 7
  s_mul_i32 s100, s45, 7168
  s_add_u32 s101, s101, s100
  s_lshl_b32 s100, s45, 10
  s_add_u32 m0, s100, 0
  s_add_u32 s98, s101, 0
  buffer_load_dwordx4 v14, s[16:19], s98 offen lds
  s_add_u32 m0, s100, 32768
  s_add_u32 s98, s101, 200704
  buffer_load_dwordx4 v14, s[16:19], s98 offen lds
  s_add_u32 m0, s100, 4096
  s_add_u32 s98, s101, 25088
  buffer_load_dwordx4 v14, s[16:19], s98 offen lds
  s_add_u32 m0, s100, 36864
  s_add_u32 s98, s101, 225792
  buffer_load_dwordx4 v14, s[16:19], s98 offen lds
  s_add_u32 m0, s100, 8192
  s_add_u32 s98, s101, 50176
  buffer_load_dwordx4 v14, s[16:19], s98 offen lds
  s_add_u32 m0, s100, 40960
  s_add_u32 s98, s101, 250880
  buffer_load_dwordx4 v14, s[16:19], s98 offen lds
  s_add_u32 m0, s100, 12288
  s_add_u32 s98, s101, 75264
  buffer_load_dwordx4 v14, s[16:19], s98 offen lds
  s_add_u32 m0, s100, 45056
  s_add_u32 s98, s101, 275968
  buffer_load_dwordx4 v14, s[16:19], s98 offen lds
  s_add_u32 m0, s100, 16384
  s_add_u32 s98, s101, 100352
  buffer_load_dwordx4 v14, s[16:19], s98 offen lds
  s_add_u32 m0, s100, 49152
  s_add_u32 s98, s101, 301056
  buffer_load_dwordx4 v14, s[16:19], s98 offen lds
  s_add_u32 m0, s100, 20480
  s_add_u32 s98, s101, 125440
  buffer_load_dwordx4 v14, s[16:19], s98 offen lds
  s_add_u32 m0, s100, 53248
  s_add_u32 s98, s101, 326144
  buffer_load_dwordx4 v14, s[16:19], s98 offen lds
  s_add_u32 m0, s100, 24576
  s_add_u32 s98, s101, 150528
  buffer_load_dwordx4 v14, s[16:19], s98 offen lds
  s_add_u32 m0, s100, 57344
  s_add_u32 s98, s101, 351232
  buffer_load_dwordx4 v14, s[16:19], s98 offen lds
  s_add_u32 m0, s100, 28672
  s_add_u32 s98, s101, 175616
  buffer_load_dwordx4 v14, s[16:19], s98 offen lds
  s_add_u32 m0, s100, 61440
  s_add_u32 s98, s101, 376320
  buffer_load_dwordx4 v14, s[16:19], s98 offen lds
  v_lshrrev_b32 v10, 3, v1
  v_mul_u32_u24 v10, 3584, v10
  v_lshrrev_b32 v11, 4, v1
  v_and_b32 v11, 1, v11
  v_lshlrev_b32 v11, 2, v11
  v_and_b32 v12, 7, v1
  v_xor_b32 v12, v12, v11
  v_lshlrev_b32 v12, 4, v12
  v_add_u32 v15, v10, v12
  s_cmp_ge_u32 s47, 14
  s_cselect_b32 s50, 14, 0
  s_sub_u32 s99, s47, s50
  v_mul_u32_u24 v13, 896, v3
  v_lshlrev_b32 v12, 3, v4
  v_add_u32 v13, v13, v12
  s_mul_i32 s54, s52, 28672
  s_lshl_b32 s50, s49, 7
  s_add_u32 s54, s54, s50
  s_lshl_b32 s50, s53, 6
  s_add_u32 s54, s54, s50
  buffer_load_dwordx2 v[16:17], v13, s[8:11], s54 offen offset:0
  buffer_load_dwordx2 v[18:19], v13, s[8:11], s54 offen offset:16
  buffer_load_dwordx2 v[20:21], v13, s[8:11], s54 offen offset:32
  buffer_load_dwordx2 v[22:23], v13, s[8:11], s54 offen offset:48
  s_mul_i32 s51, s53, 32768
  v_lshrrev_b32 v10, 2, v1
  v_and_b32 v10, 3, v10
  v_lshlrev_b32 v11, 2, v4
  v_add_u32 v11, v11, v10
  v_lshlrev_b32 v11, 7, v11
  v_lshrrev_b32 v12, 4, v1
  v_and_b32 v12, 1, v12
  v_lshlrev_b32 v12, 5, v12
  v_add_u32 v11, v11, v12
  v_and_b32 v12, 3, v1
  v_lshlrev_b32 v12, 3, v12
  v_add_u32 v11, v11, v12
  v_lshrrev_b32 v10, 1, v10
  v_lshlrev_b32 v10, 6, v10
  v_add_u32 v11, s51, v11
  v_add_u32 v24, v11, v10
  v_xor_b32 v10, 64, v10
  v_add_u32 v25, v11, v10
  s_lshr_b32 s55, s48, 1
  s_lshl_b32 s55, s55, 7
  s_add_u32 s55, s55, 8192
  v_min_u32 v9, 15, v1
  v_lshlrev_b32 v9, 2, v9
  s_cmp_lg_u32 s45, 0
  s_cbranch_scc1 L_po_44
  buffer_load_dword v5, v9, s[40:43], s55 offen sc1
  s_sleep 1
  buffer_load_dword v6, v9, s[40:43], s55 offen sc1
  s_sleep 1
  buffer_load_dword v7, v9, s[40:43], s55 offen sc1
  s_sleep 1
  buffer_load_dword v8, v9, s[40:43], s55 offen sc1
  s_mov_b32 s70, 0
L_poll_42:
  s_waitcnt vmcnt(3)
  v_cmp_ne_u32 vcc, s44, v5
  s_cbranch_vccz L_pd_43
  buffer_load_dword v5, v9, s[40:43], s55 offen sc1
  s_waitcnt vmcnt(3)
  v_cmp_ne_u32 vcc, s44, v6
  s_cbranch_vccz L_pd_43
  buffer_load_dword v6, v9, s[40:43], s55 offen sc1
  s_waitcnt vmcnt(3)
  v_cmp_ne_u32 vcc, s44, v7
  s_cbranch_vccz L_pd_43
  buffer_load_dword v7, v9, s[40:43], s55 offen sc1
  s_waitcnt vmcnt(3)
  v_cmp_ne_u32 vcc, s44, v8
  s_cbranch_vccz L_pd_43
  buffer_load_dword v8, v9, s[40:43], s55 offen sc1
  s_add_u32 s70, s70, 1
  s_cmp_lt_u32 s70, 20000
  s_cbranch_scc1 L_poll_42
  s_branch L_pd_43
L_po_44:
L_pd_43:
  s_barrier
  s_mov_b32 s54, 0
  s_cmp_ge_u32 s54, 8
  s_cselect_b32 s50, 8, 0
  s_sub_u32 s54, s54, s50
  s_lshl_b32 s59, s54, 11
  s_add_u32 s59, s59, s58
  s_add_u32 s54, s54, 1
  buffer_load_dwordx4 v[28:31], v2, s[40:43], s59 offen offset:0 sc1
  buffer_load_dwordx4 v[32:35], v2, s[40:43], s59 offen offset:1024 sc1
  s_cmp_ge_u32 s54, 8
  s_cselect_b32 s50, 8, 0
  s_sub_u32 s54, s54, s50
  s_lshl_b32 s59, s54, 11
  s_add_u32 s59, s59, s58
  s_add_u32 s54, s54, 1
  buffer_load_dwordx4 v[36:39], v2, s[40:43], s59 offen offset:0 sc1
  buffer_load_dwordx4 v[40:43], v2, s[40:43], s59 offen offset:1024 sc1
  s_cmp_ge_u32 s54, 8
  s_cselect_b32 s50, 8, 0
  s_sub_u32 s54, s54, s50
  s_lshl_b32 s59, s54, 11
  s_add_u32 s59, s59, s58
  s_add_u32 s54, s54, 1
  buffer_load_dwordx4 v[44:47], v2, s[40:43], s59 offen offset:0 sc1
  buffer_load_dwordx4 v[48:51], v2, s[40:43], s59 offen offset:1024 sc1
  s_waitcnt vmcnt(10)
  s_barrier
  ds_read_b64_tr_b16 v[124:125], v24 offset:0
  ds_read_b64_tr_b16 v[126:127], v24 offset:1024
  ds_read_b64_tr_b16 v[128:129], v25 offset:0
  ds_read_b64_tr_b16 v[130:131], v25 offset:1024
  ds_read_b64_tr_b16 v[132:133], v24 offset:2048
  ds_read_b64_tr_b16 v[134:135], v24 offset:3072
  ds_read_b64_tr_b16 v[136:137], v25 offset:2048
  ds_read_b64_tr_b16 v[138:139], v25 offset:3072
  s_waitcnt lgkmcnt(4)
  s_waitcnt vmcnt(5)
  v_mfma_f32_32x32x16_bf16 v[92:107], v[124:127], v[28:31], 0
  s_cmp_ge_u32 s54, 8
  s_cselect_b32 s50, 8, 0
  s_sub_u32 s54, s54, s50
  s_lshl_b32 s59, s54, 11
  s_add_u32 s59, s59, s58
  s_add_u32 s54, s54, 1
  buffer_load_dwordx4 v[52:55], v2, s[40:43], s59 offen offset:0 sc1
  v_mfma_f32_32x32x16_bf16 v[108:123], v[128:131], v[28:31], 0
  ds_read_b64_tr_b16 v[140:141], v24 offset:4096
  ds_read_b64_tr_b16 v[142:143], v24 offset:5120
  ds_read_b64_tr_b16 v[144:145], v25 offset:4096
  ds_read_b64_tr_b16 v[146:147], v25 offset:5120
  s_waitcnt lgkmcnt(4)
  s_waitcnt vmcnt(5)
  v_mfma_f32_32x32x16_bf16 v[92:107], v[132:135], v[32:35], v[92:107]
  buffer_load_dwordx4 v[56:59], v2, s[40:43], s59 offen offset:1024 sc1
  ds_read_b64_tr_b16 v[124:125], v24 offset:6144
  ds_read_b64_tr_b16 v[126:127], v24 offset:7168
  v_mfma_f32_32x32x16_bf16 v[108:123], v[136:139], v[32:35], v[108:123]
  ds_read_b64_tr_b16 v[128:129], v25 offset:6144
  ds_read_b64_tr_b16 v[130:131], v25 offset:7168
  s_waitcnt lgkmcnt(4)
  s_waitcnt vmcnt(5)
  v_mfma_f32_32x32x16_bf16 v[92:107], v[140:143], v[36:39], v[92:107]
  s_cmp_ge_u32 s54, 8
  s_cselect_b32 s50, 8, 0
  s_sub_u32 s54, s54, s50
  s_lshl_b32 s59, s54, 11
  s_add_u32 s59, s59, s58
  s_add_u32 s54, s54, 1
  buffer_load_dwordx4 v[60:63], v2, s[40:43], s59 offen offset:0 sc1
  v_mfma_f32_32x32x16_bf16 v[108:123], v[144:147], v[36:39], v[108:123]
  ds_read_b64_tr_b16 v[132:133], v24 offset:8192
  ds_read_b64_tr_b16 v[134:135], v24 offset:9216
  ds_read_b64_tr_b16 v[136:137], v25 offset:8192
  ds_read_b64_tr_b16 v[138:139], v25 offset:9216
  s_waitcnt lgkmcnt(4)
  s_waitcnt vmcnt(5)
  v_mfma_f32_32x32x16_bf16 v[92:107], v[124:127], v[40:43], v[92:107]
  buffer_load_dwordx4 v[64:67], v2, s[40:43], s59 offen offset:1024 sc1
  ds_read_b64_tr_b16 v[140:141], v24 offset:10240
  ds_read_b64_tr_b16 v[142:143], v24 offset:11264
  v_mfma_f32_32x32x16_bf16 v[108:123], v[128:131], v[40:43], v[108:123]
  ds_read_b64_tr_b16 v[144:145], v25 offset:10240
  ds_read_b64_tr_b16 v[146:147], v25 offset:11264
  s_waitcnt lgkmcnt(4)
  s_waitcnt vmcnt(5)
  v_mfma_f32_32x32x16_bf16 v[92:107], v[132:135], v[44:47], v[92:107]
  s_cmp_ge_u32 s54, 8
  s_cselect_b32 s50, 8, 0
  s_sub_u32 s54, s54, s50
  s_lshl_b32 s59, s54, 11
  s_add_u32 s59, s59, s58
  s_add_u32 s54, s54, 1
  buffer_load_dwordx4 v[68:71], v2, s[40:43], s59 offen offset:0 sc1
  v_mfma_f32_32x32x16_bf16 v[108:123], v[136:139], v[44:47], v[108:123]
  ds_read_b64_tr_b16 v[124:125], v24 offset:12288
  ds_read_b64_tr_b16 v[126:127], v24 offset:13312
  ds_read_b64_tr_b16 v[128:129], v25 offset:12288
  ds_read_b64_tr_b16 v[130:131], v25 offset:13312
  s_waitcnt lgkmcnt(4)
  s_waitcnt vmcnt(5)
  v_mfma_f32_32x32x16_bf16 v[92:107], v[140:143], v[48:51], v[92:107]
  buffer_load_dwordx4 v[72:75], v2, s[40:43], s59 offen offset:1024 sc1
  ds_read_b64_tr_b16 v[132:133], v24 offset:14336
  ds_read_b64_tr_b16 v[134:135], v24 offset:15360
  v_mfma_f32_32x32x16_bf16 v[108:123], v[144:147], v[48:51], v[108:123]
  ds_read_b64_tr_b16 v[136:137], v25 offset:14336
  ds_read_b64_tr_b16 v[138:139], v25 offset:15360
  s_waitcnt lgkmcnt(4)
  s_waitcnt vmcnt(5)
  v_mfma_f32_32x32x16_bf16 v[92:107], v[124:127], v[52:55], v[92:107]
  s_cmp_ge_u32 s54, 8
  s_cselect_b32 s50, 8, 0
  s_sub_u32 s54, s54, s50
  s_lshl_b32 s59, s54, 11
  s_add_u32 s59, s59, s58
  s_add_u32 s54, s54, 1
  buffer_load_dwordx4 v[76:79], v2, s[40:43], s59 offen offset:0 sc1
  v_mfma_f32_32x32x16_bf16 v[108:123], v[128:131], v[52:55], v[108:123]
  ds_read_b64_tr_b16 v[140:141], v24 offset:16384
  ds_read_b64_tr_b16 v[142:143], v24 offset:17408
  ds_read_b64_tr_b16 v[144:145], v25 offset:16384
  ds_read_b64_tr_b16 v[146:147], v25 offset:17408
  s_waitcnt lgkmcnt(4)
  s_waitcnt vmcnt(5)
  v_mfma_f32_32x32x16_bf16 v[92:107], v[132:135], v[56:59], v[92:107]
  buffer_load_dwordx4 v[80:83], v2, s[40:43], s59 offen offset:1024 sc1
  ds_read_b64_tr_b16 v[124:125], v24 offset:18432
  ds_read_b64_tr_b16 v[126:127], v24 offset:19456
  v_mfma_f32_32x32x16_bf16 v[108:123], v[136:139], v[56:59], v[108:123]
  ds_read_b64_tr_b16 v[128:129], v25 offset:18432
  ds_read_b64_tr_b16 v[130:131], v25 offset:19456
  s_waitcnt lgkmcnt(4)
  s_waitcnt vmcnt(5)
  v_mfma_f32_32x32x16_bf16 v[92:107], v[140:143], v[60:63], v[92:107]
  s_cmp_ge_u32 s54, 8
  s_cselect_b32 s50, 8, 0
  s_sub_u32 s54, s54, s50
  s_lshl_b32 s59, s54, 11
  s_add_u32 s59, s59, s58
  s_add_u32 s54, s54, 1
  buffer_load_dwordx4 v[84:87], v2, s[40:43], s59 offen offset:0 sc1
  v_mfma_f32_32x32x16_bf16 v[108:123], v[144:147], v[60:63], v[108:123]
  ds_read_b64_tr_b16 v[132:133], v24 offset:20480
  ds_read_b64_tr_b16 v[134:135], v24 offset:21504
  ds_read_b64_tr_b16 v[136:137], v25 offset:20480
  ds_read_b64_tr_b16 v[138:139], v25 offset:21504
  s_waitcnt lgkmcnt(4)
  s_waitcnt vmcnt(5)
  v_mfma_f32_32x32x16_bf16 v[92:107], v[124:127], v[64:67], v[92:107]
  buffer_load_dwordx4 v[88:91], v2, s[40:43], s59 offen offset:1024 sc1
  ds_read_b64_tr_b16 v[140:141], v24 offset:22528
  ds_read_b64_tr_b16 v[142:143], v24 offset:23552
  v_mfma_f32_32x32x16_bf16 v[108:123], v[128:131], v[64:67], v[108:123]
  ds_read_b64_tr_b16 v[144:145], v25 offset:22528
  ds_read_b64_tr_b16 v[146:147], v25 offset:23552
  s_waitcnt lgkmcnt(4)
  s_waitcnt vmcnt(5)
  v_mfma_f32_32x32x16_bf16 v[92:107], v[132:135], v[68:71], v[92:107]
  ds_read_b64_tr_b16 v[124:125], v24 offset:24576
  ds_read_b64_tr_b16 v[126:127], v24 offset:25600
  ds_read_b64_tr_b16 v[128:129], v25 offset:24576
  ds_read_b64_tr_b16 v[130:131], v25 offset:25600
  s_lshl_b32 s101, s99, 7
  s_mul_i32 s100, s45, 28672
  s_add_u32 s101, s101, s100
  s_lshl_b32 s100, s45, 10
  v_mfma_f32_32x32x16_bf16 v[108:123], v[136:139], v[68:71], v[108:123]
  s_add_u32 m0, s100, 81920
  s_add_u32 s98, s101, 1792
  buffer_load_dwordx4 v15, s[20:23], s98 offen lds
  s_add_u32 m0, s100, 86016
  s_add_u32 s98, s101, 116480
  buffer_load_dwordx4 v15, s[20:23], s98 offen lds
  s_add_u32 m0, s100, 90112
  s_add_u32 s98, s101, 231168
  buffer_load_dwordx4 v15, s[20:23], s98 offen lds
  s_waitcnt lgkmcnt(4)
  s_waitcnt vmcnt(7)
  v_mfma_f32_32x32x16_bf16 v[92:107], v[140:143], v[72:75], v[92:107]
  ds_read_b64_tr_b16 v[132:133], v24 offset:26624
  ds_read_b64_tr_b16 v[134:135], v24 offset:27648
  ds_read_b64_tr_b16 v[136:137], v25 offset:26624
  ds_read_b64_tr_b16 v[138:139], v25 offset:27648
  s_add_u32 m0, s100, 94208
  s_add_u32 s98, s101, 345856
  buffer_load_dwordx4 v15, s[20:23], s98 offen lds
  v_mfma_f32_32x32x16_bf16 v[108:123], v[144:147], v[72:75], v[108:123]
  s_add_u32 m0, s100, 98304
  s_add_u32 s98, s101, 460544
  buffer_load_dwordx4 v15, s[20:23], s98 offen lds
  s_add_u32 m0, s100, 102400
  s_add_u32 s98, s101, 575232
  buffer_load_dwordx4 v15, s[20:23], s98 offen lds
  s_waitcnt lgkmcnt(4)
  s_waitcnt vmcnt(9)
  v_mfma_f32_32x32x16_bf16 v[92:107], v[124:127], v[76:79], v[92:107]
  ds_read_b64_tr_b16 v[140:141], v24 offset:28672
  ds_read_b64_tr_b16 v[142:143], v24 offset:29696
  ds_read_b64_tr_b16 v[144:145], v25 offset:28672
  ds_read_b64_tr_b16 v[146:147], v25 offset:29696
  s_add_u32 m0, s100, 106496
  s_add_u32 s98, s101, 689920
  buffer_load_dwordx4 v15, s[20:23], s98 offen lds
  v_mfma_f32_32x32x16_bf16 v[108:123], v[128:131], v[76:79], v[108:123]
  s_add_u32 m0, s100, 110592
  s_add_u32 s98, s101, 804608
  buffer_load_dwordx4 v15, s[20:23], s98 offen lds
  s_add_u32 m0, s100, 114688
  s_add_u32 s98, s101, 919296
  buffer_load_dwordx4 v15, s[20:23], s98 offen lds
  s_waitcnt lgkmcnt(4)
  s_waitcnt vmcnt(11)
  v_mfma_f32_32x32x16_bf16 v[92:107], v[132:135], v[80:83], v[92:107]
  ds_read_b64_tr_b16 v[124:125], v24 offset:30720
  ds_read_b64_tr_b16 v[126:127], v24 offset:31744
  ds_read_b64_tr_b16 v[128:129], v25 offset:30720
  ds_read_b64_tr_b16 v[130:131], v25 offset:31744
  s_add_u32 m0, s100, 118784
  s_add_u32 s98, s101, 1033984
  buffer_load_dwordx4 v15, s[20:23], s98 offen lds
  v_mfma_f32_32x32x16_bf16 v[108:123], v[136:139], v[80:83], v[108:123]
  s_add_u32 m0, s100, 122880
  s_add_u32 s98, s101, 1148672
  buffer_load_dwordx4 v15, s[20:23], s98 offen lds
  s_add_u32 m0, s100, 126976
  s_add_u32 s98, s101, 1263360
  buffer_load_dwordx4 v15, s[20:23], s98 offen lds
  s_waitcnt lgkmcnt(4)
  s_waitcnt vmcnt(13)
  v_mfma_f32_32x32x16_bf16 v[92:107], v[140:143], v[84:87], v[92:107]
  s_add_u32 m0, s100, 131072
  s_add_u32 s98, s101, 1378048
  buffer_load_dwordx4 v15, s[20:23], s98 offen lds
  v_mfma_f32_32x32x16_bf16 v[108:123], v[144:147], v[84:87], v[108:123]
  s_add_u32 m0, s100, 135168
  s_add_u32 s98, s101, 1492736
  buffer_load_dwordx4 v15, s[20:23], s98 offen lds
  s_waitcnt lgkmcnt(0)
  s_waitcnt vmcnt(14)
  v_mfma_f32_32x32x16_bf16 v[92:107], v[124:127], v[88:91], v[92:107]
  v_mfma_f32_32x32x16_bf16 v[108:123], v[128:131], v[88:91], v[108:123]
  s_barrier
  s_lshl_b32 s101, s99, 7
  s_mul_i32 s100, s45, 28672
  s_add_u32 s101, s101, s100
  s_lshl_b32 s100, s45, 10
  s_add_u32 m0, s100, 0
  s_add_u32 s98, s101, 0
  buffer_load_dwordx4 v15, s[20:23], s98 offen lds
  s_add_u32 m0, s100, 4096
  s_add_u32 s98, s101, 114688
  buffer_load_dwordx4 v15, s[20:23], s98 offen lds
  s_add_u32 m0, s100, 8192
  s_add_u32 s98, s101, 229376
  buffer_load_dwordx4 v15, s[20:23], s98 offen lds
  s_add_u32 m0, s100, 12288
  s_add_u32 s98, s101, 344064
  buffer_load_dwordx4 v15, s[20:23], s98 offen lds
  s_lshl_b32 s50, s45, 12
  s_add_u32 s50, s50, 65536
  v_add_u32 v10, s50, v2
  s_xor_b32 s51, s45, 2
  s_lshl_b32 s51, s51, 12
  s_add_u32 s51, s51, 65536
  v_add_u32 v11, s51, v2
  s_cmp_lt_u32 s45, 2
  s_cbranch_scc1 L_x_45
  ds_write_b128 v10, v[92:95] offset:0
  ds_write_b128 v10, v[96:99] offset:1024
  ds_write_b128 v10, v[100:103] offset:2048
  ds_write_b128 v10, v[104:107] offset:3072
  s_nop 1
  v_pk_mul_f32 v[92:93], v[108:109], 1.0 op_sel_hi:[1,0]
  v_pk_mul_f32 v[94:95], v[110:111], 1.0 op_sel_hi:[1,0]
  v_pk_mul_f32 v[96:97], v[112:113], 1.0 op_sel_hi:[1,0]
  v_pk_mul_f32 v[98:99], v[114:115], 1.0 op_sel_hi:[1,0]
  v_pk_mul_f32 v[100:101], v[116:117], 1.0 op_sel_hi:[1,0]
  v_pk_mul_f32 v[102:103], v[118:119], 1.0 op_sel_hi:[1,0]
  v_pk_mul_f32 v[104:105], v[120:121], 1.0 op_sel_hi:[1,0]
  v_pk_mul_f32 v[106:107], v[122:123], 1.0 op_sel_hi:[1,0]
  s_branch L_x_46
L_x_45:
  ds_write_b128 v10, v[108:111] offset:0
  ds_write_b128 v10, v[112:115] offset:1024
  ds_write_b128 v10, v[116:119] offset:2048
  ds_write_b128 v10, v[120:123] offset:3072
L_x_46:
  s_waitcnt lgkmcnt(0)
  s_barrier
  ds_read_b128 v[108:111], v11 offset:0
  ds_read_b128 v[112:115], v11 offset:1024
  ds_read_b128 v[116:119], v11 offset:2048
  ds_read_b128 v[120:123], v11 offset:3072
  v_lshlrev_b32 v36, 16, v16
  v_and_b32 v37, 0xffff0000, v16
  v_lshlrev_b32 v38, 16, v17
  v_and_b32 v39, 0xffff0000, v17
  v_lshlrev_b32 v40, 16, v18
  v_and_b32 v41, 0xffff0000, v18
  v_lshlrev_b32 v42, 16, v19
  v_and_b32 v43, 0xffff0000, v19
  v_lshlrev_b32 v44, 16, v20
  v_and_b32 v45, 0xffff0000, v20
  v_lshlrev_b32 v46, 16, v21
  v_and_b32 v47, 0xffff0000, v21
  v_lshlrev_b32 v48, 16, v22
  v_and_b32 v49, 0xffff0000, v22
  v_lshlrev_b32 v50, 16, v23
  v_and_b32 v51, 0xffff0000, v23
  v_pk_add_f32 v[92:93], v[92:93], v[36:37]
  v_pk_add_f32 v[94:95], v[94:95], v[38:39]
  v_pk_add_f32 v[96:97], v[96:97], v[40:41]
  v_pk_add_f32 v[98:99], v[98:99], v[42:43]
  v_pk_add_f32 v[100:101], v[100:101], v[44:45]
  v_pk_add_f32 v[102:103], v[102:103], v[46:47]
  v_pk_add_f32 v[104:105], v[104:105], v[48:49]
  v_pk_add_f32 v[106:107], v[106:107], v[50:51]
  s_waitcnt lgkmcnt(0)
  v_pk_add_f32 v[92:93], v[92:93], v[108:109]
  v_pk_add_f32 v[94:95], v[94:95], v[110:111]
  v_pk_add_f32 v[96:97], v[96:97], v[112:113]
  v_pk_add_f32 v[98:99], v[98:99], v[114:115]
  v_pk_add_f32 v[100:101], v[100:101], v[116:117]
  v_pk_add_f32 v[102:103], v[102:103], v[118:119]
  v_pk_add_f32 v[104:105], v[104:105], v[120:121]
  v_pk_add_f32 v[106:107], v[106:107], v[122:123]
  v_cvt_pk_bf16_f32 v28, v92, v93
  v_cvt_pk_bf16_f32 v29, v94, v95
  v_cvt_pk_bf16_f32 v30, v96, v97
  v_cvt_pk_bf16_f32 v31, v98, v99
  v_cvt_pk_bf16_f32 v32, v100, v101
  v_cvt_pk_bf16_f32 v33, v102, v103
  v_cvt_pk_bf16_f32 v34, v104, v105
  v_cvt_pk_bf16_f32 v35, v106, v107
  s_add_u32 m0, s100, 16384
  s_add_u32 s98, s101, 458752
  buffer_load_dwordx4 v15, s[20:23], s98 offen lds
  s_add_u32 m0, s100, 20480
  s_add_u32 s98, s101, 573440
  buffer_load_dwordx4 v15, s[20:23], s98 offen lds
  s_add_u32 m0, s100, 24576
  s_add_u32 s98, s101, 688128
  buffer_load_dwordx4 v15, s[20:23], s98 offen lds
  s_lshl_b32 s50, s49, 1
  s_add_u32 s50, s50, s53
  s_mul_i32 s51, s52, 14
  s_add_u32 s50, s50, s51
  s_lshl_b32 s55, s50, 11
  s_add_u32 s55, s55, 7340032
  buffer_store_dwordx4 v[28:31], v2, s[40:43], s55 offen offset:0 sc1
  buffer_store_dwordx4 v[32:35], v2, s[40:43], s55 offen offset:1024 sc1
  v_pk_add_f32 v[52:53], v[92:93], v[94:95]
  v_pk_mul_f32 v[54:55], v[92:93], v[92:93]
  v_pk_fma_f32 v[54:55], v[94:95], v[94:95], v[54:55]
  v_pk_add_f32 v[52:53], v[52:53], v[96:97]
  v_pk_fma_f32 v[54:55], v[96:97], v[96:97], v[54:55]
  v_pk_add_f32 v[52:53], v[52:53], v[98:99]
  v_pk_fma_f32 v[54:55], v[98:99], v[98:99], v[54:55]
  v_pk_add_f32 v[52:53], v[52:53], v[100:101]
  v_pk_fma_f32 v[54:55], v[100:101], v[100:101], v[54:55]
  v_pk_add_f32 v[52:53], v[52:53], v[102:103]
  v_pk_fma_f32 v[54:55], v[102:103], v[102:103], v[54:55]
  v_pk_add_f32 v[52:53], v[52:53], v[104:105]
  v_pk_fma_f32 v[54:55], v[104:105], v[104:105], v[54:55]
  v_pk_add_f32 v[52:53], v[52:53], v[106:107]
  v_pk_fma_f32 v[54:55], v[106:107], v[106:107], v[54:55]
  v_add_f32 v52, v52, v53
  v_add_f32 v53, v54, v55
  v_mov_b32 v26, v52
  s_nop 1
  v_permlane32_swap_b32 v52, v26
  v_add_f32 v52, v52, v26
  v_mov_b32 v27, v53
  s_nop 1
  v_permlane32_swap_b32 v53, v27
  v_add_f32 v53, v53, v27
  v_lshlrev_b32 v26, 3, v3
  s_lshl_b32 s55, s50, 8
  s_add_u32 s55, s55, 524288
  buffer_store_dwordx2 v[52:53], v26, s[40:43], s55 offen sc1
  s_lshr_b32 s55, s48, 1
  s_lshl_b32 s55, s55, 7
  s_and_b32 s50, s48, 1
  s_mul_i32 s50, s50, 7
  s_add_u32 s50, s50, s49
  s_lshl_b32 s50, s50, 2
  s_add_u32 s55, s55, s50
  s_add_u32 s55, s55, 12288
  s_add_u32 m0, s100, 28672
  s_add_u32 s98, s101, 802816
  buffer_load_dwordx4 v15, s[20:23], s98 offen lds
  s_add_u32 m0, s100, 32768
  s_add_u32 s98, s101, 917504
  buffer_load_dwordx4 v15, s[20:23], s98 offen lds
  s_add_u32 m0, s100, 36864
  s_add_u32 s98, s101, 1032192
  buffer_load_dwordx4 v15, s[20:23], s98 offen lds
  s_add_u32 m0, s100, 40960
  s_add_u32 s98, s101, 1146880
  buffer_load_dwordx4 v15, s[20:23], s98 offen lds
  s_add_u32 m0, s100, 45056
  s_add_u32 s98, s101, 1261568
  buffer_load_dwordx4 v15, s[20:23], s98 offen lds
  s_add_u32 m0, s100, 49152
  s_add_u32 s98, s101, 1376256
  buffer_load_dwordx4 v15, s[20:23], s98 offen lds
  s_add_u32 m0, s100, 53248
  s_add_u32 s98, s101, 1490944
  buffer_load_dwordx4 v15, s[20:23], s98 offen lds
  s_waitcnt vmcnt(7)
  s_barrier
  s_cmp_lg_u32 s45, 0
  s_cbranch_scc1 L_nf_47
  v_mov_b32 v5, s44
  v_mov_b32 v6, 0
  s_mov_b64 exec, 1
  buffer_store_dword v5, v6, s[40:43], s55 offen sc1
  s_mov_b64 exec, -1
L_nf_47:
  s_branch L_ip_48
L_skipB:
  s_lshl_b32 s50, s46, 20
  s_sub_u32 s51, s47, 28
  s_lshl_b32 s51, s51, 2
  s_add_u32 s51, s51, s45
  s_lshl_b32 s51, s51, 12
  s_add_u32 s50, s50, s51
  s_add_u32 s50, s50, 0
  v_lshlrev_b32 v251, 6, v1
  s_mov_b32 s51, 6
L_il_49:
  buffer_load_dword v252, v251, s[24:27], s50 offen
  s_add_u32 s50, s50, 65536
  s_sub_u32 s51, s51, 1
  s_cmp_lg_u32 s51, 0
  s_cbranch_scc1 L_il_49
  s_waitcnt vmcnt(0)
L_ip_48:
  s_cmp_ge_u32 s47, 28
  s_cbranch_scc1 L_skipC
  s_cmp_ge_u32 s47, 14
  s_cselect_b32 s50, 1, 0
  s_mul_i32 s51, s50, 14
  s_sub_u32 s49, s47, s51
  s_lshl_b32 s48, s46, 1
  s_add_u32 s48, s48, s50
  s_lshl_b32 s52, s48, 2
  s_add_u32 s52, s52, s45
  v_lshrrev_b32 v10, 3, v1
  v_mul_u32_u24 v10, 3584, v10
  v_lshrrev_b32 v11, 4, v1
  v_and_b32 v11, 1, v11
  v_lshlrev_b32 v11, 2, v11
  v_and_b32 v12, 7, v1
  v_xor_b32 v12, v12, v11
  v_lshlrev_b32 v12, 4, v12
  v_add_u32 v14, v10, v12
  v_lshrrev_b32 v10, 2, v1
  v_and_b32 v10, 3, v10
  v_lshlrev_b32 v11, 2, v4
  v_add_u32 v11, v11, v10
  v_lshlrev_b32 v11, 7, v11
  v_lshrrev_b32 v12, 4, v1
  v_and_b32 v12, 1, v12
  v_lshlrev_b32 v12, 5, v12
  v_add_u32 v11, v11, v12
  v_and_b32 v12, 3, v1
  v_lshlrev_b32 v12, 3, v12
  v_add_u32 v11, v11, v12
  v_lshrrev_b32 v10, 1, v10
  v_lshlrev_b32 v10, 6, v10
  v_add_u32 v11, 81920, v11
  v_add_u32 v15, v11, v10
  v_xor_b32 v10, 64, v10
  v_add_u32 v16, v11, v10
  v_subrev_u32 v17, 81920, v15
  v_subrev_u32 v18, 81920, v16
  v_mov_b32 v20, 0x3f803f80
  v_mov_b32 v21, 0x3f803f80
  v_mov_b32 v22, 0x3f803f80
  v_mov_b32 v23, 0x3f803f80
  s_lshr_b32 s50, s45, 1
  s_mul_i32 s50, s50, 81920
  s_and_b32 s51, s45, 1
  s_cmp_eq_u32 s51, 0
  v_mov_b32 v19, v16
  s_cselect_b64 vcc, -1, 0
  v_cndmask_b32 v19, v19, v15, vcc
  v_subrev_u32 v19, s50, v19
  s_waitcnt vmcnt(0)
  s_barrier
  ds_read_b64_tr_b16 v[40:41], v19 offset:0
  ds_read_b64_tr_b16 v[42:43], v19 offset:1024
  ds_read_b64_tr_b16 v[44:45], v19 offset:2048
  ds_read_b64_tr_b16 v[46:47], v19 offset:3072
  ds_read_b64_tr_b16 v[48:49], v19 offset:4096
  ds_read_b64_tr_b16 v[50:51], v19 offset:5120
  s_waitcnt lgkmcnt(4)
  v_mfma_f32_32x32x16_bf16 v[24:39], v[40:43], v[20:23], 0
  ds_read_b64_tr_b16 v[52:53], v19 offset:6144
  ds_read_b64_tr_b16 v[54:55], v19 offset:7168
  s_waitcnt lgkmcnt(4)
  v_mfma_f32_32x32x16_bf16 v[24:39], v[44:47], v[20:23], v[24:39]
  ds_read_b64_tr_b16 v[40:41], v19 offset:8192
  ds_read_b64_tr_b16 v[42:43], v19 offset:9216
  s_waitcnt lgkmcnt(4)
  v_mfma_f32_32x32x16_bf16 v[24:39], v[48:51], v[20:23], v[24:39]
  ds_read_b64_tr_b16 v[44:45], v19 offset:10240
  ds_read_b64_tr_b16 v[46:47], v19 offset:11264
  s_waitcnt lgkmcnt(4)
  v_mfma_f32_32x32x16_bf16 v[24:39], v[52:55], v[20:23], v[24:39]
  ds_read_b64_tr_b16 v[48:49], v19 offset:12288
  ds_read_b64_tr_b16 v[50:51], v19 offset:13312
  s_waitcnt lgkmcnt(4)
  v_mfma_f32_32x32x16_bf16 v[24:39], v[40:43], v[20:23], v[24:39]
  ds_read_b64_tr_b16 v[52:53], v19 offset:14336
  ds_read_b64_tr_b16 v[54:55], v19 offset:15360
  s_waitcnt lgkmcnt(4)
  v_mfma_f32_32x32x16_bf16 v[24:39], v[44:47], v[20:23], v[24:39]
  ds_read_b64_tr_b16 v[40:41], v19 offset:16384
  ds_read_b64_tr_b16 v[42:43], v19 offset:17408
  s_waitcnt lgkmcnt(4)
  v_mfma_f32_32x32x16_bf16 v[24:39], v[48:51], v[20:23], v[24:39]
  ds_read_b64_tr_b16 v[44:45], v19 offset:18432
  ds_read_b64_tr_b16 v[46:47], v19 offset:19456
  s_waitcnt lgkmcnt(4)
  v_mfma_f32_32x32x16_bf16 v[24:39], v[52:55], v[20:23], v[24:39]
  ds_read_b64_tr_b16 v[48:49], v19 offset:20480
  ds_read_b64_tr_b16 v[50:51], v19 offset:21504
  s_waitcnt lgkmcnt(4)
  v_mfma_f32_32x32x16_bf16 v[24:39], v[40:43], v[20:23], v[24:39]
  ds_read_b64_tr_b16 v[52:53], v19 offset:22528
  ds_read_b64_tr_b16 v[54:55], v19 offset:23552
  s_waitcnt lgkmcnt(4)
  v_mfma_f32_32x32x16_bf16 v[24:39], v[44:47], v[20:23], v[24:39]
  ds_read_b64_tr_b16 v[40:41], v19 offset:24576
  ds_read_b64_tr_b16 v[42:43], v19 offset:25600
  s_waitcnt lgkmcnt(4)
  v_mfma_f32_32x32x16_bf16 v[24:39], v[48:51], v[20:23], v[24:39]
  ds_read_b64_tr_b16 v[44:45], v19 offset:26624
  ds_read_b64_tr_b16 v[46:47], v19 offset:27648
  s_waitcnt lgkmcnt(4)
  v_mfma_f32_32x32x16_bf16 v[24:39], v[52:55], v[20:23], v[24:39]
  ds_read_b64_tr_b16 v[48:49], v19 offset:28672
  ds_read_b64_tr_b16 v[50:51], v19 offset:29696
  s_waitcnt lgkmcnt(4)
  v_mfma_f32_32x32x16_bf16 v[24:39], v[40:43], v[20:23], v[24:39]
  ds_read_b64_tr_b16 v[52:53], v19 offset:30720
  ds_read_b64_tr_b16 v[54:55], v19 offset:31744
  s_waitcnt lgkmcnt(4)
  v_mfma_f32_32x32x16_bf16 v[24:39], v[44:47], v[20:23], v[24:39]
  ds_read_b64_tr_b16 v[40:41], v19 offset:32768
  ds_read_b64_tr_b16 v[42:43], v19 offset:33792
  s_waitcnt lgkmcnt(4)
  v_mfma_f32_32x32x16_bf16 v[24:39], v[48:51], v[20:23], v[24:39]
  ds_read_b64_tr_b16 v[44:45], v19 offset:34816
  ds_read_b64_tr_b16 v[46:47], v19 offset:35840
  s_waitcnt lgkmcnt(4)
  v_mfma_f32_32x32x16_bf16 v[24:39], v[52:55], v[20:23], v[24:39]
  ds_read_b64_tr_b16 v[48:49], v19 offset:36864
  ds_read_b64_tr_b16 v[50:51], v19 offset:37888
  s_waitcnt lgkmcnt(4)
  v_mfma_f32_32x32x16_bf16 v[24:39], v[40:43], v[20:23], v[24:39]
  ds_read_b64_tr_b16 v[52:53], v19 offset:38912
  ds_read_b64_tr_b16 v[54:55], v19 offset:39936
  s_waitcnt lgkmcnt(4)
  v_mfma_f32_32x32x16_bf16 v[24:39], v[44:47], v[20:23], v[24:39]
  ds_read_b64_tr_b16 v[40:41], v19 offset:40960
  ds_read_b64_tr_b16 v[42:43], v19 offset:41984
  s_waitcnt lgkmcnt(4)
  v_mfma_f32_32x32x16_bf16 v[24:39], v[48:51], v[20:23], v[24:39]
  ds_read_b64_tr_b16 v[44:45], v19 offset:43008
  ds_read_b64_tr_b16 v[46:47], v19 offset:44032
  s_waitcnt lgkmcnt(4)
  v_mfma_f32_32x32x16_bf16 v[24:39], v[52:55], v[20:23], v[24:39]
  ds_read_b64_tr_b16 v[48:49], v19 offset:45056
  ds_read_b64_tr_b16 v[50:51], v19 offset:46080
  s_waitcnt lgkmcnt(4)
  v_mfma_f32_32x32x16_bf16 v[24:39], v[40:43], v[20:23], v[24:39]
  ds_read_b64_tr_b16 v[52:53], v19 offset:47104
  ds_read_b64_tr_b16 v[54:55], v19 offset:48128
  s_waitcnt lgkmcnt(4)
  v_mfma_f32_32x32x16_bf16 v[24:39], v[44:47], v[20:23], v[24:39]
  ds_read_b64_tr_b16 v[40:41], v19 offset:49152
  ds_read_b64_tr_b16 v[42:43], v19 offset:50176
  s_waitcnt lgkmcnt(4)
  v_mfma_f32_32x32x16_bf16 v[24:39], v[48:51], v[20:23], v[24:39]
  ds_read_b64_tr_b16 v[44:45], v19 offset:51200
  ds_read_b64_tr_b16 v[46:47], v19 offset:52224
  s_waitcnt lgkmcnt(4)
  v_mfma_f32_32x32x16_bf16 v[24:39], v[52:55], v[20:23], v[24:39]
  ds_read_b64_tr_b16 v[48:49], v19 offset:53248
  ds_read_b64_tr_b16 v[50:51], v19 offset:54272
  s_waitcnt lgkmcnt(4)
  v_mfma_f32_32x32x16_bf16 v[24:39], v[40:43], v[20:23], v[24:39]
  ds_read_b64_tr_b16 v[52:53], v19 offset:55296
  ds_read_b64_tr_b16 v[54:55], v19 offset:56320
  s_waitcnt lgkmcnt(4)
  v_mfma_f32_32x32x16_bf16 v[24:39], v[44:47], v[20:23], v[24:39]
  s_waitcnt lgkmcnt(2)
  v_mfma_f32_32x32x16_bf16 v[24:39], v[48:51], v[20:23], v[24:39]
  s_waitcnt lgkmcnt(0)
  v_mfma_f32_32x32x16_bf16 v[24:39], v[52:55], v[20:23], v[24:39]
  v_lshlrev_b32 v10, 4, v4
  s_lshl_b32 s50, s45, 7
  s_add_u32 s50, s50, 57344
  v_add_u32 v10, s50, v10
  s_mov_b32 exec_lo, 1
  s_mov_b32 exec_hi, 1
  s_nop 5
  ds_write_b128 v10, v[24:27] offset:0
  ds_write_b128 v10, v[28:31] offset:32
  ds_write_b128 v10, v[32:35] offset:64
  ds_write_b128 v10, v[36:39] offset:96
  s_mov_b64 exec, -1
  s_waitcnt lgkmcnt(0)
  s_lshl_b32 s55, s48, 7
  s_add_u32 s55, s55, 12288
  v_min_u32 v9, 13, v1
  v_lshlrev_b32 v9, 2, v9
  s_cmp_lg_u32 s45, 0
  s_cbranch_scc1 L_po_52
  buffer_load_dword v5, v9, s[40:43], s55 offen sc1
  s_sleep 1
  buffer_load_dword v6, v9, s[40:43], s55 offen sc1
  s_sleep 1
  buffer_load_dword v7, v9, s[40:43], s55 offen sc1
  s_sleep 1
  buffer_load_dword v8, v9, s[40:43], s55 offen sc1
  s_mov_b32 s70, 0
L_poll_50:
  s_waitcnt vmcnt(3)
  v_cmp_ne_u32 vcc, s44, v5
  s_cbranch_vccz L_pd_51
  buffer_load_dword v5, v9, s[40:43], s55 offen sc1
  s_waitcnt vmcnt(3)
  v_cmp_ne_u32 vcc, s44, v6
  s_cbranch_vccz L_pd_51
  buffer_load_dword v6, v9, s[40:43], s55 offen sc1
  s_waitcnt vmcnt(3)
  v_cmp_ne_u32 vcc, s44, v7
  s_cbranch_vccz L_pd_51
  buffer_load_dword v7, v9, s[40:43], s55 offen sc1
  s_waitcnt vmcnt(3)
  v_cmp_ne_u32 vcc, s44, v8
  s_cbranch_vccz L_pd_51
  buffer_load_dword v8, v9, s[40:43], s55 offen sc1
  s_add_u32 s70, s70, 1
  s_cmp_lt_u32 s70, 20000
  s_cbranch_scc1 L_poll_50
  s_branch L_pd_51
L_po_52:
L_pd_51:
  s_barrier
  s_mul_i32 s55, s52, 14
  s_lshl_b32 s54, s55, 11
  s_add_u32 s54, s54, 7340032
  s_mov_b32 s58, 0
  s_cmp_ge_u32 s58, 28
  s_cselect_b32 s50, 28, 0
  s_sub_u32 s58, s58, s50
  s_lshl_b32 s56, s58, 10
  s_add_u32 s56, s56, s54
  buffer_load_dwordx4 a[0:3], v2, s[40:43], s56 offen sc1
  s_add_u32 s58, s58, 1
  s_cmp_ge_u32 s58, 28
  s_cselect_b32 s50, 28, 0
  s_sub_u32 s58, s58, s50
  s_lshl_b32 s56, s58, 10
  s_add_u32 s56, s56, s54
  buffer_load_dwordx4 a[4:7], v2, s[40:43], s56 offen sc1
  s_add_u32 s58, s58, 1
  s_cmp_ge_u32 s58, 28
  s_cselect_b32 s50, 28, 0
  s_sub_u32 s58, s58, s50
  s_lshl_b32 s56, s58, 10
  s_add_u32 s56, s56, s54
  buffer_load_dwordx4 a[8:11], v2, s[40:43], s56 offen sc1
  s_add_u32 s58, s58, 1
  s_cmp_ge_u32 s58, 28
  s_cselect_b32 s50, 28, 0
  s_sub_u32 s58, s58, s50
  s_lshl_b32 s56, s58, 10
  s_add_u32 s56, s56, s54
  buffer_load_dwordx4 a[12:15], v2, s[40:43], s56 offen sc1
  s_add_u32 s58, s58, 1
  s_cmp_ge_u32 s58, 28
  s_cselect_b32 s50, 28, 0
  s_sub_u32 s58, s58, s50
  s_lshl_b32 s56, s58, 10
  s_add_u32 s56, s56, s54
  buffer_load_dwordx4 a[16:19], v2, s[40:43], s56 offen sc1
  s_add_u32 s58, s58, 1
  s_cmp_ge_u32 s58, 28
  s_cselect_b32 s50, 28, 0
  s_sub_u32 s58, s58, s50
  s_lshl_b32 s56, s58, 10
  s_add_u32 s56, s56, s54
  buffer_load_dwordx4 a[20:23], v2, s[40:43], s56 offen sc1
  s_add_u32 s58, s58, 1
  s_cmp_ge_u32 s58, 28
  s_cselect_b32 s50, 28, 0
  s_sub_u32 s58, s58, s50
  s_lshl_b32 s56, s58, 10
  s_add_u32 s56, s56, s54
  buffer_load_dwordx4 a[24:27], v2, s[40:43], s56 offen sc1
  s_add_u32 s58, s58, 1
  s_cmp_ge_u32 s58, 28
  s_cselect_b32 s50, 28, 0
  s_sub_u32 s58, s58, s50
  s_lshl_b32 s56, s58, 10
  s_add_u32 s56, s56, s54
  buffer_load_dwordx4 a[28:31], v2, s[40:43], s56 offen sc1
  s_add_u32 s58, s58, 1
  s_cmp_ge_u32 s58, 28
  s_cselect_b32 s50, 28, 0
  s_sub_u32 s58, s58, s50
  s_lshl_b32 s56, s58, 10
  s_add_u32 s56, s56, s54
  buffer_load_dwordx4 a[32:35], v2, s[40:43], s56 offen sc1
  s_add_u32 s58, s58, 1
  s_cmp_ge_u32 s58, 28
  s_cselect_b32 s50, 28, 0
  s_sub_u32 s58, s58, s50
  s_lshl_b32 s56, s58, 10
  s_add_u32 s56, s56, s54
  buffer_load_dwordx4 a[36:39], v2, s[40:43], s56 offen sc1
  s_add_u32 s58, s58, 1
  v_lshlrev_b32 v160, 4, v4
  v_add_u32 v160, 57344, v160
  ds_read_b64_tr_b16 v[104:105], v15 offset:0
  ds_read_b64_tr_b16 v[106:107], v15 offset:1024
  ds_read_b64_tr_b16 v[108:109], v16 offset:0
  ds_read_b64_tr_b16 v[110:111], v16 offset:1024
  ds_read_b64_tr_b16 v[112:113], v15 offset:2048
  ds_read_b64_tr_b16 v[114:115], v15 offset:3072
  ds_read_b64_tr_b16 v[116:117], v16 offset:2048
  ds_read_b64_tr_b16 v[118:119], v16 offset:3072
  s_waitcnt lgkmcnt(4)
  s_waitcnt vmcnt(9)
  v_mfma_f32_32x32x16_bf16 v[40:55], v[104:107], a[0:3], 0
  s_cmp_ge_u32 s58, 28
  s_cselect_b32 s50, 28, 0
  s_sub_u32 s58, s58, s50
  s_lshl_b32 s56, s58, 10
  s_add_u32 s56, s56, s54
  buffer_load_dwordx4 a[40:43], v2, s[40:43], s56 offen sc1
  s_add_u32 s58, s58, 1
  v_mfma_f32_32x32x16_bf16 v[56:71], v[108:111], a[0:3], 0
  ds_read_b64_tr_b16 v[120:121], v15 offset:4096
  ds_read_b64_tr_b16 v[122:123], v15 offset:5120
  ds_read_b64_tr_b16 v[124:125], v16 offset:4096
  ds_read_b64_tr_b16 v[126:127], v16 offset:5120
  s_waitcnt lgkmcnt(4)
  s_waitcnt vmcnt(9)
  v_mfma_f32_32x32x16_bf16 v[40:55], v[112:115], a[4:7], v[40:55]
  s_cmp_ge_u32 s58, 28
  s_cselect_b32 s50, 28, 0
  s_sub_u32 s58, s58, s50
  s_lshl_b32 s56, s58, 10
  s_add_u32 s56, s56, s54
  buffer_load_dwordx4 a[44:47], v2, s[40:43], s56 offen sc1
  s_add_u32 s58, s58, 1
  v_mfma_f32_32x32x16_bf16 v[56:71], v[116:119], a[4:7], v[56:71]
  ds_read_b64_tr_b16 v[104:105], v15 offset:6144
  ds_read_b64_tr_b16 v[106:107], v15 offset:7168
  ds_read_b64_tr_b16 v[108:109], v16 offset:6144
  ds_read_b64_tr_b16 v[110:111], v16 offset:7168
  s_waitcnt lgkmcnt(4)
  s_waitcnt vmcnt(9)
  v_mfma_f32_32x32x16_bf16 v[40:55], v[120:123], a[8:11], v[40:55]
  s_cmp_ge_u32 s58, 28
  s_cselect_b32 s50, 28, 0
  s_sub_u32 s58, s58, s50
  s_lshl_b32 s56, s58, 10
  s_add_u32 s56, s56, s54
  buffer_load_dwordx4 a[48:51], v2, s[40:43], s56 offen sc1
  s_add_u32 s58, s58, 1
  v_mfma_f32_32x32x16_bf16 v[56:71], v[124:127], a[8:11], v[56:71]
  ds_read_b64_tr_b16 v[112:113], v15 offset:8192
  ds_read_b64_tr_b16 v[114:115], v15 offset:9216
  ds_read_b64_tr_b16 v[116:117], v16 offset:8192
  ds_read_b64_tr_b16 v[118:119], v16 offset:9216
  s_waitcnt lgkmcnt(4)
  s_waitcnt vmcnt(9)
  v_mfma_f32_32x32x16_bf16 v[40:55], v[104:107], a[12:15], v[40:55]
  s_cmp_ge_u32 s58, 28
  s_cselect_b32 s50, 28, 0
  s_sub_u32 s58, s58, s50
  s_lshl_b32 s56, s58, 10
  s_add_u32 s56, s56, s54
  buffer_load_dwordx4 a[52:55], v2, s[40:43], s56 offen sc1
  s_add_u32 s58, s58, 1
  v_mfma_f32_32x32x16_bf16 v[56:71], v[108:111], a[12:15], v[56:71]
  ds_read_b64_tr_b16 v[120:121], v15 offset:10240
  ds_read_b64_tr_b16 v[122:123], v15 offset:11264
  ds_read_b64_tr_b16 v[124:125], v16 offset:10240
  ds_read_b64_tr_b16 v[126:127], v16 offset:11264
  s_waitcnt lgkmcnt(4)
  s_waitcnt vmcnt(9)
  v_mfma_f32_32x32x16_bf16 v[40:55], v[112:115], a[16:19], v[40:55]
  s_cmp_ge_u32 s58, 28
  s_cselect_b32 s50, 28, 0
  s_sub_u32 s58, s58, s50
  s_lshl_b32 s56, s58, 10
  s_add_u32 s56, s56, s54
  buffer_load_dwordx4 a[56:59], v2, s[40:43], s56 offen sc1
  s_add_u32 s58, s58, 1
  v_mfma_f32_32x32x16_bf16 v[56:71], v[116:119], a[16:19], v[56:71]
  ds_read_b64_tr_b16 v[104:105], v15 offset:12288
  ds_read_b64_tr_b16 v[106:107], v15 offset:13312
  ds_read_b64_tr_b16 v[108:109], v16 offset:12288
  ds_read_b64_tr_b16 v[110:111], v16 offset:13312
  s_waitcnt lgkmcnt(4)
  s_waitcnt vmcnt(9)
  v_mfma_f32_32x32x16_bf16 v[40:55], v[120:123], a[20:23], v[40:55]
  s_cmp_ge_u32 s58, 28
  s_cselect_b32 s50, 28, 0
  s_sub_u32 s58, s58, s50
  s_lshl_b32 s56, s58, 10
  s_add_u32 s56, s56, s54
  buffer_load_dwordx4 a[60:63], v2, s[40:43], s56 offen sc1
  s_add_u32 s58, s58, 1
  v_mfma_f32_32x32x16_bf16 v[56:71], v[124:127], a[20:23], v[56:71]
  ds_read_b64_tr_b16 v[112:113], v15 offset:14336
  ds_read_b64_tr_b16 v[114:115], v15 offset:15360
  ds_read_b64_tr_b16 v[116:117], v16 offset:14336
  ds_read_b64_tr_b16 v[118:119], v16 offset:15360
  s_waitcnt lgkmcnt(4)
  s_waitcnt vmcnt(9)
  v_mfma_f32_32x32x16_bf16 v[40:55], v[104:107], a[24:27], v[40:55]
  s_cmp_ge_u32 s58, 28
  s_cselect_b32 s50, 28, 0
  s_sub_u32 s58, s58, s50
  s_lshl_b32 s56, s58, 10
  s_add_u32 s56, s56, s54
  buffer_load_dwordx4 a[64:67], v2, s[40:43], s56 offen sc1
  s_add_u32 s58, s58, 1
  v_mfma_f32_32x32x16_bf16 v[56:71], v[108:111], a[24:27], v[56:71]
  ds_read_b64_tr_b16 v[120:121], v15 offset:16384
  ds_read_b64_tr_b16 v[122:123], v15 offset:17408
  ds_read_b64_tr_b16 v[124:125], v16 offset:16384
  ds_read_b64_tr_b16 v[126:127], v16 offset:17408
  s_waitcnt lgkmcnt(4)
  s_waitcnt vmcnt(9)
  v_mfma_f32_32x32x16_bf16 v[40:55], v[112:115], a[28:31], v[40:55]
  s_cmp_ge_u32 s58, 28
  s_cselect_b32 s50, 28, 0
  s_sub_u32 s58, s58, s50
  s_lshl_b32 s56, s58, 10
  s_add_u32 s56, s56, s54
  buffer_load_dwordx4 a[68:71], v2, s[40:43], s56 offen sc1
  s_add_u32 s58, s58, 1
  v_mfma_f32_32x32x16_bf16 v[56:71], v[116:119], a[28:31], v[56:71]
  ds_read_b64_tr_b16 v[104:105], v15 offset:18432
  ds_read_b64_tr_b16 v[106:107], v15 offset:19456
  ds_read_b64_tr_b16 v[108:109], v16 offset:18432
  ds_read_b64_tr_b16 v[110:111], v16 offset:19456
  s_waitcnt lgkmcnt(4)
  s_waitcnt vmcnt(9)
  v_mfma_f32_32x32x16_bf16 v[40:55], v[120:123], a[32:35], v[40:55]
  s_cmp_ge_u32 s58, 28
  s_cselect_b32 s50, 28, 0
  s_sub_u32 s58, s58, s50
  s_lshl_b32 s56, s58, 10
  s_add_u32 s56, s56, s54
  buffer_load_dwordx4 a[72:75], v2, s[40:43], s56 offen sc1
  s_add_u32 s58, s58, 1
  v_mfma_f32_32x32x16_bf16 v[56:71], v[124:127], a[32:35], v[56:71]
  ds_read_b64_tr_b16 v[112:113], v15 offset:20480
  ds_read_b64_tr_b16 v[114:115], v15 offset:21504
  ds_read_b64_tr_b16 v[116:117], v16 offset:20480
  ds_read_b64_tr_b16 v[118:119], v16 offset:21504
  s_waitcnt lgkmcnt(4)
  s_waitcnt vmcnt(9)
  v_mfma_f32_32x32x16_bf16 v[40:55], v[104:107], a[36:39], v[40:55]
  s_cmp_ge_u32 s58, 28
  s_cselect_b32 s50, 28, 0
  s_sub_u32 s58, s58, s50
  s_lshl_b32 s56, s58, 10
  s_add_u32 s56, s56, s54
  buffer_load_dwordx4 a[76:79], v2, s[40:43], s56 offen sc1
  s_add_u32 s58, s58, 1
  v_mfma_f32_32x32x16_bf16 v[56:71], v[108:111], a[36:39], v[56:71]
  ds_read_b64_tr_b16 v[120:121], v15 offset:22528
  ds_read_b64_tr_b16 v[122:123], v15 offset:23552
  ds_read_b64_tr_b16 v[124:125], v16 offset:22528
  ds_read_b64_tr_b16 v[126:127], v16 offset:23552
  s_waitcnt lgkmcnt(4)
  s_waitcnt vmcnt(9)
  v_mfma_f32_32x32x16_bf16 v[40:55], v[112:115], a[40:43], v[40:55]
  s_cmp_ge_u32 s58, 28
  s_cselect_b32 s50, 28, 0
  s_sub_u32 s58, s58, s50
  s_lshl_b32 s56, s58, 10
  s_add_u32 s56, s56, s54
  buffer_load_dwordx4 a[80:83], v2, s[40:43], s56 offen sc1
  s_add_u32 s58, s58, 1
  v_mfma_f32_32x32x16_bf16 v[56:71], v[116:119], a[40:43], v[56:71]
  ds_read_b64_tr_b16 v[104:105], v15 offset:24576
  ds_read_b64_tr_b16 v[106:107], v15 offset:25600
  ds_read_b64_tr_b16 v[108:109], v16 offset:24576
  ds_read_b64_tr_b16 v[110:111], v16 offset:25600
  s_waitcnt lgkmcnt(4)
  s_waitcnt vmcnt(9)
  v_mfma_f32_32x32x16_bf16 v[40:55], v[120:123], a[44:47], v[40:55]
  s_cmp_ge_u32 s58, 28
  s_cselect_b32 s50, 28, 0
  s_sub_u32 s58, s58, s50
  s_lshl_b32 s56, s58, 10
  s_add_u32 s56, s56, s54
  buffer_load_dwordx4 a[84:87], v2, s[40:43], s56 offen sc1
  s_add_u32 s58, s58, 1
  v_mfma_f32_32x32x16_bf16 v[56:71], v[124:127], a[44:47], v[56:71]
  ds_read_b64_tr_b16 v[112:113], v15 offset:26624
  ds_read_b64_tr_b16 v[114:115], v15 offset:27648
  ds_read_b64_tr_b16 v[116:117], v16 offset:26624
  ds_read_b64_tr_b16 v[118:119], v16 offset:27648
  s_waitcnt lgkmcnt(4)
  s_waitcnt vmcnt(9)
  v_mfma_f32_32x32x16_bf16 v[40:55], v[104:107], a[48:51], v[40:55]
  s_cmp_ge_u32 s58, 28
  s_cselect_b32 s50, 28, 0
  s_sub_u32 s58, s58, s50
  s_lshl_b32 s56, s58, 10
  s_add_u32 s56, s56, s54
  buffer_load_dwordx4 a[88:91], v2, s[40:43], s56 offen sc1
  s_add_u32 s58, s58, 1
  v_mfma_f32_32x32x16_bf16 v[56:71], v[108:111], a[48:51], v[56:71]
  ds_read_b64_tr_b16 v[120:121], v15 offset:28672
  ds_read_b64_tr_b16 v[122:123], v15 offset:29696
  ds_read_b64_tr_b16 v[124:125], v16 offset:28672
  ds_read_b64_tr_b16 v[126:127], v16 offset:29696
  s_waitcnt lgkmcnt(4)
  s_waitcnt vmcnt(9)
  v_mfma_f32_32x32x16_bf16 v[40:55], v[112:115], a[52:55], v[40:55]
  s_cmp_ge_u32 s58, 28
  s_cselect_b32 s50, 28, 0
  s_sub_u32 s58, s58, s50
  s_lshl_b32 s56, s58, 10
  s_add_u32 s56, s56, s54
  buffer_load_dwordx4 a[92:95], v2, s[40:43], s56 offen sc1
  s_add_u32 s58, s58, 1
  v_mfma_f32_32x32x16_bf16 v[56:71], v[116:119], a[52:55], v[56:71]
  ds_read_b64_tr_b16 v[104:105], v15 offset:30720
  ds_read_b64_tr_b16 v[106:107], v15 offset:31744
  ds_read_b64_tr_b16 v[108:109], v16 offset:30720
  ds_read_b64_tr_b16 v[110:111], v16 offset:31744
  s_waitcnt lgkmcnt(4)
  s_waitcnt vmcnt(9)
  v_mfma_f32_32x32x16_bf16 v[40:55], v[120:123], a[56:59], v[40:55]
  s_cmp_ge_u32 s58, 28
  s_cselect_b32 s50, 28, 0
  s_sub_u32 s58, s58, s50
  s_lshl_b32 s56, s58, 10
  s_add_u32 s56, s56, s54
  buffer_load_dwordx4 a[96:99], v2, s[40:43], s56 offen sc1
  s_add_u32 s58, s58, 1
  v_mfma_f32_32x32x16_bf16 v[56:71], v[124:127], a[56:59], v[56:71]
  ds_read_b64_tr_b16 v[112:113], v15 offset:32768
  ds_read_b64_tr_b16 v[114:115], v15 offset:33792
  ds_read_b64_tr_b16 v[116:117], v16 offset:32768
  ds_read_b64_tr_b16 v[118:119], v16 offset:33792
  s_waitcnt lgkmcnt(4)
  s_waitcnt vmcnt(9)
  v_mfma_f32_32x32x16_bf16 v[40:55], v[104:107], a[60:63], v[40:55]
  s_cmp_ge_u32 s58, 28
  s_cselect_b32 s50, 28, 0
  s_sub_u32 s58, s58, s50
  s_lshl_b32 s56, s58, 10
  s_add_u32 s56, s56, s54
  buffer_load_dwordx4 a[100:103], v2, s[40:43], s56 offen sc1
  s_add_u32 s58, s58, 1
  v_mfma_f32_32x32x16_bf16 v[56:71], v[108:111], a[60:63], v[56:71]
  ds_read_b64_tr_b16 v[120:121], v15 offset:34816
  ds_read_b64_tr_b16 v[122:123], v15 offset:35840
  ds_read_b64_tr_b16 v[124:125], v16 offset:34816
  ds_read_b64_tr_b16 v[126:127], v16 offset:35840
  s_waitcnt lgkmcnt(4)
  s_waitcnt vmcnt(9)
  v_mfma_f32_32x32x16_bf16 v[40:55], v[112:115], a[64:67], v[40:55]
  s_cmp_ge_u32 s58, 28
  s_cselect_b32 s50, 28, 0
  s_sub_u32 s58, s58, s50
  s_lshl_b32 s56, s58, 10
  s_add_u32 s56, s56, s54
  buffer_load_dwordx4 a[104:107], v2, s[40:43], s56 offen sc1
  s_add_u32 s58, s58, 1
  v_mfma_f32_32x32x16_bf16 v[56:71], v[116:119], a[64:67], v[56:71]
  ds_read_b64_tr_b16 v[104:105], v15 offset:36864
  ds_read_b64_tr_b16 v[106:107], v15 offset:37888
  ds_read_b64_tr_b16 v[108:109], v16 offset:36864
  ds_read_b64_tr_b16 v[110:111], v16 offset:37888
  s_waitcnt lgkmcnt(4)
  s_waitcnt vmcnt(9)
  v_mfma_f32_32x32x16_bf16 v[40:55], v[120:123], a[68:71], v[40:55]
  s_cmp_ge_u32 s58, 28
  s_cselect_b32 s50, 28, 0
  s_sub_u32 s58, s58, s50
  s_lshl_b32 s56, s58, 10
  s_add_u32 s56, s56, s54
  buffer_load_dwordx4 a[108:111], v2, s[40:43], s56 offen sc1
  s_add_u32 s58, s58, 1
  v_mfma_f32_32x32x16_bf16 v[56:71], v[124:127], a[68:71], v[56:71]
  ds_read_b64_tr_b16 v[112:113], v15 offset:38912
  ds_read_b64_tr_b16 v[114:115], v15 offset:39936
  ds_read_b64_tr_b16 v[116:117], v16 offset:38912
  ds_read_b64_tr_b16 v[118:119], v16 offset:39936
  s_waitcnt lgkmcnt(4)
  s_waitcnt vmcnt(9)
  v_mfma_f32_32x32x16_bf16 v[40:55], v[104:107], a[72:75], v[40:55]
  ds_read_b64_tr_b16 v[120:121], v15 offset:40960
  ds_read_b64_tr_b16 v[122:123], v15 offset:41984
  ds_read_b64_tr_b16 v[124:125], v16 offset:40960
  ds_read_b64_tr_b16 v[126:127], v16 offset:41984
  v_mfma_f32_32x32x16_bf16 v[56:71], v[108:111], a[72:75], v[56:71]
  v_mul_u32_u24 v24, 1792, v4
  v_lshlrev_b32 v25, 3, v3
  v_add_u32 v24, v24, v25
  s_lshl_b32 s55, s55, 8
  s_add_u32 s55, s55, 524288
  buffer_load_dwordx2 v[26:27], v24, s[40:43], s55 offen offset:0 sc1
  buffer_load_dwordx2 v[28:29], v24, s[40:43], s55 offen offset:256 sc1
  buffer_load_dwordx2 v[30:31], v24, s[40:43], s55 offen offset:512 sc1
  buffer_load_dwordx2 v[32:33], v24, s[40:43], s55 offen offset:768 sc1
  buffer_load_dwordx2 v[34:35], v24, s[40:43], s55 offen offset:1024 sc1
  buffer_load_dwordx2 v[36:37], v24, s[40:43], s55 offen offset:1280 sc1
  buffer_load_dwordx2 v[38:39], v24, s[40:43], s55 offen offset:1536 sc1
  s_waitcnt lgkmcnt(4)
  s_waitcnt vmcnt(15)
  v_mfma_f32_32x32x16_bf16 v[40:55], v[112:115], a[76:79], v[40:55]
  ds_read_b64_tr_b16 v[104:105], v15 offset:43008
  ds_read_b64_tr_b16 v[106:107], v15 offset:44032
  v_mfma_f32_32x32x16_bf16 v[56:71], v[116:119], a[76:79], v[56:71]
  ds_read_b64_tr_b16 v[108:109], v16 offset:43008
  ds_read_b64_tr_b16 v[110:111], v16 offset:44032
  s_waitcnt lgkmcnt(4)
  s_waitcnt vmcnt(14)
  v_mfma_f32_32x32x16_bf16 v[40:55], v[120:123], a[80:83], v[40:55]
  ds_read_b64_tr_b16 v[112:113], v15 offset:45056
  ds_read_b64_tr_b16 v[114:115], v15 offset:46080
  v_mfma_f32_32x32x16_bf16 v[56:71], v[124:127], a[80:83], v[56:71]
  ds_read_b64_tr_b16 v[116:117], v16 offset:45056
  ds_read_b64_tr_b16 v[118:119], v16 offset:46080
  s_waitcnt lgkmcnt(4)
  s_waitcnt vmcnt(13)
  v_mfma_f32_32x32x16_bf16 v[40:55], v[104:107], a[84:87], v[40:55]
  ds_read_b64_tr_b16 v[120:121], v15 offset:47104
  ds_read_b64_tr_b16 v[122:123], v15 offset:48128
  v_mfma_f32_32x32x16_bf16 v[56:71], v[108:111], a[84:87], v[56:71]
  ds_read_b64_tr_b16 v[124:125], v16 offset:47104
  ds_read_b64_tr_b16 v[126:127], v16 offset:48128
  s_waitcnt lgkmcnt(4)
  s_waitcnt vmcnt(12)
  v_mfma_f32_32x32x16_bf16 v[40:55], v[112:115], a[88:91], v[40:55]
  ds_read_b64_tr_b16 v[104:105], v15 offset:49152
  ds_read_b64_tr_b16 v[106:107], v15 offset:50176
  v_mfma_f32_32x32x16_bf16 v[56:71], v[116:119], a[88:91], v[56:71]
  ds_read_b64_tr_b16 v[108:109], v16 offset:49152
  ds_read_b64_tr_b16 v[110:111], v16 offset:50176
  s_waitcnt lgkmcnt(4)
  s_waitcnt vmcnt(11)
  v_mfma_f32_32x32x16_bf16 v[40:55], v[120:123], a[92:95], v[40:55]
  ds_read_b64_tr_b16 v[112:113], v15 offset:51200
  ds_read_b64_tr_b16 v[114:115], v15 offset:52224
  v_mfma_f32_32x32x16_bf16 v[56:71], v[124:127], a[92:95], v[56:71]
  ds_read_b64_tr_b16 v[116:117], v16 offset:51200
  ds_read_b64_tr_b16 v[118:119], v16 offset:52224
  s_waitcnt lgkmcnt(4)
  s_waitcnt vmcnt(10)
  v_mfma_f32_32x32x16_bf16 v[40:55], v[104:107], a[96:99], v[40:55]
  ds_read_b64_tr_b16 v[120:121], v15 offset:53248
  ds_read_b64_tr_b16 v[122:123], v15 offset:54272
  v_mfma_f32_32x32x16_bf16 v[56:71], v[108:111], a[96:99], v[56:71]
  ds_read_b64_tr_b16 v[124:125], v16 offset:53248
  ds_read_b64_tr_b16 v[126:127], v16 offset:54272
  s_waitcnt lgkmcnt(4)
  s_waitcnt vmcnt(9)
  v_mfma_f32_32x32x16_bf16 v[40:55], v[112:115], a[100:103], v[40:55]
  ds_read_b64_tr_b16 v[104:105], v15 offset:55296
  ds_read_b64_tr_b16 v[106:107], v15 offset:56320
  v_mfma_f32_32x32x16_bf16 v[56:71], v[116:119], a[100:103], v[56:71]
  ds_read_b64_tr_b16 v[108:109], v16 offset:55296
  ds_read_b64_tr_b16 v[110:111], v16 offset:56320
  s_waitcnt lgkmcnt(4)
  s_waitcnt vmcnt(8)
  v_mfma_f32_32x32x16_bf16 v[40:55], v[120:123], a[104:107], v[40:55]
  ds_read_b64_tr_b16 v[112:113], v17 offset:0
  ds_read_b64_tr_b16 v[114:115], v17 offset:1024
  ds_read_b64_tr_b16 v[116:117], v18 offset:0
  ds_read_b64_tr_b16 v[118:119], v18 offset:1024
  ds_read_b128 v[128:131], v160 offset:0
  ds_read_b128 v[132:135], v160 offset:32
  v_mfma_f32_32x32x16_bf16 v[56:71], v[124:127], a[104:107], v[56:71]
  ds_read_b128 v[136:139], v160 offset:64
  ds_read_b128 v[140:143], v160 offset:96
  ds_read_b128 v[144:147], v160 offset:128
  ds_read_b128 v[148:151], v160 offset:160
  ds_read_b128 v[152:155], v160 offset:192
  ds_read_b128 v[156:159], v160 offset:224
  s_waitcnt lgkmcnt(0)
  s_waitcnt vmcnt(7)
  v_mfma_f32_32x32x16_bf16 v[40:55], v[104:107], a[108:111], v[40:55]
  ds_read_b64_tr_b16 v[120:121], v17 offset:2048
  ds_read_b64_tr_b16 v[122:123], v17 offset:3072
  v_mfma_f32_32x32x16_bf16 v[56:71], v[108:111], a[108:111], v[56:71]
  ds_read_b64_tr_b16 v[124:125], v18 offset:2048
  ds_read_b64_tr_b16 v[126:127], v18 offset:3072
  s_waitcnt vmcnt(0)
  v_mov_b32 v162, v26
  v_mov_b32 v163, v27
  v_add_f32 v162, v162, v28
  v_add_f32 v163, v163, v29
  v_add_f32 v162, v162, v30
  v_add_f32 v163, v163, v31
  v_add_f32 v162, v162, v32
  v_add_f32 v163, v163, v33
  v_add_f32 v162, v162, v34
  v_add_f32 v163, v163, v35
  v_add_f32 v162, v162, v36
  v_add_f32 v163, v163, v37
  v_add_f32 v162, v162, v38
  v_add_f32 v163, v163, v39
  v_mov_b32 v24, v162
  s_nop 1
  v_permlane32_swap_b32 v162, v24
  v_add_f32 v162, v162, v24
  v_mov_b32 v25, v163
  s_nop 1
  v_permlane32_swap_b32 v163, v25
  v_add_f32 v163, v163, v25
  v_mul_f32 v162, 0x3b124925, v162
  v_mul_f32 v163, 0x3b124925, v163
  v_fma_f32 v163, -v162, v162, v163
  v_max_f32 v163, 0, v163
  v_add_f32 v163, 0x3727c5ac, v163
  v_rsq_f32 v163, v163
  s_mov_b32 s62, 0xbdd2d3e8
  s_mov_b32 s63, 0xbdd2d3e8
  v_mov_b32 v164, 0xc0135761
  v_mov_b32 v165, 0xc0135761
  s_barrier
  s_mul_i32 s50, s47, 37
  s_lshr_b32 s50, s50, 8
  s_mul_i32 s51, s50, 7
  s_sub_u32 s94, s47, s51
  s_lshl_b32 s95, s46, 2
  s_add_u32 s95, s95, s50
  s_mul_i32 s96, s50, 0
  s_and_b32 s51, s94, 3
  s_mul_i32 s51, s51, 0
  s_add_u32 s96, s96, s51
  s_lshl_b32 s97, s95, 18
  v_lshrrev_b32 v180, 3, v1
  v_and_b32 v181, 7, v1
  v_lshrrev_b32 v182, 4, v1
  v_xor_b32 v183, v181, v182
  v_lshlrev_b32 v183, 4, v183
  v_lshlrev_b32 v180, 12, v180
  v_add_u32 v161, v180, v183
  v_add_u32 v182, 4, v182
  v_xor_b32 v183, v181, v182
  v_lshlrev_b32 v183, 4, v183
  v_add_u32 v170, v180, v183
  s_waitcnt lgkmcnt(8)
  s_waitcnt lgkmcnt(0)
  v_pk_fma_f32 v[40:41], v[162:163], v[128:129], v[40:41] op_sel_hi:[0,1,1] neg_lo:[1,0,0] neg_hi:[1,0,0]
  v_pk_fma_f32 v[42:43], v[162:163], v[130:131], v[42:43] op_sel_hi:[0,1,1] neg_lo:[1,0,0] neg_hi:[1,0,0]
  v_pk_fma_f32 v[44:45], v[162:163], v[132:133], v[44:45] op_sel_hi:[0,1,1] neg_lo:[1,0,0] neg_hi:[1,0,0]
  v_pk_fma_f32 v[46:47], v[162:163], v[134:135], v[46:47] op_sel_hi:[0,1,1] neg_lo:[1,0,0] neg_hi:[1,0,0]
  v_pk_mul_f32 v[40:41], v[40:41], v[162:163] op_sel:[0,1] op_sel_hi:[1,1]
  v_pk_mul_f32 v[42:43], v[42:43], v[162:163] op_sel:[0,1] op_sel_hi:[1,1]
  v_pk_mul_f32 v[44:45], v[44:45], v[162:163] op_sel:[0,1] op_sel_hi:[1,1]
  v_pk_mul_f32 v[46:47], v[46:47], v[162:163] op_sel:[0,1] op_sel_hi:[1,1]
  v_pk_mul_f32 v[172:173], v[40:41], v[40:41]
  v_pk_mul_f32 v[174:175], v[42:43], v[42:43]
  v_pk_mul_f32 v[176:177], v[44:45], v[44:45]
  v_pk_mul_f32 v[178:179], v[46:47], v[46:47]
  v_pk_fma_f32 v[172:173], v[172:173], s[62:63], v[164:165]
  v_pk_fma_f32 v[174:175], v[174:175], s[62:63], v[164:165]
  v_pk_fma_f32 v[176:177], v[176:177], s[62:63], v[164:165]
  v_pk_fma_f32 v[178:179], v[178:179], s[62:63], v[164:165]
  v_pk_mul_f32 v[172:173], v[172:173], v[40:41]
  v_pk_mul_f32 v[174:175], v[174:175], v[42:43]
  v_pk_mul_f32 v[176:177], v[176:177], v[44:45]
  v_pk_mul_f32 v[178:179], v[178:179], v[46:47]
  v_exp_f32 v172, v172
  v_exp_f32 v173, v173
  v_exp_f32 v174, v174
  v_exp_f32 v175, v175
  s_add_u32 s98, s96, 0
  s_and_b32 s98, s98, 15
  s_lshl_b32 s98, s98, 7
  s_add_u32 s98, s98, s97
  s_lshl_b32 s99, s45, 16
  s_add_u32 s98, s98, s99
  s_lshl_b32 s99, s45, 11
  s_add_u32 m0, s99, 81920
  s_add_u32 s99, s98, 2048
  buffer_load_dwordx4 v161, s[24:27], s99 offen lds
  v_exp_f32 v176, v176
  v_exp_f32 v177, v177
  v_exp_f32 v178, v178
  v_exp_f32 v179, v179
  v_pk_add_f32 v[172:173], v[172:173], 1.0 op_sel_hi:[1,0]
  v_pk_add_f32 v[174:175], v[174:175], 1.0 op_sel_hi:[1,0]
  v_pk_add_f32 v[176:177], v[176:177], 1.0 op_sel_hi:[1,0]
  v_pk_add_f32 v[178:179], v[178:179], 1.0 op_sel_hi:[1,0]
  v_rcp_f32 v172, v172
  v_rcp_f32 v173, v173
  v_rcp_f32 v174, v174
  v_rcp_f32 v175, v175
  v_rcp_f32 v176, v176
  v_rcp_f32 v177, v177
  v_rcp_f32 v178, v178
  v_rcp_f32 v179, v179
  v_pk_mul_f32 v[40:41], v[40:41], v[172:173]
  v_pk_mul_f32 v[42:43], v[42:43], v[174:175]
  v_pk_mul_f32 v[44:45], v[44:45], v[176:177]
  v_pk_mul_f32 v[46:47], v[46:47], v[178:179]
  v_pk_mul_f32 v[168:169], v[40:41], v[40:41]
  v_pk_mul_f32 v[166:167], v[40:41], 1.0 op_sel_hi:[1,0]
  v_pk_fma_f32 v[168:169], v[42:43], v[42:43], v[168:169]
  v_pk_add_f32 v[166:167], v[166:167], v[42:43]
  s_lshl_b32 s99, s45, 11
  s_add_u32 m0, s99, 82944
  s_add_u32 s99, s98, 34816
  buffer_load_dwordx4 v170, s[24:27], s99 offen lds
  v_pk_fma_f32 v[168:169], v[44:45], v[44:45], v[168:169]
  v_pk_add_f32 v[166:167], v[166:167], v[44:45]
  v_pk_fma_f32 v[168:169], v[46:47], v[46:47], v[168:169]
  v_pk_add_f32 v[166:167], v[166:167], v[46:47]
  v_pk_fma_f32 v[48:49], v[162:163], v[136:137], v[48:49] op_sel_hi:[0,1,1] neg_lo:[1,0,0] neg_hi:[1,0,0]
  v_pk_fma_f32 v[50:51], v[162:163], v[138:139], v[50:51] op_sel_hi:[0,1,1] neg_lo:[1,0,0] neg_hi:[1,0,0]
  v_pk_fma_f32 v[52:53], v[162:163], v[140:141], v[52:53] op_sel_hi:[0,1,1] neg_lo:[1,0,0] neg_hi:[1,0,0]
  v_pk_fma_f32 v[54:55], v[162:163], v[142:143], v[54:55] op_sel_hi:[0,1,1] neg_lo:[1,0,0] neg_hi:[1,0,0]
  v_pk_mul_f32 v[48:49], v[48:49], v[162:163] op_sel:[0,1] op_sel_hi:[1,1]
  v_pk_mul_f32 v[50:51], v[50:51], v[162:163] op_sel:[0,1] op_sel_hi:[1,1]
  v_pk_mul_f32 v[52:53], v[52:53], v[162:163] op_sel:[0,1] op_sel_hi:[1,1]
  v_pk_mul_f32 v[54:55], v[54:55], v[162:163] op_sel:[0,1] op_sel_hi:[1,1]
  v_pk_mul_f32 v[172:173], v[48:49], v[48:49]
  v_pk_mul_f32 v[174:175], v[50:51], v[50:51]
  v_pk_mul_f32 v[176:177], v[52:53], v[52:53]
  v_pk_mul_f32 v[178:179], v[54:55], v[54:55]
  v_pk_fma_f32 v[172:173], v[172:173], s[62:63], v[164:165]
  v_pk_fma_f32 v[174:175], v[174:175], s[62:63], v[164:165]
  v_pk_fma_f32 v[176:177], v[176:177], s[62:63], v[164:165]
  v_pk_fma_f32 v[178:179], v[178:179], s[62:63], v[164:165]
  v_pk_mul_f32 v[172:173], v[172:173], v[48:49]
  v_pk_mul_f32 v[174:175], v[174:175], v[50:51]
  v_pk_mul_f32 v[176:177], v[176:177], v[52:53]
  v_pk_mul_f32 v[178:179], v[178:179], v[54:55]
  s_add_u32 s98, s96, 1
  s_and_b32 s98, s98, 15
  s_lshl_b32 s98, s98, 7
  s_add_u32 s98, s98, s97
  s_lshl_b32 s99, s45, 16
  s_add_u32 s98, s98, s99
  s_lshl_b32 s99, s45, 11
  s_add_u32 m0, s99, 90112
  s_add_u32 s99, s98, 2048
  buffer_load_dwordx4 v161, s[24:27], s99 offen lds
  v_exp_f32 v172, v172
  v_exp_f32 v173, v173
  v_exp_f32 v174, v174
  v_exp_f32 v175, v175
  v_exp_f32 v176, v176
  v_exp_f32 v177, v177
  v_exp_f32 v178, v178
  v_exp_f32 v179, v179
  v_pk_add_f32 v[172:173], v[172:173], 1.0 op_sel_hi:[1,0]
  v_pk_add_f32 v[174:175], v[174:175], 1.0 op_sel_hi:[1,0]
  v_pk_add_f32 v[176:177], v[176:177], 1.0 op_sel_hi:[1,0]
  v_pk_add_f32 v[178:179], v[178:179], 1.0 op_sel_hi:[1,0]
  v_rcp_f32 v172, v172
  v_rcp_f32 v173, v173
  v_rcp_f32 v174, v174
  v_rcp_f32 v175, v175
  v_rcp_f32 v176, v176
  v_rcp_f32 v177, v177
  v_rcp_f32 v178, v178
  v_rcp_f32 v179, v179
  v_pk_mul_f32 v[48:49], v[48:49], v[172:173]
  v_pk_mul_f32 v[50:51], v[50:51], v[174:175]
  v_pk_mul_f32 v[52:53], v[52:53], v[176:177]
  v_pk_mul_f32 v[54:55], v[54:55], v[178:179]
  s_lshl_b32 s99, s45, 11
  s_add_u32 m0, s99, 91136
  s_add_u32 s99, s98, 34816
  buffer_load_dwordx4 v170, s[24:27], s99 offen lds
  v_pk_fma_f32 v[168:169], v[48:49], v[48:49], v[168:169]
  v_pk_add_f32 v[166:167], v[166:167], v[48:49]
  v_pk_fma_f32 v[168:169], v[50:51], v[50:51], v[168:169]
  v_pk_add_f32 v[166:167], v[166:167], v[50:51]
  v_pk_fma_f32 v[168:169], v[52:53], v[52:53], v[168:169]
  v_pk_add_f32 v[166:167], v[166:167], v[52:53]
  v_pk_fma_f32 v[168:169], v[54:55], v[54:55], v[168:169]
  v_pk_add_f32 v[166:167], v[166:167], v[54:55]
  v_pk_fma_f32 v[56:57], v[162:163], v[144:145], v[56:57] op_sel_hi:[0,1,1] neg_lo:[1,0,0] neg_hi:[1,0,0]
  v_pk_fma_f32 v[58:59], v[162:163], v[146:147], v[58:59] op_sel_hi:[0,1,1] neg_lo:[1,0,0] neg_hi:[1,0,0]
  v_pk_fma_f32 v[60:61], v[162:163], v[148:149], v[60:61] op_sel_hi:[0,1,1] neg_lo:[1,0,0] neg_hi:[1,0,0]
  v_pk_fma_f32 v[62:63], v[162:163], v[150:151], v[62:63] op_sel_hi:[0,1,1] neg_lo:[1,0,0] neg_hi:[1,0,0]
  v_pk_mul_f32 v[56:57], v[56:57], v[162:163] op_sel:[0,1] op_sel_hi:[1,1]
  v_pk_mul_f32 v[58:59], v[58:59], v[162:163] op_sel:[0,1] op_sel_hi:[1,1]
  v_pk_mul_f32 v[60:61], v[60:61], v[162:163] op_sel:[0,1] op_sel_hi:[1,1]
  v_pk_mul_f32 v[62:63], v[62:63], v[162:163] op_sel:[0,1] op_sel_hi:[1,1]
  v_pk_mul_f32 v[172:173], v[56:57], v[56:57]
  v_pk_mul_f32 v[174:175], v[58:59], v[58:59]
  v_pk_mul_f32 v[176:177], v[60:61], v[60:61]
  v_pk_mul_f32 v[178:179], v[62:63], v[62:63]
  v_pk_fma_f32 v[172:173], v[172:173], s[62:63], v[164:165]
  v_pk_fma_f32 v[174:175], v[174:175], s[62:63], v[164:165]
  v_pk_fma_f32 v[176:177], v[176:177], s[62:63], v[164:165]
  v_pk_fma_f32 v[178:179], v[178:179], s[62:63], v[164:165]
  s_add_u32 s98, s96, 2
  s_and_b32 s98, s98, 15
  s_lshl_b32 s98, s98, 7
  s_add_u32 s98, s98, s97
  s_lshl_b32 s99, s45, 16
  s_add_u32 s98, s98, s99
  s_lshl_b32 s99, s45, 11
  s_add_u32 m0, s99, 98304
  s_add_u32 s99, s98, 2048
  buffer_load_dwordx4 v161, s[24:27], s99 offen lds
  v_pk_mul_f32 v[172:173], v[172:173], v[56:57]
  v_pk_mul_f32 v[174:175], v[174:175], v[58:59]
  v_pk_mul_f32 v[176:177], v[176:177], v[60:61]
  v_pk_mul_f32 v[178:179], v[178:179], v[62:63]
  v_exp_f32 v172, v172
  v_exp_f32 v173, v173
  v_exp_f32 v174, v174
  v_exp_f32 v175, v175
  v_exp_f32 v176, v176
  v_exp_f32 v177, v177
  v_exp_f32 v178, v178
  v_exp_f32 v179, v179
  v_pk_add_f32 v[172:173], v[172:173], 1.0 op_sel_hi:[1,0]
  v_pk_add_f32 v[174:175], v[174:175], 1.0 op_sel_hi:[1,0]
  v_pk_add_f32 v[176:177], v[176:177], 1.0 op_sel_hi:[1,0]
  v_pk_add_f32 v[178:179], v[178:179], 1.0 op_sel_hi:[1,0]
  v_rcp_f32 v172, v172
  v_rcp_f32 v173, v173
  v_rcp_f32 v174, v174
  v_rcp_f32 v175, v175
  v_rcp_f32 v176, v176
  v_rcp_f32 v177, v177
  v_rcp_f32 v178, v178
  v_rcp_f32 v179, v179
  s_lshl_b32 s99, s45, 11
  s_add_u32 m0, s99, 99328
  s_add_u32 s99, s98, 34816
  buffer_load_dwordx4 v170, s[24:27], s99 offen lds
  v_pk_mul_f32 v[56:57], v[56:57], v[172:173]
  v_pk_mul_f32 v[58:59], v[58:59], v[174:175]
  v_pk_mul_f32 v[60:61], v[60:61], v[176:177]
  v_pk_mul_f32 v[62:63], v[62:63], v[178:179]
  v_pk_fma_f32 v[168:169], v[56:57], v[56:57], v[168:169]
  v_pk_add_f32 v[166:167], v[166:167], v[56:57]
  v_pk_fma_f32 v[168:169], v[58:59], v[58:59], v[168:169]
  v_pk_add_f32 v[166:167], v[166:167], v[58:59]
  v_pk_fma_f32 v[168:169], v[60:61], v[60:61], v[168:169]
  v_pk_add_f32 v[166:167], v[166:167], v[60:61]
  v_pk_fma_f32 v[168:169], v[62:63], v[62:63], v[168:169]
  v_pk_add_f32 v[166:167], v[166:167], v[62:63]
  v_pk_fma_f32 v[64:65], v[162:163], v[152:153], v[64:65] op_sel_hi:[0,1,1] neg_lo:[1,0,0] neg_hi:[1,0,0]
  v_pk_fma_f32 v[66:67], v[162:163], v[154:155], v[66:67] op_sel_hi:[0,1,1] neg_lo:[1,0,0] neg_hi:[1,0,0]
  v_pk_fma_f32 v[68:69], v[162:163], v[156:157], v[68:69] op_sel_hi:[0,1,1] neg_lo:[1,0,0] neg_hi:[1,0,0]
  v_pk_fma_f32 v[70:71], v[162:163], v[158:159], v[70:71] op_sel_hi:[0,1,1] neg_lo:[1,0,0] neg_hi:[1,0,0]
  v_pk_mul_f32 v[64:65], v[64:65], v[162:163] op_sel:[0,1] op_sel_hi:[1,1]
  v_pk_mul_f32 v[66:67], v[66:67], v[162:163] op_sel:[0,1] op_sel_hi:[1,1]
  v_pk_mul_f32 v[68:69], v[68:69], v[162:163] op_sel:[0,1] op_sel_hi:[1,1]
  v_pk_mul_f32 v[70:71], v[70:71], v[162:163] op_sel:[0,1] op_sel_hi:[1,1]
  v_pk_mul_f32 v[172:173], v[64:65], v[64:65]
  v_pk_mul_f32 v[174:175], v[66:67], v[66:67]
  v_pk_mul_f32 v[176:177], v[68:69], v[68:69]
  v_pk_mul_f32 v[178:179], v[70:71], v[70:71]
  v_pk_fma_f32 v[172:173], v[172:173], s[62:63], v[164:165]
  v_pk_fma_f32 v[174:175], v[174:175], s[62:63], v[164:165]
  v_pk_fma_f32 v[176:177], v[176:177], s[62:63], v[164:165]
  v_pk_fma_f32 v[178:179], v[178:179], s[62:63], v[164:165]
  v_pk_mul_f32 v[172:173], v[172:173], v[64:65]
  v_pk_mul_f32 v[174:175], v[174:175], v[66:67]
  v_pk_mul_f32 v[176:177], v[176:177], v[68:69]
  v_pk_mul_f32 v[178:179], v[178:179], v[70:71]
  v_exp_f32 v172, v172
  v_exp_f32 v173, v173
  v_exp_f32 v174, v174
  v_exp_f32 v175, v175
  v_exp_f32 v176, v176
  v_exp_f32 v177, v177
  v_exp_f32 v178, v178
  v_exp_f32 v179, v179
  v_pk_add_f32 v[172:173], v[172:173], 1.0 op_sel_hi:[1,0]
  v_pk_add_f32 v[174:175], v[174:175], 1.0 op_sel_hi:[1,0]
  v_pk_add_f32 v[176:177], v[176:177], 1.0 op_sel_hi:[1,0]
  v_pk_add_f32 v[178:179], v[178:179], 1.0 op_sel_hi:[1,0]
  v_rcp_f32 v172, v172
  v_rcp_f32 v173, v173
  v_rcp_f32 v174, v174
  v_rcp_f32 v175, v175
  v_rcp_f32 v176, v176
  v_rcp_f32 v177, v177
  v_rcp_f32 v178, v178
  v_rcp_f32 v179, v179
  v_pk_mul_f32 v[64:65], v[64:65], v[172:173]
  v_pk_mul_f32 v[66:67], v[66:67], v[174:175]
  v_pk_mul_f32 v[68:69], v[68:69], v[176:177]
  v_pk_mul_f32 v[70:71], v[70:71], v[178:179]
  v_pk_fma_f32 v[168:169], v[64:65], v[64:65], v[168:169]
  v_pk_add_f32 v[166:167], v[166:167], v[64:65]
  v_pk_fma_f32 v[168:169], v[66:67], v[66:67], v[168:169]
  v_pk_add_f32 v[166:167], v[166:167], v[66:67]
  v_pk_fma_f32 v[168:169], v[68:69], v[68:69], v[168:169]
  v_pk_add_f32 v[166:167], v[166:167], v[68:69]
  v_pk_fma_f32 v[168:169], v[70:71], v[70:71], v[168:169]
  v_pk_add_f32 v[166:167], v[166:167], v[70:71]
  v_add_f32 v196, v166, v167
  v_add_f32 v197, v168, v169
  v_mov_b32 v24, v196
  s_nop 1
  v_permlane32_swap_b32 v196, v24
  v_add_f32 v196, v196, v24
  v_mov_b32 v25, v197
  s_nop 1
  v_permlane32_swap_b32 v197, v25
  v_add_f32 v197, v197, v25
  v_mov_b32 v198, s44
  v_mov_b32 v199, s44
  s_mul_i32 s55, s48, 14
  s_add_u32 s55, s55, s49
  s_lshl_b32 s55, s55, 11
  s_lshl_b32 s50, s45, 9
  s_add_u32 s55, s55, s50
  s_add_u32 s55, s55, 65536
  v_lshlrev_b32 v25, 4, v3
  buffer_store_dwordx4 v[196:199], v25, s[40:43], s55 offen sc1
  v_mul_u32_u24 v24, 14336, v4
  v_add_u32 v25, v25, v24
  s_mul_i32 s55, s48, 14
  s_lshl_b32 s55, s55, 11
  s_lshl_b32 s50, s45, 9
  s_add_u32 s55, s55, s50
  s_add_u32 s55, s55, 65536
  s_waitcnt lgkmcnt(0)
  v_mfma_f32_32x32x16_bf16 v[72:87], v[112:115], a[0:3], 0
  ds_read_b64_tr_b16 v[104:105], v17 offset:4096
  ds_read_b64_tr_b16 v[106:107], v17 offset:5120
  ds_read_b64_tr_b16 v[108:109], v18 offset:4096
  ds_read_b64_tr_b16 v[110:111], v18 offset:5120
  v_mfma_f32_32x32x16_bf16 v[88:103], v[116:119], a[0:3], 0
  s_lshl_b32 s68, s45, 12
  s_add_u32 s68, s68, 57856
  v_lshrrev_b32 v171, 1, v3
  s_waitcnt lgkmcnt(4)
  v_mfma_f32_32x32x16_bf16 v[72:87], v[120:123], a[4:7], v[72:87]
  ds_read_b64_tr_b16 v[112:113], v17 offset:6144
  ds_read_b64_tr_b16 v[114:115], v17 offset:7168
  ds_read_b64_tr_b16 v[116:117], v18 offset:6144
  ds_read_b64_tr_b16 v[118:119], v18 offset:7168
  v_mfma_f32_32x32x16_bf16 v[88:103], v[124:127], a[4:7], v[88:103]
  v_and_b32 v171, 7, v171
  v_xor_b32 v171, v171, v4
  v_lshlrev_b32 v171, 3, v171
  s_waitcnt lgkmcnt(4)
  v_mfma_f32_32x32x16_bf16 v[72:87], v[104:107], a[8:11], v[72:87]
  ds_read_b64_tr_b16 v[120:121], v17 offset:8192
  ds_read_b64_tr_b16 v[122:123], v17 offset:9216
  ds_read_b64_tr_b16 v[124:125], v18 offset:8192
  ds_read_b64_tr_b16 v[126:127], v18 offset:9216
  v_lshlrev_b32 v228, 6, v3
  v_add_u32 v228, v228, v171
  v_add_u32 v228, s68, v228
  v_mfma_f32_32x32x16_bf16 v[88:103], v[108:111], a[8:11], v[88:103]
  s_add_u32 s98, s96, 3
  s_and_b32 s98, s98, 15
  s_lshl_b32 s98, s98, 7
  s_add_u32 s98, s98, s97
  s_lshl_b32 s99, s45, 16
  s_add_u32 s98, s98, s99
  s_lshl_b32 s99, s45, 11
  s_add_u32 m0, s99, 106496
  s_add_u32 s99, s98, 2048
  buffer_load_dwordx4 v161, s[24:27], s99 offen lds
  s_waitcnt lgkmcnt(4)
  v_mfma_f32_32x32x16_bf16 v[72:87], v[112:115], a[12:15], v[72:87]
  ds_read_b64_tr_b16 v[104:105], v17 offset:10240
  ds_read_b64_tr_b16 v[106:107], v17 offset:11264
  ds_read_b64_tr_b16 v[108:109], v18 offset:10240
  ds_read_b64_tr_b16 v[110:111], v18 offset:11264
  v_xor_b32 v229, 16, v228
  v_xor_b32 v230, 32, v228
  v_xor_b32 v231, 48, v228
  v_mfma_f32_32x32x16_bf16 v[88:103], v[116:119], a[12:15], v[88:103]
  s_lshl_b32 s99, s45, 11
  s_add_u32 m0, s99, 107520
  s_add_u32 s99, s98, 34816
  buffer_load_dwordx4 v170, s[24:27], s99 offen lds
  s_waitcnt lgkmcnt(4)
  v_mfma_f32_32x32x16_bf16 v[72:87], v[120:123], a[16:19], v[72:87]
  ds_read_b64_tr_b16 v[112:113], v17 offset:12288
  ds_read_b64_tr_b16 v[114:115], v17 offset:13312
  ds_read_b64_tr_b16 v[116:117], v18 offset:12288
  ds_read_b64_tr_b16 v[118:119], v18 offset:13312
  v_lshrrev_b32 v171, 2, v1
  v_and_b32 v171, 3, v171
  v_lshlrev_b32 v234, 3, v4
  v_mfma_f32_32x32x16_bf16 v[88:103], v[124:127], a[16:19], v[88:103]
  s_add_u32 s98, s96, 4
  s_and_b32 s98, s98, 15
  s_lshl_b32 s98, s98, 7
  s_add_u32 s98, s98, s97
  s_lshl_b32 s99, s45, 16
  s_add_u32 s98, s98, s99
  s_lshl_b32 s99, s45, 11
  s_add_u32 m0, s99, 114688
  s_add_u32 s99, s98, 2048
  buffer_load_dwordx4 v161, s[24:27], s99 offen lds
  s_waitcnt lgkmcnt(4)
  v_mfma_f32_32x32x16_bf16 v[72:87], v[104:107], a[20:23], v[72:87]
  ds_read_b64_tr_b16 v[120:121], v17 offset:14336
  ds_read_b64_tr_b16 v[122:123], v17 offset:15360
  ds_read_b64_tr_b16 v[124:125], v18 offset:14336
  ds_read_b64_tr_b16 v[126:127], v18 offset:15360
  v_add_u32 v234, v234, v171
  v_lshlrev_b32 v232, 6, v234
  v_lshrrev_b32 v171, 1, v171
  v_mfma_f32_32x32x16_bf16 v[88:103], v[108:111], a[20:23], v[88:103]
  s_lshl_b32 s99, s45, 11
  s_add_u32 m0, s99, 115712
  s_add_u32 s99, s98, 34816
  buffer_load_dwordx4 v170, s[24:27], s99 offen lds
  s_waitcnt lgkmcnt(4)
  v_mfma_f32_32x32x16_bf16 v[72:87], v[112:115], a[24:27], v[72:87]
  ds_read_b64_tr_b16 v[104:105], v17 offset:16384
  ds_read_b64_tr_b16 v[106:107], v17 offset:17408
  ds_read_b64_tr_b16 v[108:109], v18 offset:16384
  ds_read_b64_tr_b16 v[110:111], v18 offset:17408
  v_lshlrev_b32 v234, 2, v4
  v_add_u32 v171, v171, v234
  v_lshrrev_b32 v234, 4, v1
  v_mfma_f32_32x32x16_bf16 v[88:103], v[116:119], a[24:27], v[88:103]
  s_add_u32 s98, s96, 5
  s_and_b32 s98, s98, 15
  s_lshl_b32 s98, s98, 7
  s_add_u32 s98, s98, s97
  s_lshl_b32 s99, s45, 16
  s_add_u32 s98, s98, s99
  s_lshl_b32 s99, s45, 11
  s_add_u32 m0, s99, 122880
  s_add_u32 s99, s98, 2048
  buffer_load_dwordx4 v161, s[24:27], s99 offen lds
  s_waitcnt lgkmcnt(4)
  v_mfma_f32_32x32x16_bf16 v[72:87], v[120:123], a[28:31], v[72:87]
  ds_read_b64_tr_b16 v[112:113], v17 offset:18432
  ds_read_b64_tr_b16 v[114:115], v17 offset:19456
  ds_read_b64_tr_b16 v[116:117], v18 offset:18432
  ds_read_b64_tr_b16 v[118:119], v18 offset:19456
  v_and_b32 v234, 1, v234
  v_lshlrev_b32 v234, 2, v234
  v_and_b32 v235, 3, v1
  v_mfma_f32_32x32x16_bf16 v[88:103], v[124:127], a[28:31], v[88:103]
  s_lshl_b32 s99, s45, 11
  s_add_u32 m0, s99, 123904
  s_add_u32 s99, s98, 34816
  buffer_load_dwordx4 v170, s[24:27], s99 offen lds
  s_waitcnt lgkmcnt(4)
  v_mfma_f32_32x32x16_bf16 v[72:87], v[104:107], a[32:35], v[72:87]
  ds_read_b64_tr_b16 v[120:121], v17 offset:20480
  ds_read_b64_tr_b16 v[122:123], v17 offset:21504
  ds_read_b64_tr_b16 v[124:125], v18 offset:20480
  ds_read_b64_tr_b16 v[126:127], v18 offset:21504
  v_add_u32 v234, v234, v235
  v_xor_b32 v171, v171, v234
  v_lshlrev_b32 v171, 3, v171
  v_mfma_f32_32x32x16_bf16 v[88:103], v[108:111], a[32:35], v[88:103]
  s_add_u32 s98, s96, 6
  s_and_b32 s98, s98, 15
  s_lshl_b32 s98, s98, 7
  s_add_u32 s98, s98, s97
  s_lshl_b32 s99, s45, 16
  s_add_u32 s98, s98, s99
  s_lshl_b32 s99, s45, 11
  s_add_u32 m0, s99, 131072
  s_add_u32 s99, s98, 2048
  buffer_load_dwordx4 v161, s[24:27], s99 offen lds
  s_waitcnt lgkmcnt(4)
  v_mfma_f32_32x32x16_bf16 v[72:87], v[112:115], a[36:39], v[72:87]
  ds_read_b64_tr_b16 v[104:105], v17 offset:22528
  ds_read_b64_tr_b16 v[106:107], v17 offset:23552
  ds_read_b64_tr_b16 v[108:109], v18 offset:22528
  ds_read_b64_tr_b16 v[110:111], v18 offset:23552
  v_add_u32 v232, v232, v171
  v_add_u32 v232, s68, v232
  v_xor_b32 v233, 16, v232
  v_mfma_f32_32x32x16_bf16 v[88:103], v[116:119], a[36:39], v[88:103]
  s_lshl_b32 s99, s45, 11
  s_add_u32 m0, s99, 132096
  s_add_u32 s99, s98, 34816
  buffer_load_dwordx4 v170, s[24:27], s99 offen lds
  s_waitcnt lgkmcnt(4)
  v_mfma_f32_32x32x16_bf16 v[72:87], v[120:123], a[40:43], v[72:87]
  ds_read_b64_tr_b16 v[112:113], v17 offset:24576
  ds_read_b64_tr_b16 v[114:115], v17 offset:25600
  ds_read_b64_tr_b16 v[116:117], v18 offset:24576
  ds_read_b64_tr_b16 v[118:119], v18 offset:25600
  v_mfma_f32_32x32x16_bf16 v[88:103], v[124:127], a[40:43], v[88:103]
  s_add_u32 s98, s96, 7
  s_and_b32 s98, s98, 15
  s_lshl_b32 s98, s98, 7
  s_add_u32 s98, s98, s97
  s_lshl_b32 s99, s45, 16
  s_add_u32 s98, s98, s99
  s_lshl_b32 s99, s45, 11
  s_add_u32 m0, s99, 147456
  s_add_u32 s99, s98, 0
  buffer_load_dwordx4 v161, s[24:27], s99 offen lds
  s_waitcnt lgkmcnt(4)
  v_mfma_f32_32x32x16_bf16 v[72:87], v[104:107], a[44:47], v[72:87]
  ds_read_b64_tr_b16 v[120:121], v17 offset:26624
  ds_read_b64_tr_b16 v[122:123], v17 offset:27648
  ds_read_b64_tr_b16 v[124:125], v18 offset:26624
  ds_read_b64_tr_b16 v[126:127], v18 offset:27648
  v_mfma_f32_32x32x16_bf16 v[88:103], v[108:111], a[44:47], v[88:103]
  s_lshl_b32 s99, s45, 11
  s_add_u32 m0, s99, 148480
  s_add_u32 s99, s98, 32768
  buffer_load_dwordx4 v170, s[24:27], s99 offen lds
  s_waitcnt lgkmcnt(4)
  v_mfma_f32_32x32x16_bf16 v[72:87], v[112:115], a[48:51], v[72:87]
  ds_read_b64_tr_b16 v[104:105], v17 offset:28672
  ds_read_b64_tr_b16 v[106:107], v17 offset:29696
  ds_read_b64_tr_b16 v[108:109], v18 offset:28672
  ds_read_b64_tr_b16 v[110:111], v18 offset:29696
  s_mov_b32 s54, s55
  buffer_load_dwordx4 v[200:203], v25, s[40:43], s54 offen offset:0 sc1
  buffer_load_dwordx4 v[204:207], v25, s[40:43], s54 offen offset:2048 sc1
  s_add_u32 s54, s54, 4096
  buffer_load_dwordx4 v[208:211], v25, s[40:43], s54 offen offset:0 sc1
  buffer_load_dwordx4 v[212:215], v25, s[40:43], s54 offen offset:2048 sc1
  s_add_u32 s54, s54, 4096
  buffer_load_dwordx4 v[216:219], v25, s[40:43], s54 offen offset:0 sc1
  buffer_load_dwordx4 v[220:223], v25, s[40:43], s54 offen offset:2048 sc1
  s_add_u32 s54, s54, 4096
  buffer_load_dwordx4 v[224:227], v25, s[40:43], s54 offen offset:0 sc1
  v_mfma_f32_32x32x16_bf16 v[88:103], v[116:119], a[48:51], v[88:103]
  s_add_u32 s98, s96, 7
  s_and_b32 s98, s98, 15
  s_lshl_b32 s98, s98, 7
  s_add_u32 s98, s98, s97
  s_lshl_b32 s99, s45, 16
  s_add_u32 s98, s98, s99
  s_lshl_b32 s99, s45, 11
  s_add_u32 m0, s99, 139264
  s_add_u32 s99, s98, 2048
  buffer_load_dwordx4 v161, s[24:27], s99 offen lds
  s_waitcnt lgkmcnt(4)
  v_mfma_f32_32x32x16_bf16 v[72:87], v[120:123], a[52:55], v[72:87]
  ds_read_b64_tr_b16 v[112:113], v17 offset:30720
  ds_read_b64_tr_b16 v[114:115], v17 offset:31744
  ds_read_b64_tr_b16 v[116:117], v18 offset:30720
  ds_read_b64_tr_b16 v[118:119], v18 offset:31744
  v_mfma_f32_32x32x16_bf16 v[88:103], v[124:127], a[52:55], v[88:103]
  s_lshl_b32 s99, s45, 11
  s_add_u32 m0, s99, 140288
  s_add_u32 s99, s98, 34816
  buffer_load_dwordx4 v170, s[24:27], s99 offen lds
  s_waitcnt lgkmcnt(4)
  v_mfma_f32_32x32x16_bf16 v[72:87], v[104:107], a[56:59], v[72:87]
  ds_read_b64_tr_b16 v[120:121], v17 offset:32768
  ds_read_b64_tr_b16 v[122:123], v17 offset:33792
  v_mfma_f32_32x32x16_bf16 v[88:103], v[108:111], a[56:59], v[88:103]
  ds_read_b64_tr_b16 v[124:125], v18 offset:32768
  ds_read_b64_tr_b16 v[126:127], v18 offset:33792
  s_waitcnt lgkmcnt(4)
  v_mfma_f32_32x32x16_bf16 v[72:87], v[112:115], a[60:63], v[72:87]
  ds_read_b64_tr_b16 v[104:105], v17 offset:34816
  ds_read_b64_tr_b16 v[106:107], v17 offset:35840
  v_mfma_f32_32x32x16_bf16 v[88:103], v[116:119], a[60:63], v[88:103]
  ds_read_b64_tr_b16 v[108:109], v18 offset:34816
  ds_read_b64_tr_b16 v[110:111], v18 offset:35840
  s_waitcnt lgkmcnt(4)
  v_mfma_f32_32x32x16_bf16 v[72:87], v[120:123], a[64:67], v[72:87]
  ds_read_b64_tr_b16 v[112:113], v17 offset:36864
  ds_read_b64_tr_b16 v[114:115], v17 offset:37888
  v_mfma_f32_32x32x16_bf16 v[88:103], v[124:127], a[64:67], v[88:103]
  ds_read_b64_tr_b16 v[116:117], v18 offset:36864
  ds_read_b64_tr_b16 v[118:119], v18 offset:37888
  s_waitcnt lgkmcnt(4)
  v_mfma_f32_32x32x16_bf16 v[72:87], v[104:107], a[68:71], v[72:87]
  ds_read_b64_tr_b16 v[120:121], v17 offset:38912
  ds_read_b64_tr_b16 v[122:123], v17 offset:39936
  v_mfma_f32_32x32x16_bf16 v[88:103], v[108:111], a[68:71], v[88:103]
  ds_read_b64_tr_b16 v[124:125], v18 offset:38912
  ds_read_b64_tr_b16 v[126:127], v18 offset:39936
  s_waitcnt lgkmcnt(4)
  v_mfma_f32_32x32x16_bf16 v[72:87], v[112:115], a[72:75], v[72:87]
  ds_read_b64_tr_b16 v[104:105], v17 offset:40960
  ds_read_b64_tr_b16 v[106:107], v17 offset:41984
  v_mfma_f32_32x32x16_bf16 v[88:103], v[116:119], a[72:75], v[88:103]
  ds_read_b64_tr_b16 v[108:109], v18 offset:40960
  ds_read_b64_tr_b16 v[110:111], v18 offset:41984
  s_waitcnt lgkmcnt(4)
  v_mfma_f32_32x32x16_bf16 v[72:87], v[120:123], a[76:79], v[72:87]
  ds_read_b64_tr_b16 v[112:113], v17 offset:43008
  ds_read_b64_tr_b16 v[114:115], v17 offset:44032
  v_mfma_f32_32x32x16_bf16 v[88:103], v[124:127], a[76:79], v[88:103]
  ds_read_b64_tr_b16 v[116:117], v18 offset:43008
  ds_read_b64_tr_b16 v[118:119], v18 offset:44032
  s_waitcnt vmcnt(2)
  s_mov_b32 s70, 0
L_sp_53:
  v_xor_b32 v24, s44, v202
  v_xor_b32 v196, s44, v206
  v_or_b32 v24, v24, v196
  v_xor_b32 v196, s44, v210
  v_or_b32 v24, v24, v196
  v_xor_b32 v196, s44, v214
  v_or_b32 v24, v24, v196
  v_xor_b32 v196, s44, v218
  v_or_b32 v24, v24, v196
  v_xor_b32 v196, s44, v222
  v_or_b32 v24, v24, v196
  v_xor_b32 v196, s44, v226
  v_or_b32 v24, v24, v196
  v_cmp_ne_u32 vcc, 0, v24
  s_cbranch_vccz L_sd_54
  s_mov_b32 s54, s55
  buffer_load_dwordx4 v[200:203], v25, s[40:43], s54 offen offset:0 sc1
  buffer_load_dwordx4 v[204:207], v25, s[40:43], s54 offen offset:2048 sc1
  s_add_u32 s54, s54, 4096
  buffer_load_dwordx4 v[208:211], v25, s[40:43], s54 offen offset:0 sc1
  buffer_load_dwordx4 v[212:215], v25, s[40:43], s54 offen offset:2048 sc1
  s_add_u32 s54, s54, 4096
  buffer_load_dwordx4 v[216:219], v25, s[40:43], s54 offen offset:0 sc1
  buffer_load_dwordx4 v[220:223], v25, s[40:43], s54 offen offset:2048 sc1
  s_add_u32 s54, s54, 4096
  buffer_load_dwordx4 v[224:227], v25, s[40:43], s54 offen offset:0 sc1
  s_waitcnt vmcnt(0)
  s_add_u32 s70, s70, 1
  s_cmp_lt_u32 s70, 20000
  s_cbranch_scc1 L_sp_53
L_sd_54:
  v_pk_add_f32 v[200:201], v[200:201], v[204:205]
  v_pk_add_f32 v[200:201], v[200:201], v[208:209]
  v_pk_add_f32 v[200:201], v[200:201], v[212:213]
  v_pk_add_f32 v[200:201], v[200:201], v[216:217]
  v_pk_add_f32 v[200:201], v[200:201], v[220:221]
  v_pk_add_f32 v[200:201], v[200:201], v[224:225]
  v_mov_b32 v24, v200
  s_nop 1
  v_permlane32_swap_b32 v200, v24
  v_add_f32 v200, v200, v24
  v_mov_b32 v196, v201
  s_nop 1
  v_permlane32_swap_b32 v201, v196
  v_add_f32 v201, v201, v196
  v_mul_f32 v200, 0x3a924925, v200
  v_mul_f32 v201, 0x3a924925, v201
  v_fma_f32 v201, -v200, v200, v201
  v_max_f32 v201, 0, v201
  v_add_f32 v201, 0x3727c5ac, v201
  v_rsq_f32 v201, v201
  s_nop 0
  v_mul_f32 v200, v200, v201
  v_pk_fma_f32 v[40:41], v[40:41], v[200:201], v[200:201] op_sel:[0,1,0] op_sel_hi:[1,1,0] neg_lo:[0,0,1] neg_hi:[0,0,1]
  v_pk_fma_f32 v[42:43], v[42:43], v[200:201], v[200:201] op_sel:[0,1,0] op_sel_hi:[1,1,0] neg_lo:[0,0,1] neg_hi:[0,0,1]
  v_pk_fma_f32 v[44:45], v[44:45], v[200:201], v[200:201] op_sel:[0,1,0] op_sel_hi:[1,1,0] neg_lo:[0,0,1] neg_hi:[0,0,1]
  v_pk_fma_f32 v[46:47], v[46:47], v[200:201], v[200:201] op_sel:[0,1,0] op_sel_hi:[1,1,0] neg_lo:[0,0,1] neg_hi:[0,0,1]
  v_pk_fma_f32 v[48:49], v[48:49], v[200:201], v[200:201] op_sel:[0,1,0] op_sel_hi:[1,1,0] neg_lo:[0,0,1] neg_hi:[0,0,1]
  v_pk_fma_f32 v[50:51], v[50:51], v[200:201], v[200:201] op_sel:[0,1,0] op_sel_hi:[1,1,0] neg_lo:[0,0,1] neg_hi:[0,0,1]
  v_pk_fma_f32 v[52:53], v[52:53], v[200:201], v[200:201] op_sel:[0,1,0] op_sel_hi:[1,1,0] neg_lo:[0,0,1] neg_hi:[0,0,1]
  v_pk_fma_f32 v[54:55], v[54:55], v[200:201], v[200:201] op_sel:[0,1,0] op_sel_hi:[1,1,0] neg_lo:[0,0,1] neg_hi:[0,0,1]
  v_cvt_pk_bf16_f32 v204, v40, v41
  v_cvt_pk_bf16_f32 v205, v42, v43
  v_cvt_pk_bf16_f32 v206, v44, v45
  v_cvt_pk_bf16_f32 v207, v46, v47
  v_cvt_pk_bf16_f32 v208, v48, v49
  v_cvt_pk_bf16_f32 v209, v50, v51
  v_cvt_pk_bf16_f32 v210, v52, v53
  v_cvt_pk_bf16_f32 v211, v54, v55
  ds_write_b64 v228, v[204:205] offset:0
  ds_write_b64 v229, v[206:207] offset:0
  ds_write_b64 v230, v[208:209] offset:0
  ds_write_b64 v231, v[210:211] offset:0
  v_pk_fma_f32 v[56:57], v[56:57], v[200:201], v[200:201] op_sel:[0,1,0] op_sel_hi:[1,1,0] neg_lo:[0,0,1] neg_hi:[0,0,1]
  v_pk_fma_f32 v[58:59], v[58:59], v[200:201], v[200:201] op_sel:[0,1,0] op_sel_hi:[1,1,0] neg_lo:[0,0,1] neg_hi:[0,0,1]
  v_pk_fma_f32 v[60:61], v[60:61], v[200:201], v[200:201] op_sel:[0,1,0] op_sel_hi:[1,1,0] neg_lo:[0,0,1] neg_hi:[0,0,1]
  v_pk_fma_f32 v[62:63], v[62:63], v[200:201], v[200:201] op_sel:[0,1,0] op_sel_hi:[1,1,0] neg_lo:[0,0,1] neg_hi:[0,0,1]
  v_pk_fma_f32 v[64:65], v[64:65], v[200:201], v[200:201] op_sel:[0,1,0] op_sel_hi:[1,1,0] neg_lo:[0,0,1] neg_hi:[0,0,1]
  v_pk_fma_f32 v[66:67], v[66:67], v[200:201], v[200:201] op_sel:[0,1,0] op_sel_hi:[1,1,0] neg_lo:[0,0,1] neg_hi:[0,0,1]
  v_pk_fma_f32 v[68:69], v[68:69], v[200:201], v[200:201] op_sel:[0,1,0] op_sel_hi:[1,1,0] neg_lo:[0,0,1] neg_hi:[0,0,1]
  v_pk_fma_f32 v[70:71], v[70:71], v[200:201], v[200:201] op_sel:[0,1,0] op_sel_hi:[1,1,0] neg_lo:[0,0,1] neg_hi:[0,0,1]
  v_cvt_pk_bf16_f32 v212, v56, v57
  v_cvt_pk_bf16_f32 v213, v58, v59
  v_cvt_pk_bf16_f32 v214, v60, v61
  v_cvt_pk_bf16_f32 v215, v62, v63
  v_cvt_pk_bf16_f32 v216, v64, v65
  v_cvt_pk_bf16_f32 v217, v66, v67
  v_cvt_pk_bf16_f32 v218, v68, v69
  v_cvt_pk_bf16_f32 v219, v70, v71
  ds_write_b64 v228, v[212:213] offset:2048
  ds_write_b64 v229, v[214:215] offset:2048
  ds_write_b64 v230, v[216:217] offset:2048
  ds_write_b64 v231, v[218:219] offset:2048
  s_waitcnt lgkmcnt(0)
  ds_read_b64_tr_b16 v[204:205], v232 offset:0
  ds_read_b64_tr_b16 v[206:207], v233 offset:256
  ds_read_b64_tr_b16 v[208:209], v232 offset:1024
  ds_read_b64_tr_b16 v[210:211], v233 offset:1280
  ds_read_b64_tr_b16 v[212:213], v232 offset:2048
  ds_read_b64_tr_b16 v[214:215], v233 offset:2304
  ds_read_b64_tr_b16 v[216:217], v232 offset:3072
  ds_read_b64_tr_b16 v[218:219], v233 offset:3328
  s_lshl_b32 s55, s49, 1
  s_add_u32 s55, s55, 0
  s_lshl_b32 s55, s55, 6
  s_add_u32 s55, s55, s52
  s_lshl_b32 s55, s55, 11
  s_add_u32 s55, s55, 13631488
  s_waitcnt lgkmcnt(4)
  buffer_store_dwordx4 v[204:207], v2, s[40:43], s55 offen offset:0 sc1
  buffer_store_dwordx4 v[208:211], v2, s[40:43], s55 offen offset:1024 sc1
  s_lshl_b32 s55, s49, 1
  s_add_u32 s55, s55, 1
  s_lshl_b32 s55, s55, 6
  s_add_u32 s55, s55, s52
  s_lshl_b32 s55, s55, 11
  s_add_u32 s55, s55, 13631488
  s_waitcnt lgkmcnt(0)
  buffer_store_dwordx4 v[212:215], v2, s[40:43], s55 offen offset:0 sc1
  buffer_store_dwordx4 v[216:219], v2, s[40:43], s55 offen offset:1024 sc1
  s_waitcnt lgkmcnt(0)
  v_mfma_f32_32x32x16_bf16 v[72:87], v[104:107], a[80:83], v[72:87]
  ds_read_b64_tr_b16 v[120:121], v17 offset:45056
  ds_read_b64_tr_b16 v[122:123], v17 offset:46080
  v_mfma_f32_32x32x16_bf16 v[88:103], v[108:111], a[80:83], v[88:103]
  ds_read_b64_tr_b16 v[124:125], v18 offset:45056
  ds_read_b64_tr_b16 v[126:127], v18 offset:46080
  s_waitcnt lgkmcnt(4)
  v_mfma_f32_32x32x16_bf16 v[72:87], v[112:115], a[84:87], v[72:87]
  ds_read_b64_tr_b16 v[104:105], v17 offset:47104
  ds_read_b64_tr_b16 v[106:107], v17 offset:48128
  v_mfma_f32_32x32x16_bf16 v[88:103], v[116:119], a[84:87], v[88:103]
  ds_read_b64_tr_b16 v[108:109], v18 offset:47104
  ds_read_b64_tr_b16 v[110:111], v18 offset:48128
  s_waitcnt lgkmcnt(4)
  v_mfma_f32_32x32x16_bf16 v[72:87], v[120:123], a[88:91], v[72:87]
  ds_read_b64_tr_b16 v[112:113], v17 offset:49152
  ds_read_b64_tr_b16 v[114:115], v17 offset:50176
  v_mfma_f32_32x32x16_bf16 v[88:103], v[124:127], a[88:91], v[88:103]
  ds_read_b64_tr_b16 v[116:117], v18 offset:49152
  ds_read_b64_tr_b16 v[118:119], v18 offset:50176
  s_waitcnt lgkmcnt(4)
  v_mfma_f32_32x32x16_bf16 v[72:87], v[104:107], a[92:95], v[72:87]
  ds_read_b64_tr_b16 v[120:121], v17 offset:51200
  ds_read_b64_tr_b16 v[122:123], v17 offset:52224
  v_mfma_f32_32x32x16_bf16 v[88:103], v[108:111], a[92:95], v[88:103]
  ds_read_b64_tr_b16 v[124:125], v18 offset:51200
  ds_read_b64_tr_b16 v[126:127], v18 offset:52224
  s_waitcnt lgkmcnt(4)
  v_mfma_f32_32x32x16_bf16 v[72:87], v[112:115], a[96:99], v[72:87]
  ds_read_b64_tr_b16 v[104:105], v17 offset:53248
  ds_read_b64_tr_b16 v[106:107], v17 offset:54272
  ds_read_b64_tr_b16 v[108:109], v18 offset:53248
  ds_read_b64_tr_b16 v[110:111], v18 offset:54272
  ds_read_b128 v[128:131], v160 offset:256
  ds_read_b128 v[132:135], v160 offset:288
  v_mfma_f32_32x32x16_bf16 v[88:103], v[116:119], a[96:99], v[88:103]
  ds_read_b128 v[136:139], v160 offset:320
  ds_read_b128 v[140:143], v160 offset:352
  ds_read_b128 v[144:147], v160 offset:384
  ds_read_b128 v[148:151], v160 offset:416
  ds_read_b128 v[152:155], v160 offset:448
  ds_read_b128 v[156:159], v160 offset:480
  s_waitcnt lgkmcnt(4)
  v_mfma_f32_32x32x16_bf16 v[72:87], v[120:123], a[100:103], v[72:87]
  ds_read_b64_tr_b16 v[112:113], v17 offset:55296
  ds_read_b64_tr_b16 v[114:115], v17 offset:56320
  v_mfma_f32_32x32x16_bf16 v[88:103], v[124:127], a[100:103], v[88:103]
  ds_read_b64_tr_b16 v[116:117], v18 offset:55296
  ds_read_b64_tr_b16 v[118:119], v18 offset:56320
  s_waitcnt lgkmcnt(4)
  v_mfma_f32_32x32x16_bf16 v[72:87], v[104:107], a[104:107], v[72:87]
  v_mfma_f32_32x32x16_bf16 v[88:103], v[108:111], a[104:107], v[88:103]
  s_waitcnt lgkmcnt(0)
  v_mfma_f32_32x32x16_bf16 v[72:87], v[112:115], a[108:111], v[72:87]
  v_mfma_f32_32x32x16_bf16 v[88:103], v[116:119], a[108:111], v[88:103]
  s_waitcnt lgkmcnt(0)
  s_barrier
  s_lshl_b32 s55, s49, 7
  s_lshl_b32 s50, s48, 2
  s_add_u32 s55, s55, s50
  s_add_u32 s55, s55, 16384
  s_nop 4
  v_pk_fma_f32 v[72:73], v[162:163], v[128:129], v[72:73] op_sel_hi:[0,1,1] neg_lo:[1,0,0] neg_hi:[1,0,0]
  v_pk_fma_f32 v[74:75], v[162:163], v[130:131], v[74:75] op_sel_hi:[0,1,1] neg_lo:[1,0,0] neg_hi:[1,0,0]
  v_pk_fma_f32 v[76:77], v[162:163], v[132:133], v[76:77] op_sel_hi:[0,1,1] neg_lo:[1,0,0] neg_hi:[1,0,0]
  v_pk_fma_f32 v[78:79], v[162:163], v[134:135], v[78:79] op_sel_hi:[0,1,1] neg_lo:[1,0,0] neg_hi:[1,0,0]
  v_pk_mul_f32 v[72:73], v[72:73], v[162:163] op_sel:[0,1] op_sel_hi:[1,1]
  v_pk_mul_f32 v[74:75], v[74:75], v[162:163] op_sel:[0,1] op_sel_hi:[1,1]
  v_pk_mul_f32 v[76:77], v[76:77], v[162:163] op_sel:[0,1] op_sel_hi:[1,1]
  v_pk_mul_f32 v[78:79], v[78:79], v[162:163] op_sel:[0,1] op_sel_hi:[1,1]
  v_pk_mul_f32 v[172:173], v[72:73], v[72:73]
  v_pk_mul_f32 v[174:175], v[74:75], v[74:75]
  v_pk_mul_f32 v[176:177], v[76:77], v[76:77]
  v_pk_mul_f32 v[178:179], v[78:79], v[78:79]
  v_pk_fma_f32 v[172:173], v[172:173], s[62:63], v[164:165]
  v_pk_fma_f32 v[174:175], v[174:175], s[62:63], v[164:165]
  v_pk_fma_f32 v[176:177], v[176:177], s[62:63], v[164:165]
  v_pk_fma_f32 v[178:179], v[178:179], s[62:63], v[164:165]
  v_pk_mul_f32 v[172:173], v[172:173], v[72:73]
  v_pk_mul_f32 v[174:175], v[174:175], v[74:75]
  v_pk_mul_f32 v[176:177], v[176:177], v[76:77]
  v_pk_mul_f32 v[178:179], v[178:179], v[78:79]
  v_exp_f32 v172, v172
  v_exp_f32 v173, v173
  v_exp_f32 v174, v174
  v_exp_f32 v175, v175
  s_add_u32 s98, s96, 0
  s_and_b32 s98, s98, 15
  s_lshl_b32 s98, s98, 7
  s_add_u32 s98, s98, s97
  s_lshl_b32 s99, s45, 16
  s_add_u32 s98, s98, s99
  s_lshl_b32 s99, s45, 11
  s_add_u32 m0, s99, 0
  s_add_u32 s99, s98, 0
  buffer_load_dwordx4 v161, s[24:27], s99 offen lds
  v_exp_f32 v176, v176
  v_exp_f32 v177, v177
  v_exp_f32 v178, v178
  v_exp_f32 v179, v179
  v_pk_add_f32 v[172:173], v[172:173], 1.0 op_sel_hi:[1,0]
  v_pk_add_f32 v[174:175], v[174:175], 1.0 op_sel_hi:[1,0]
  v_pk_add_f32 v[176:177], v[176:177], 1.0 op_sel_hi:[1,0]
  v_pk_add_f32 v[178:179], v[178:179], 1.0 op_sel_hi:[1,0]
  v_rcp_f32 v172, v172
  v_rcp_f32 v173, v173
  v_rcp_f32 v174, v174
  v_rcp_f32 v175, v175
  v_rcp_f32 v176, v176
  v_rcp_f32 v177, v177
  v_rcp_f32 v178, v178
  v_rcp_f32 v179, v179
  v_pk_mul_f32 v[72:73], v[72:73], v[172:173]
  v_pk_mul_f32 v[74:75], v[74:75], v[174:175]
  v_pk_mul_f32 v[76:77], v[76:77], v[176:177]
  v_pk_mul_f32 v[78:79], v[78:79], v[178:179]
  v_cvt_pk_bf16_f32 v180, v72, v73
  v_cvt_pk_bf16_f32 v181, v74, v75
  v_cvt_pk_bf16_f32 v182, v76, v77
  v_cvt_pk_bf16_f32 v183, v78, v79
  s_lshl_b32 s99, s45, 11
  s_add_u32 m0, s99, 1024
  s_add_u32 s99, s98, 32768
  buffer_load_dwordx4 v170, s[24:27], s99 offen lds
  s_waitcnt vmcnt(2)
  s_barrier
  s_cmp_lg_u32 s45, 0
  s_cbranch_scc1 L_nf_55
  v_mov_b32 v5, s44
  v_mov_b32 v6, 0
  s_mov_b64 exec, 1
  buffer_store_dword v5, v6, s[40:43], s55 offen sc1
  s_mov_b64 exec, -1
L_nf_55:
  v_pk_fma_f32 v[80:81], v[162:163], v[136:137], v[80:81] op_sel_hi:[0,1,1] neg_lo:[1,0,0] neg_hi:[1,0,0]
  v_pk_fma_f32 v[82:83], v[162:163], v[138:139], v[82:83] op_sel_hi:[0,1,1] neg_lo:[1,0,0] neg_hi:[1,0,0]
  v_pk_fma_f32 v[84:85], v[162:163], v[140:141], v[84:85] op_sel_hi:[0,1,1] neg_lo:[1,0,0] neg_hi:[1,0,0]
  v_pk_fma_f32 v[86:87], v[162:163], v[142:143], v[86:87] op_sel_hi:[0,1,1] neg_lo:[1,0,0] neg_hi:[1,0,0]
  v_pk_mul_f32 v[80:81], v[80:81], v[162:163] op_sel:[0,1] op_sel_hi:[1,1]
  v_pk_mul_f32 v[82:83], v[82:83], v[162:163] op_sel:[0,1] op_sel_hi:[1,1]
  v_pk_mul_f32 v[84:85], v[84:85], v[162:163] op_sel:[0,1] op_sel_hi:[1,1]
  v_pk_mul_f32 v[86:87], v[86:87], v[162:163] op_sel:[0,1] op_sel_hi:[1,1]
  v_pk_mul_f32 v[172:173], v[80:81], v[80:81]
  v_pk_mul_f32 v[174:175], v[82:83], v[82:83]
  v_pk_mul_f32 v[176:177], v[84:85], v[84:85]
  v_pk_mul_f32 v[178:179], v[86:87], v[86:87]
  v_pk_fma_f32 v[172:173], v[172:173], s[62:63], v[164:165]
  v_pk_fma_f32 v[174:175], v[174:175], s[62:63], v[164:165]
  v_pk_fma_f32 v[176:177], v[176:177], s[62:63], v[164:165]
  v_pk_fma_f32 v[178:179], v[178:179], s[62:63], v[164:165]
  v_pk_mul_f32 v[172:173], v[172:173], v[80:81]
  v_pk_mul_f32 v[174:175], v[174:175], v[82:83]
  v_pk_mul_f32 v[176:177], v[176:177], v[84:85]
  v_pk_mul_f32 v[178:179], v[178:179], v[86:87]
  v_exp_f32 v172, v172
  v_exp_f32 v173, v173
  v_exp_f32 v174, v174
  s_add_u32 s98, s96, 1
  s_and_b32 s98, s98, 15
  s_lshl_b32 s98, s98, 7
  s_add_u32 s98, s98, s97
  s_lshl_b32 s99, s45, 16
  s_add_u32 s98, s98, s99
  s_lshl_b32 s99, s45, 11
  s_add_u32 m0, s99, 8192
  s_add_u32 s99, s98, 0
  buffer_load_dwordx4 v161, s[24:27], s99 offen lds
  v_exp_f32 v175, v175
  v_exp_f32 v176, v176
  v_exp_f32 v177, v177
  v_exp_f32 v178, v178
  v_exp_f32 v179, v179
  v_pk_add_f32 v[172:173], v[172:173], 1.0 op_sel_hi:[1,0]
  v_pk_add_f32 v[174:175], v[174:175], 1.0 op_sel_hi:[1,0]
  v_pk_add_f32 v[176:177], v[176:177], 1.0 op_sel_hi:[1,0]
  v_pk_add_f32 v[178:179], v[178:179], 1.0 op_sel_hi:[1,0]
  v_rcp_f32 v172, v172
  v_rcp_f32 v173, v173
  v_rcp_f32 v174, v174
  v_rcp_f32 v175, v175
  v_rcp_f32 v176, v176
  v_rcp_f32 v177, v177
  v_rcp_f32 v178, v178
  v_rcp_f32 v179, v179
  v_pk_mul_f32 v[80:81], v[80:81], v[172:173]
  v_pk_mul_f32 v[82:83], v[82:83], v[174:175]
  v_pk_mul_f32 v[84:85], v[84:85], v[176:177]
  v_pk_mul_f32 v[86:87], v[86:87], v[178:179]
  v_cvt_pk_bf16_f32 v184, v80, v81
  v_cvt_pk_bf16_f32 v185, v82, v83
  v_cvt_pk_bf16_f32 v186, v84, v85
  s_lshl_b32 s99, s45, 11
  s_add_u32 m0, s99, 9216
  s_add_u32 s99, s98, 32768
  buffer_load_dwordx4 v170, s[24:27], s99 offen lds
  v_cvt_pk_bf16_f32 v187, v86, v87
  v_pk_fma_f32 v[88:89], v[162:163], v[144:145], v[88:89] op_sel_hi:[0,1,1] neg_lo:[1,0,0] neg_hi:[1,0,0]
  v_pk_fma_f32 v[90:91], v[162:163], v[146:147], v[90:91] op_sel_hi:[0,1,1] neg_lo:[1,0,0] neg_hi:[1,0,0]
  v_pk_fma_f32 v[92:93], v[162:163], v[148:149], v[92:93] op_sel_hi:[0,1,1] neg_lo:[1,0,0] neg_hi:[1,0,0]
  v_pk_fma_f32 v[94:95], v[162:163], v[150:151], v[94:95] op_sel_hi:[0,1,1] neg_lo:[1,0,0] neg_hi:[1,0,0]
  v_pk_mul_f32 v[88:89], v[88:89], v[162:163] op_sel:[0,1] op_sel_hi:[1,1]
  v_pk_mul_f32 v[90:91], v[90:91], v[162:163] op_sel:[0,1] op_sel_hi:[1,1]
  v_pk_mul_f32 v[92:93], v[92:93], v[162:163] op_sel:[0,1] op_sel_hi:[1,1]
  v_pk_mul_f32 v[94:95], v[94:95], v[162:163] op_sel:[0,1] op_sel_hi:[1,1]
  v_pk_mul_f32 v[172:173], v[88:89], v[88:89]
  v_pk_mul_f32 v[174:175], v[90:91], v[90:91]
  v_pk_mul_f32 v[176:177], v[92:93], v[92:93]
  v_pk_mul_f32 v[178:179], v[94:95], v[94:95]
  v_pk_fma_f32 v[172:173], v[172:173], s[62:63], v[164:165]
  v_pk_fma_f32 v[174:175], v[174:175], s[62:63], v[164:165]
  v_pk_fma_f32 v[176:177], v[176:177], s[62:63], v[164:165]
  v_pk_fma_f32 v[178:179], v[178:179], s[62:63], v[164:165]
  v_pk_mul_f32 v[172:173], v[172:173], v[88:89]
  v_pk_mul_f32 v[174:175], v[174:175], v[90:91]
  v_pk_mul_f32 v[176:177], v[176:177], v[92:93]
  v_pk_mul_f32 v[178:179], v[178:179], v[94:95]
  v_exp_f32 v172, v172
  v_exp_f32 v173, v173
  v_exp_f32 v174, v174
  s_add_u32 s98, s96, 2
  s_and_b32 s98, s98, 15
  s_lshl_b32 s98, s98, 7
  s_add_u32 s98, s98, s97
  s_lshl_b32 s99, s45, 16
  s_add_u32 s98, s98, s99
  s_lshl_b32 s99, s45, 11
  s_add_u32 m0, s99, 16384
  s_add_u32 s99, s98, 0
  buffer_load_dwordx4 v161, s[24:27], s99 offen lds
  v_exp_f32 v175, v175
  v_exp_f32 v176, v176
  v_exp_f32 v177, v177
  v_exp_f32 v178, v178
  v_exp_f32 v179, v179
  v_pk_add_f32 v[172:173], v[172:173], 1.0 op_sel_hi:[1,0]
  v_pk_add_f32 v[174:175], v[174:175], 1.0 op_sel_hi:[1,0]
  v_pk_add_f32 v[176:177], v[176:177], 1.0 op_sel_hi:[1,0]
  v_pk_add_f32 v[178:179], v[178:179], 1.0 op_sel_hi:[1,0]
  v_rcp_f32 v172, v172
  v_rcp_f32 v173, v173
  v_rcp_f32 v174, v174
  v_rcp_f32 v175, v175
  v_rcp_f32 v176, v176
  v_rcp_f32 v177, v177
  v_rcp_f32 v178, v178
  v_rcp_f32 v179, v179
  v_pk_mul_f32 v[88:89], v[88:89], v[172:173]
  v_pk_mul_f32 v[90:91], v[90:91], v[174:175]
  v_pk_mul_f32 v[92:93], v[92:93], v[176:177]
  v_pk_mul_f32 v[94:95], v[94:95], v[178:179]
  v_cvt_pk_bf16_f32 v188, v88, v89
  v_cvt_pk_bf16_f32 v189, v90, v91
  v_cvt_pk_bf16_f32 v190, v92, v93
  s_lshl_b32 s99, s45, 11
  s_add_u32 m0, s99, 17408
  s_add_u32 s99, s98, 32768
  buffer_load_dwordx4 v170, s[24:27], s99 offen lds
  v_cvt_pk_bf16_f32 v191, v94, v95
  v_pk_fma_f32 v[96:97], v[162:163], v[152:153], v[96:97] op_sel_hi:[0,1,1] neg_lo:[1,0,0] neg_hi:[1,0,0]
  v_pk_fma_f32 v[98:99], v[162:163], v[154:155], v[98:99] op_sel_hi:[0,1,1] neg_lo:[1,0,0] neg_hi:[1,0,0]
  v_pk_fma_f32 v[100:101], v[162:163], v[156:157], v[100:101] op_sel_hi:[0,1,1] neg_lo:[1,0,0] neg_hi:[1,0,0]
  v_pk_fma_f32 v[102:103], v[162:163], v[158:159], v[102:103] op_sel_hi:[0,1,1] neg_lo:[1,0,0] neg_hi:[1,0,0]
  v_pk_mul_f32 v[96:97], v[96:97], v[162:163] op_sel:[0,1] op_sel_hi:[1,1]
  v_pk_mul_f32 v[98:99], v[98:99], v[162:163] op_sel:[0,1] op_sel_hi:[1,1]
  v_pk_mul_f32 v[100:101], v[100:101], v[162:163] op_sel:[0,1] op_sel_hi:[1,1]
  v_pk_mul_f32 v[102:103], v[102:103], v[162:163] op_sel:[0,1] op_sel_hi:[1,1]
  v_pk_mul_f32 v[172:173], v[96:97], v[96:97]
  v_pk_mul_f32 v[174:175], v[98:99], v[98:99]
  v_pk_mul_f32 v[176:177], v[100:101], v[100:101]
  v_pk_mul_f32 v[178:179], v[102:103], v[102:103]
  v_pk_fma_f32 v[172:173], v[172:173], s[62:63], v[164:165]
  v_pk_fma_f32 v[174:175], v[174:175], s[62:63], v[164:165]
  v_pk_fma_f32 v[176:177], v[176:177], s[62:63], v[164:165]
  v_pk_fma_f32 v[178:179], v[178:179], s[62:63], v[164:165]
  v_pk_mul_f32 v[172:173], v[172:173], v[96:97]
  v_pk_mul_f32 v[174:175], v[174:175], v[98:99]
  v_pk_mul_f32 v[176:177], v[176:177], v[100:101]
  v_pk_mul_f32 v[178:179], v[178:179], v[102:103]
  v_exp_f32 v172, v172
  v_exp_f32 v173, v173
  v_exp_f32 v174, v174
  s_add_u32 s98, s96, 3
  s_and_b32 s98, s98, 15
  s_lshl_b32 s98, s98, 7
  s_add_u32 s98, s98, s97
  s_lshl_b32 s99, s45, 16
  s_add_u32 s98, s98, s99
  s_lshl_b32 s99, s45, 11
  s_add_u32 m0, s99, 24576
  s_add_u32 s99, s98, 0
  buffer_load_dwordx4 v161, s[24:27], s99 offen lds
  v_exp_f32 v175, v175
  v_exp_f32 v176, v176
  v_exp_f32 v177, v177
  v_exp_f32 v178, v178
  v_exp_f32 v179, v179
  v_pk_add_f32 v[172:173], v[172:173], 1.0 op_sel_hi:[1,0]
  v_pk_add_f32 v[174:175], v[174:175], 1.0 op_sel_hi:[1,0]
  v_pk_add_f32 v[176:177], v[176:177], 1.0 op_sel_hi:[1,0]
  v_pk_add_f32 v[178:179], v[178:179], 1.0 op_sel_hi:[1,0]
  v_rcp_f32 v172, v172
  v_rcp_f32 v173, v173
  v_rcp_f32 v174, v174
  v_rcp_f32 v175, v175
  v_rcp_f32 v176, v176
  v_rcp_f32 v177, v177
  v_rcp_f32 v178, v178
  v_rcp_f32 v179, v179
  v_pk_mul_f32 v[96:97], v[96:97], v[172:173]
  v_pk_mul_f32 v[98:99], v[98:99], v[174:175]
  v_pk_mul_f32 v[100:101], v[100:101], v[176:177]
  v_pk_mul_f32 v[102:103], v[102:103], v[178:179]
  v_cvt_pk_bf16_f32 v192, v96, v97
  v_cvt_pk_bf16_f32 v193, v98, v99
  v_cvt_pk_bf16_f32 v194, v100, v101
  s_lshl_b32 s99, s45, 11
  s_add_u32 m0, s99, 25600
  s_add_u32 s99, s98, 32768
  buffer_load_dwordx4 v170, s[24:27], s99 offen lds
  v_cvt_pk_bf16_f32 v195, v102, v103
  s_mul_i32 s56, s52, 28
  s_lshl_b32 s50, s49, 1
  s_add_u32 s56, s56, s50
  s_lshl_b32 s56, s56, 11
  s_add_u32 s56, s56, 9437184
  buffer_store_dwordx4 v[180:183], v2, s[40:43], s56 offen offset:0 sc1
  buffer_store_dwordx4 v[184:187], v2, s[40:43], s56 offen offset:1024 sc1
  buffer_store_dwordx4 v[188:191], v2, s[40:43], s56 offen offset:2048 sc1
  buffer_store_dwordx4 v[192:195], v2, s[40:43], s56 offen offset:3072 sc1
  s_add_u32 s98, s96, 4
  s_and_b32 s98, s98, 15
  s_lshl_b32 s98, s98, 7
  s_add_u32 s98, s98, s97
  s_lshl_b32 s99, s45, 16
  s_add_u32 s98, s98, s99
  s_lshl_b32 s99, s45, 11
  s_add_u32 m0, s99, 32768
  s_add_u32 s99, s98, 0
  buffer_load_dwordx4 v161, s[24:27], s99 offen lds
  s_lshl_b32 s99, s45, 11
  s_add_u32 m0, s99, 33792
  s_add_u32 s99, s98, 32768
  buffer_load_dwordx4 v170, s[24:27], s99 offen lds
  s_add_u32 s98, s96, 5
  s_and_b32 s98, s98, 15
  s_lshl_b32 s98, s98, 7
  s_add_u32 s98, s98, s97
  s_lshl_b32 s99, s45, 16
  s_add_u32 s98, s98, s99
  s_lshl_b32 s99, s45, 11
  s_add_u32 m0, s99, 40960
  s_add_u32 s99, s98, 0
  buffer_load_dwordx4 v161, s[24:27], s99 offen lds
  s_lshl_b32 s99, s45, 11
  s_add_u32 m0, s99, 41984
  s_add_u32 s99, s98, 32768
  buffer_load_dwordx4 v170, s[24:27], s99 offen lds
  s_add_u32 s98, s96, 6
  s_and_b32 s98, s98, 15
  s_lshl_b32 s98, s98, 7
  s_add_u32 s98, s98, s97
  s_lshl_b32 s99, s45, 16
  s_add_u32 s98, s98, s99
  s_lshl_b32 s99, s45, 11
  s_add_u32 m0, s99, 49152
  s_add_u32 s99, s98, 0
  buffer_load_dwordx4 v161, s[24:27], s99 offen lds
  s_lshl_b32 s99, s45, 11
  s_add_u32 m0, s99, 50176
  s_add_u32 s99, s98, 32768
  buffer_load_dwordx4 v170, s[24:27], s99 offen lds
  s_branch L_ip_56
L_skipC:
  s_lshl_b32 s50, s46, 20
  s_sub_u32 s51, s47, 28
  s_lshl_b32 s51, s51, 2
  s_add_u32 s51, s51, s45
  s_lshl_b32 s51, s51, 12
  s_add_u32 s50, s50, s51
  s_add_u32 s50, s50, 393216
  v_lshlrev_b32 v251, 6, v1
  s_mov_b32 s51, 10
L_il_57:
  buffer_load_dword v252, v251, s[24:27], s50 offen
  s_add_u32 s50, s50, 65536
  s_sub_u32 s51, s51, 1
  s_cmp_lg_u32 s51, 0
  s_cbranch_scc1 L_il_57
  s_waitcnt vmcnt(0)
L_ip_56:
  s_cmp_ge_u32 s47, 28
  s_cbranch_scc1 L_skipD
  s_mul_i32 s50, s47, 37
  s_lshr_b32 s50, s50, 8
  s_mul_i32 s51, s50, 7
  s_sub_u32 s94, s47, s51
  s_lshl_b32 s95, s46, 2
  s_add_u32 s95, s95, s50
  s_mul_i32 s96, s50, 0
  s_and_b32 s51, s94, 3
  s_mul_i32 s51, s51, 0
  s_add_u32 s96, s96, s51
  s_lshl_b32 s97, s95, 18
  s_mov_b32 s49, s94
  s_mov_b32 s48, s95
  s_mov_b32 s54, s96
  s_lshr_b32 s53, s45, 1
  s_and_b32 s52, s45, 1
  v_lshrrev_b32 v10, 3, v1
  v_and_b32 v11, 7, v1
  v_lshrrev_b32 v12, 4, v1
  v_xor_b32 v13, v11, v12
  v_lshlrev_b32 v13, 4, v13
  v_lshlrev_b32 v10, 12, v10
  v_add_u32 v14, v10, v13
  v_add_u32 v12, 4, v12
  v_xor_b32 v13, v11, v12
  v_lshlrev_b32 v13, 4, v13
  v_add_u32 v15, v10, v13
  s_lshl_b32 s55, s48, 18
  s_lshl_b32 s50, s53, 11
  s_add_u32 s55, s55, s50
  s_lshl_b32 s50, s52, 17
  s_add_u32 s55, s55, s50
  s_mul_i32 s57, s53, 81920
  s_lshl_b32 s50, s52, 12
  s_add_u32 s57, s57, s50
  s_mov_b32 s67, 147456
  s_cmp_eq_u32 s53, 0
  s_cselect_b32 s67, s67, 139264
  s_add_u32 s67, s67, s50
  s_lshl_b32 s61, s48, 18
  v_lshrrev_b32 v10, 1, v3
  v_and_b32 v10, 7, v10
  v_xor_b32 v10, v10, v4
  v_lshlrev_b32 v10, 4, v10
  v_lshlrev_b32 v16, 7, v3
  v_add_u32 v16, v16, v10
  s_lshl_b32 s50, s52, 12
  s_sub_u32 s51, s67, s50
  v_add_u32 v20, s51, v16
  s_sub_u32 s51, s57, s50
  v_add_u32 v16, s51, v16
  v_xor_b32 v17, 32, v16
  v_xor_b32 v21, 32, v20
  v_xor_b32 v18, 64, v16
  v_xor_b32 v22, 64, v20
  v_xor_b32 v19, 96, v16
  v_xor_b32 v23, 96, v20
  v_lshlrev_b32 v10, 1, v3
  s_lshl_b32 s50, s48, 7
  s_lshl_b32 s51, s53, 6
  s_add_u32 s50, s50, s51
  buffer_load_ushort v24, v10, s[28:31], s50 offen
  s_lshl_b32 s50, s49, 2
  s_lshl_b32 s51, s52, 1
  s_add_u32 s50, s50, s51
  s_lshl_b32 s50, s50, 6
  s_lshl_b32 s51, s53, 5
  s_add_u32 s50, s50, s51
  s_lshl_b32 s50, s50, 11
  s_add_u32 s50, s50, 13631488
  v_add_u32 v25, s50, v2
  v_add_u32 v26, 131072, v25
  v_and_b32 v9, 7, v1
  v_lshlrev_b32 v9, 2, v9
  s_lshl_b32 s66, s49, 1
  s_add_u32 s66, s66, s52
  s_lshl_b32 s66, s66, 7
  s_lshl_b32 s50, s53, 5
  s_add_u32 s66, s66, s50
  s_add_u32 s66, s66, 16384
  buffer_load_dword v5, v9, s[40:43], s66 offen sc1
  s_sleep 1
  buffer_load_dword v6, v9, s[40:43], s66 offen sc1
  s_sleep 1
  buffer_load_dword v7, v9, s[40:43], s66 offen sc1
  s_sleep 1
  buffer_load_dword v8, v9, s[40:43], s66 offen sc1
  s_mov_b32 s70, 0
L_gp_58:
  s_waitcnt vmcnt(3)
  v_cmp_eq_u32 s[64:65], s44, v5
  s_nop 1
  s_bitcmp1_b32 s64, 0
  s_cbranch_scc1 L_gd_59
  buffer_load_dword v5, v9, s[40:43], s66 offen sc1
  s_waitcnt vmcnt(3)
  v_cmp_eq_u32 s[64:65], s44, v6
  s_nop 1
  s_bitcmp1_b32 s64, 0
  s_cbranch_scc1 L_gd_59
  buffer_load_dword v6, v9, s[40:43], s66 offen sc1
  s_waitcnt vmcnt(3)
  v_cmp_eq_u32 s[64:65], s44, v7
  s_nop 1
  s_bitcmp1_b32 s64, 0
  s_cbranch_scc1 L_gd_59
  buffer_load_dword v7, v9, s[40:43], s66 offen sc1
  s_waitcnt vmcnt(3)
  v_cmp_eq_u32 s[64:65], s44, v8
  s_nop 1
  s_bitcmp1_b32 s64, 0
  s_cbranch_scc1 L_gd_59
  buffer_load_dword v8, v9, s[40:43], s66 offen sc1
  s_add_u32 s70, s70, 1
  s_cmp_lt_u32 s70, 20000
  s_cbranch_scc1 L_gp_58
L_gd_59:
  s_add_u32 s60, s54, 0
  s_and_b32 s60, s60, 15
  s_lshl_b32 s60, s60, 12
  buffer_load_dwordx4 v[28:31], v25, s[40:43], s60 offen offset:0 sc1
  buffer_load_dwordx4 v[32:35], v26, s[40:43], s60 offen offset:0 sc1
  buffer_load_dwordx4 v[36:39], v25, s[40:43], s60 offen offset:1024 sc1
  buffer_load_dwordx4 v[40:43], v26, s[40:43], s60 offen offset:1024 sc1
  buffer_load_dwordx4 v[44:47], v25, s[40:43], s60 offen offset:2048 sc1
  buffer_load_dwordx4 v[48:51], v26, s[40:43], s60 offen offset:2048 sc1
  buffer_load_dword v5, v9, s[40:43], s66 offen sc1
  buffer_load_dwordx4 v[52:55], v25, s[40:43], s60 offen offset:3072 sc1
  buffer_load_dwordx4 v[56:59], v26, s[40:43], s60 offen offset:3072 sc1
  s_waitcnt vmcnt(29)
  s_barrier
  ds_read_b128 v[124:127], v16 offset:0
  ds_read_b128 v[128:131], v16 offset:4096
  ds_read_b128 v[132:135], v17 offset:0
  ds_read_b128 v[136:139], v17 offset:4096
  s_waitcnt lgkmcnt(2)
  s_waitcnt vmcnt(7)
  v_mfma_f32_32x32x16_bf16 a[0:15], v[28:31], v[124:127], 0
  ds_read_b128 v[140:143], v18 offset:0
  ds_read_b128 v[144:147], v18 offset:4096
  v_mfma_f32_32x32x16_bf16 a[16:31], v[28:31], v[128:131], 0
  s_add_u32 s61, s54, 1
  s_and_b32 s61, s61, 15
  s_lshl_b32 s61, s61, 12
  buffer_load_dwordx4 v[60:63], v25, s[40:43], s61 offen offset:0 sc1
  v_mfma_f32_32x32x16_bf16 a[32:47], v[32:35], v[124:127], 0
  buffer_load_dwordx4 v[64:67], v26, s[40:43], s61 offen offset:0 sc1
  v_mfma_f32_32x32x16_bf16 a[48:63], v[32:35], v[128:131], 0
  buffer_load_dwordx4 v[68:71], v25, s[40:43], s61 offen offset:1024 sc1
  buffer_load_dwordx4 v[72:75], v26, s[40:43], s61 offen offset:1024 sc1
  s_waitcnt lgkmcnt(2)
  s_waitcnt vmcnt(9)
  v_mfma_f32_32x32x16_bf16 a[0:15], v[36:39], v[132:135], a[0:15]
  ds_read_b128 v[124:127], v19 offset:0
  ds_read_b128 v[128:131], v19 offset:4096
  v_mfma_f32_32x32x16_bf16 a[16:31], v[36:39], v[136:139], a[16:31]
  buffer_load_dwordx4 v[76:79], v25, s[40:43], s61 offen offset:2048 sc1
  buffer_load_dwordx4 v[80:83], v26, s[40:43], s61 offen offset:2048 sc1
  v_mfma_f32_32x32x16_bf16 a[32:47], v[40:43], v[132:135], a[32:47]
  buffer_load_dwordx4 v[84:87], v25, s[40:43], s61 offen offset:3072 sc1
  v_mfma_f32_32x32x16_bf16 a[48:63], v[40:43], v[136:139], a[48:63]
  buffer_load_dwordx4 v[88:91], v26, s[40:43], s61 offen offset:3072 sc1
  s_waitcnt lgkmcnt(2)
  s_waitcnt vmcnt(11)
  v_mfma_f32_32x32x16_bf16 a[0:15], v[44:47], v[140:143], a[0:15]
  s_barrier
  ds_read_b128 v[132:135], v16 offset:8192
  ds_read_b128 v[136:139], v16 offset:12288
  v_mfma_f32_32x32x16_bf16 a[16:31], v[44:47], v[144:147], a[16:31]
  s_waitcnt vmcnt(10)
  v_cmp_eq_u32 s[64:65], s44, v5
  s_nop 1
  s_bitcmp1_b32 s64, 1
  s_cbranch_scc1 L_go_61
  s_mov_b32 s70, 0
L_gs_60:
  buffer_load_dword v5, v9, s[40:43], s66 offen sc1
  s_waitcnt vmcnt(0)
  v_cmp_eq_u32 s[64:65], s44, v5
  s_nop 1
  s_bitcmp1_b32 s64, 1
  s_cbranch_scc1 L_go_61
  s_add_u32 s70, s70, 1
  s_cmp_lt_u32 s70, 20000
  s_cbranch_scc1 L_gs_60
L_go_61:
  s_add_u32 s62, s54, 2
  s_and_b32 s62, s62, 15
  s_lshl_b32 s62, s62, 12
  v_mfma_f32_32x32x16_bf16 a[32:47], v[48:51], v[140:143], a[32:47]
  buffer_load_dwordx4 v[92:95], v25, s[40:43], s62 offen offset:0 sc1
  buffer_load_dwordx4 v[96:99], v26, s[40:43], s62 offen offset:0 sc1
  v_mfma_f32_32x32x16_bf16 a[48:63], v[48:51], v[144:147], a[48:63]
  buffer_load_dwordx4 v[100:103], v25, s[40:43], s62 offen offset:1024 sc1
  buffer_load_dwordx4 v[104:107], v26, s[40:43], s62 offen offset:1024 sc1
  s_waitcnt lgkmcnt(2)
  s_waitcnt vmcnt(12)
  v_mfma_f32_32x32x16_bf16 a[0:15], v[52:55], v[124:127], a[0:15]
  ds_read_b128 v[140:143], v17 offset:8192
  ds_read_b128 v[144:147], v17 offset:12288
  buffer_load_dwordx4 v[108:111], v25, s[40:43], s62 offen offset:2048 sc1
  v_mfma_f32_32x32x16_bf16 a[16:31], v[52:55], v[128:131], a[16:31]
  buffer_load_dwordx4 v[112:115], v26, s[40:43], s62 offen offset:2048 sc1
  v_mfma_f32_32x32x16_bf16 a[32:47], v[56:59], v[124:127], a[32:47]
  buffer_load_dword v5, v9, s[40:43], s66 offen sc1
  buffer_load_dwordx4 v[116:119], v25, s[40:43], s62 offen offset:3072 sc1
  v_mfma_f32_32x32x16_bf16 a[48:63], v[56:59], v[128:131], a[48:63]
  buffer_load_dwordx4 v[120:123], v26, s[40:43], s62 offen offset:3072 sc1
  s_waitcnt lgkmcnt(2)
  s_waitcnt vmcnt(15)
  v_mfma_f32_32x32x16_bf16 a[0:15], v[60:63], v[132:135], a[0:15]
  ds_read_b128 v[124:127], v18 offset:8192
  ds_read_b128 v[128:131], v18 offset:12288
  v_mfma_f32_32x32x16_bf16 a[16:31], v[60:63], v[136:139], a[16:31]
  s_add_u32 s63, s54, 3
  s_and_b32 s63, s63, 15
  s_lshl_b32 s63, s63, 12
  buffer_load_dwordx4 v[28:31], v25, s[40:43], s63 offen offset:0 sc1
  v_mfma_f32_32x32x16_bf16 a[32:47], v[64:67], v[132:135], a[32:47]
  buffer_load_dwordx4 v[32:35], v26, s[40:43], s63 offen offset:0 sc1
  v_mfma_f32_32x32x16_bf16 a[48:63], v[64:67], v[136:139], a[48:63]
  buffer_load_dwordx4 v[36:39], v25, s[40:43], s63 offen offset:1024 sc1
  buffer_load_dwordx4 v[40:43], v26, s[40:43], s63 offen offset:1024 sc1
  s_waitcnt lgkmcnt(2)
  s_waitcnt vmcnt(17)
  v_mfma_f32_32x32x16_bf16 a[0:15], v[68:71], v[140:143], a[0:15]
  ds_read_b128 v[132:135], v19 offset:8192
  ds_read_b128 v[136:139], v19 offset:12288
  v_mfma_f32_32x32x16_bf16 a[16:31], v[68:71], v[144:147], a[16:31]
  buffer_load_dwordx4 v[44:47], v25, s[40:43], s63 offen offset:2048 sc1
  buffer_load_dwordx4 v[48:51], v26, s[40:43], s63 offen offset:2048 sc1
  v_mfma_f32_32x32x16_bf16 a[32:47], v[72:75], v[140:143], a[32:47]
  buffer_load_dwordx4 v[52:55], v25, s[40:43], s63 offen offset:3072 sc1
  v_mfma_f32_32x32x16_bf16 a[48:63], v[72:75], v[144:147], a[48:63]
  buffer_load_dwordx4 v[56:59], v26, s[40:43], s63 offen offset:3072 sc1
  s_waitcnt lgkmcnt(2)
  s_waitcnt vmcnt(19)
  v_mfma_f32_32x32x16_bf16 a[0:15], v[76:79], v[124:127], a[0:15]
  s_barrier
  ds_read_b128 v[140:143], v16 offset:16384
  ds_read_b128 v[144:147], v16 offset:20480
  v_mfma_f32_32x32x16_bf16 a[16:31], v[76:79], v[128:131], a[16:31]
  s_waitcnt vmcnt(10)
  v_cmp_eq_u32 s[64:65], s44, v5
  s_nop 1
  s_bitcmp1_b32 s64, 2
  s_cbranch_scc1 L_go_63
  s_mov_b32 s70, 0
L_gs_62:
  buffer_load_dword v5, v9, s[40:43], s66 offen sc1
  s_waitcnt vmcnt(0)
  v_cmp_eq_u32 s[64:65], s44, v5
  s_nop 1
  s_bitcmp1_b32 s64, 2
  s_cbranch_scc1 L_go_63
  s_add_u32 s70, s70, 1
  s_cmp_lt_u32 s70, 20000
  s_cbranch_scc1 L_gs_62
L_go_63:
  s_add_u32 s60, s54, 4
  s_and_b32 s60, s60, 15
  s_lshl_b32 s60, s60, 12
  v_mfma_f32_32x32x16_bf16 a[32:47], v[80:83], v[124:127], a[32:47]
  buffer_load_dwordx4 v[60:63], v25, s[40:43], s60 offen offset:0 sc1
  buffer_load_dwordx4 v[64:67], v26, s[40:43], s60 offen offset:0 sc1
  v_mfma_f32_32x32x16_bf16 a[48:63], v[80:83], v[128:131], a[48:63]
  buffer_load_dwordx4 v[68:71], v25, s[40:43], s60 offen offset:1024 sc1
  buffer_load_dwordx4 v[72:75], v26, s[40:43], s60 offen offset:1024 sc1
  s_waitcnt lgkmcnt(2)
  v_mfma_f32_32x32x16_bf16 a[0:15], v[84:87], v[132:135], a[0:15]
  ds_read_b128 v[124:127], v17 offset:16384
  ds_read_b128 v[128:131], v17 offset:20480
  buffer_load_dwordx4 v[76:79], v25, s[40:43], s60 offen offset:2048 sc1
  buffer_load_dwordx4 v[80:83], v26, s[40:43], s60 offen offset:2048 sc1
  v_mfma_f32_32x32x16_bf16 a[16:31], v[84:87], v[136:139], a[16:31]
  s_add_u32 s58, s54, 8
  s_and_b32 s58, s58, 15
  s_lshl_b32 s58, s58, 7
  s_add_u32 s58, s58, s55
  s_add_u32 m0, s57, 0
  s_add_u32 s56, s58, 0
  buffer_load_dwordx4 v14, s[24:27], s56 offen lds
  v_mfma_f32_32x32x16_bf16 a[32:47], v[88:91], v[132:135], a[32:47]
  s_add_u32 m0, s57, 1024
  s_add_u32 s56, s58, 32768
  buffer_load_dwordx4 v15, s[24:27], s56 offen lds
  v_mfma_f32_32x32x16_bf16 a[48:63], v[88:91], v[136:139], a[48:63]
  s_add_u32 m0, s57, 2048
  s_add_u32 s56, s58, 65536
  buffer_load_dwordx4 v14, s[24:27], s56 offen lds
  s_add_u32 m0, s57, 3072
  s_add_u32 s56, s58, 98304
  buffer_load_dwordx4 v15, s[24:27], s56 offen lds
  s_waitcnt lgkmcnt(2)
  v_mfma_f32_32x32x16_bf16 a[0:15], v[92:95], v[140:143], a[0:15]
  ds_read_b128 v[132:135], v18 offset:16384
  ds_read_b128 v[136:139], v18 offset:20480
  v_mfma_f32_32x32x16_bf16 a[16:31], v[92:95], v[144:147], a[16:31]
  buffer_load_dword v5, v9, s[40:43], s66 offen sc1
  v_mfma_f32_32x32x16_bf16 a[32:47], v[96:99], v[140:143], a[32:47]
  buffer_load_dwordx4 v[84:87], v25, s[40:43], s60 offen offset:3072 sc1
  v_mfma_f32_32x32x16_bf16 a[48:63], v[96:99], v[144:147], a[48:63]
  buffer_load_dwordx4 v[88:91], v26, s[40:43], s60 offen offset:3072 sc1
  s_waitcnt lgkmcnt(2)
  v_mfma_f32_32x32x16_bf16 a[0:15], v[100:103], v[124:127], a[0:15]
  ds_read_b128 v[140:143], v19 offset:16384
  ds_read_b128 v[144:147], v19 offset:20480
  v_mfma_f32_32x32x16_bf16 a[16:31], v[100:103], v[128:131], a[16:31]
  s_add_u32 s61, s54, 5
  s_and_b32 s61, s61, 15
  s_lshl_b32 s61, s61, 12
  v_mfma_f32_32x32x16_bf16 a[32:47], v[104:107], v[124:127], a[32:47]
  buffer_load_dwordx4 v[92:95], v25, s[40:43], s61 offen offset:0 sc1
  v_mfma_f32_32x32x16_bf16 a[48:63], v[104:107], v[128:131], a[48:63]
  buffer_load_dwordx4 v[96:99], v26, s[40:43], s61 offen offset:0 sc1
  s_waitcnt lgkmcnt(2)
  v_mfma_f32_32x32x16_bf16 a[0:15], v[108:111], v[132:135], a[0:15]
  s_barrier
  s_cmp_lg_u32 s45, 0
  s_cbranch_scc1 L_z1f_64
  s_cmp_ge_u32 s47, 14
  s_cselect_b32 s50, 1, 0
  s_mul_i32 s51, s50, 14
  s_sub_u32 s51, s47, s51
  s_lshl_b32 s68, s46, 1
  s_add_u32 s50, s50, s68
  s_lshl_b32 s50, s50, 2
  s_lshl_b32 s51, s51, 7
  s_add_u32 s50, s50, s51
  s_add_u32 s50, s50, 24576
  v_mov_b32 v10, s44
  v_mov_b32 v11, 0
  s_mov_b64 exec, 1
  buffer_store_dword v10, v11, s[40:43], s50 offen sc1
  s_mov_b64 exec, -1
L_z1f_64:
  v_mfma_f32_32x32x16_bf16 a[16:31], v[108:111], v[136:139], a[16:31]
  ds_read_b128 v[124:127], v16 offset:24576
  ds_read_b128 v[128:131], v16 offset:28672
  v_mfma_f32_32x32x16_bf16 a[32:47], v[112:115], v[132:135], a[32:47]
  buffer_load_dwordx4 v[100:103], v25, s[40:43], s61 offen offset:1024 sc1
  v_mfma_f32_32x32x16_bf16 a[48:63], v[112:115], v[136:139], a[48:63]
  buffer_load_dwordx4 v[104:107], v26, s[40:43], s61 offen offset:1024 sc1
  s_waitcnt lgkmcnt(2)
  s_waitcnt vmcnt(25)
  v_mfma_f32_32x32x16_bf16 a[0:15], v[116:119], v[140:143], a[0:15]
  ds_read_b128 v[132:135], v17 offset:24576
  ds_read_b128 v[136:139], v17 offset:28672
  buffer_load_dwordx4 v[108:111], v25, s[40:43], s61 offen offset:2048 sc1
  buffer_load_dwordx4 v[112:115], v26, s[40:43], s61 offen offset:2048 sc1
  v_mfma_f32_32x32x16_bf16 a[16:31], v[116:119], v[144:147], a[16:31]
  s_add_u32 s58, s54, 9
  s_and_b32 s58, s58, 15
  s_lshl_b32 s58, s58, 7
  s_add_u32 s58, s58, s55
  s_add_u32 m0, s57, 8192
  s_add_u32 s56, s58, 0
  buffer_load_dwordx4 v14, s[24:27], s56 offen lds
  v_mfma_f32_32x32x16_bf16 a[32:47], v[120:123], v[140:143], a[32:47]
  s_add_u32 m0, s57, 9216
  s_add_u32 s56, s58, 32768
  buffer_load_dwordx4 v15, s[24:27], s56 offen lds
  v_mfma_f32_32x32x16_bf16 a[48:63], v[120:123], v[144:147], a[48:63]
  s_add_u32 m0, s57, 10240
  s_add_u32 s56, s58, 65536
  buffer_load_dwordx4 v14, s[24:27], s56 offen lds
  s_add_u32 m0, s57, 11264
  s_add_u32 s56, s58, 98304
  buffer_load_dwordx4 v15, s[24:27], s56 offen lds
  s_waitcnt lgkmcnt(2)
  s_waitcnt vmcnt(29)
  v_mfma_f32_32x32x16_bf16 a[0:15], v[28:31], v[124:127], a[0:15]
  ds_read_b128 v[140:143], v18 offset:24576
  ds_read_b128 v[144:147], v18 offset:28672
  v_mfma_f32_32x32x16_bf16 a[16:31], v[28:31], v[128:131], a[16:31]
  buffer_load_dwordx4 v[116:119], v25, s[40:43], s61 offen offset:3072 sc1
  v_mfma_f32_32x32x16_bf16 a[32:47], v[32:35], v[124:127], a[32:47]
  v_mfma_f32_32x32x16_bf16 a[48:63], v[32:35], v[128:131], a[48:63]
  buffer_load_dwordx4 v[120:123], v26, s[40:43], s61 offen offset:3072 sc1
  s_waitcnt lgkmcnt(2)
  s_waitcnt vmcnt(29)
  v_mfma_f32_32x32x16_bf16 a[0:15], v[36:39], v[132:135], a[0:15]
  ds_read_b128 v[124:127], v19 offset:24576
  ds_read_b128 v[128:131], v19 offset:28672
  v_mfma_f32_32x32x16_bf16 a[16:31], v[36:39], v[136:139], a[16:31]
  s_waitcnt vmcnt(14)
  v_cmp_eq_u32 s[64:65], s44, v5
  s_nop 1
  s_bitcmp1_b32 s64, 3
  s_cbranch_scc1 L_go_66
  s_mov_b32 s70, 0
L_gs_65:
  buffer_load_dword v5, v9, s[40:43], s66 offen sc1
  s_waitcnt vmcnt(0)
  v_cmp_eq_u32 s[64:65], s44, v5
  s_nop 1
  s_bitcmp1_b32 s64, 3
  s_cbranch_scc1 L_go_66
  s_add_u32 s70, s70, 1
  s_cmp_lt_u32 s70, 20000
  s_cbranch_scc1 L_gs_65
L_go_66:
  v_mfma_f32_32x32x16_bf16 a[32:47], v[40:43], v[132:135], a[32:47]
  s_add_u32 s62, s54, 6
  s_and_b32 s62, s62, 15
  s_lshl_b32 s62, s62, 12
  v_mfma_f32_32x32x16_bf16 a[48:63], v[40:43], v[136:139], a[48:63]
  buffer_load_dwordx4 v[28:31], v25, s[40:43], s62 offen offset:0 sc1
  buffer_load_dwordx4 v[32:35], v26, s[40:43], s62 offen offset:0 sc1
  s_waitcnt lgkmcnt(2)
  v_mfma_f32_32x32x16_bf16 a[0:15], v[44:47], v[140:143], a[0:15]
  s_barrier
  v_mfma_f32_32x32x16_bf16 a[16:31], v[44:47], v[144:147], a[16:31]
  ds_read_b128 v[132:135], v16 offset:32768
  ds_read_b128 v[136:139], v16 offset:36864
  v_mfma_f32_32x32x16_bf16 a[32:47], v[48:51], v[140:143], a[32:47]
  buffer_load_dwordx4 v[36:39], v25, s[40:43], s62 offen offset:1024 sc1
  v_mfma_f32_32x32x16_bf16 a[48:63], v[48:51], v[144:147], a[48:63]
  buffer_load_dwordx4 v[40:43], v26, s[40:43], s62 offen offset:1024 sc1
  s_waitcnt lgkmcnt(2)
  v_mfma_f32_32x32x16_bf16 a[0:15], v[52:55], v[124:127], a[0:15]
  ds_read_b128 v[140:143], v17 offset:32768
  ds_read_b128 v[144:147], v17 offset:36864
  buffer_load_dwordx4 v[44:47], v25, s[40:43], s62 offen offset:2048 sc1
  buffer_load_dwordx4 v[48:51], v26, s[40:43], s62 offen offset:2048 sc1
  v_mfma_f32_32x32x16_bf16 a[16:31], v[52:55], v[128:131], a[16:31]
  s_add_u32 s58, s54, 10
  s_and_b32 s58, s58, 15
  s_lshl_b32 s58, s58, 7
  s_add_u32 s58, s58, s55
  s_add_u32 m0, s57, 16384
  s_add_u32 s56, s58, 0
  buffer_load_dwordx4 v14, s[24:27], s56 offen lds
  v_mfma_f32_32x32x16_bf16 a[32:47], v[56:59], v[124:127], a[32:47]
  s_add_u32 m0, s57, 17408
  s_add_u32 s56, s58, 32768
  buffer_load_dwordx4 v15, s[24:27], s56 offen lds
  v_mfma_f32_32x32x16_bf16 a[48:63], v[56:59], v[128:131], a[48:63]
  s_add_u32 m0, s57, 18432
  s_add_u32 s56, s58, 65536
  buffer_load_dwordx4 v14, s[24:27], s56 offen lds
  s_add_u32 m0, s57, 19456
  s_add_u32 s56, s58, 98304
  buffer_load_dwordx4 v15, s[24:27], s56 offen lds
  s_waitcnt lgkmcnt(2)
  v_mfma_f32_32x32x16_bf16 a[0:15], v[60:63], v[132:135], a[0:15]
  ds_read_b128 v[124:127], v18 offset:32768
  ds_read_b128 v[128:131], v18 offset:36864
  v_mfma_f32_32x32x16_bf16 a[16:31], v[60:63], v[136:139], a[16:31]
  buffer_load_dword v5, v9, s[40:43], s66 offen sc1
  v_mfma_f32_32x32x16_bf16 a[32:47], v[64:67], v[132:135], a[32:47]
  buffer_load_dwordx4 v[52:55], v25, s[40:43], s62 offen offset:3072 sc1
  v_mfma_f32_32x32x16_bf16 a[48:63], v[64:67], v[136:139], a[48:63]
  buffer_load_dwordx4 v[56:59], v26, s[40:43], s62 offen offset:3072 sc1
  s_waitcnt lgkmcnt(2)
  v_mfma_f32_32x32x16_bf16 a[0:15], v[68:71], v[140:143], a[0:15]
  ds_read_b128 v[132:135], v19 offset:32768
  ds_read_b128 v[136:139], v19 offset:36864
  v_mfma_f32_32x32x16_bf16 a[16:31], v[68:71], v[144:147], a[16:31]
  s_add_u32 s63, s54, 7
  s_and_b32 s63, s63, 15
  s_lshl_b32 s63, s63, 12
  v_mfma_f32_32x32x16_bf16 a[32:47], v[72:75], v[140:143], a[32:47]
  buffer_load_dwordx4 v[60:63], v25, s[40:43], s63 offen offset:0 sc1
  v_mfma_f32_32x32x16_bf16 a[48:63], v[72:75], v[144:147], a[48:63]
  buffer_load_dwordx4 v[64:67], v26, s[40:43], s63 offen offset:0 sc1
  s_waitcnt lgkmcnt(2)
  v_mfma_f32_32x32x16_bf16 a[0:15], v[76:79], v[124:127], a[0:15]
  s_barrier
  v_mfma_f32_32x32x16_bf16 a[16:31], v[76:79], v[128:131], a[16:31]
  ds_read_b128 v[140:143], v16 offset:40960
  ds_read_b128 v[144:147], v16 offset:45056
  v_mfma_f32_32x32x16_bf16 a[32:47], v[80:83], v[124:127], a[32:47]
  buffer_load_dwordx4 v[68:71], v25, s[40:43], s63 offen offset:1024 sc1
  v_mfma_f32_32x32x16_bf16 a[48:63], v[80:83], v[128:131], a[48:63]
  buffer_load_dwordx4 v[72:75], v26, s[40:43], s63 offen offset:1024 sc1
  s_waitcnt lgkmcnt(2)
  s_waitcnt vmcnt(29)
  v_mfma_f32_32x32x16_bf16 a[0:15], v[84:87], v[132:135], a[0:15]
  ds_read_b128 v[124:127], v17 offset:40960
  ds_read_b128 v[128:131], v17 offset:45056
  buffer_load_dwordx4 v[76:79], v25, s[40:43], s63 offen offset:2048 sc1
  buffer_load_dwordx4 v[80:83], v26, s[40:43], s63 offen offset:2048 sc1
  v_mfma_f32_32x32x16_bf16 a[16:31], v[84:87], v[136:139], a[16:31]
  s_add_u32 s58, s54, 11
  s_and_b32 s58, s58, 15
  s_lshl_b32 s58, s58, 7
  s_add_u32 s58, s58, s55
  s_add_u32 m0, s57, 24576
  s_add_u32 s56, s58, 0
  buffer_load_dwordx4 v14, s[24:27], s56 offen lds
  v_mfma_f32_32x32x16_bf16 a[32:47], v[88:91], v[132:135], a[32:47]
  s_add_u32 m0, s57, 25600
  s_add_u32 s56, s58, 32768
  buffer_load_dwordx4 v15, s[24:27], s56 offen lds
  v_mfma_f32_32x32x16_bf16 a[48:63], v[88:91], v[136:139], a[48:63]
  s_add_u32 m0, s57, 26624
  s_add_u32 s56, s58, 65536
  buffer_load_dwordx4 v14, s[24:27], s56 offen lds
  s_add_u32 m0, s57, 27648
  s_add_u32 s56, s58, 98304
  buffer_load_dwordx4 v15, s[24:27], s56 offen lds
  s_waitcnt lgkmcnt(2)
  s_waitcnt vmcnt(33)
  v_mfma_f32_32x32x16_bf16 a[0:15], v[92:95], v[140:143], a[0:15]
  ds_read_b128 v[132:135], v18 offset:40960
  ds_read_b128 v[136:139], v18 offset:45056
  v_mfma_f32_32x32x16_bf16 a[16:31], v[92:95], v[144:147], a[16:31]
  buffer_load_dwordx4 v[84:87], v25, s[40:43], s63 offen offset:3072 sc1
  v_mfma_f32_32x32x16_bf16 a[32:47], v[96:99], v[140:143], a[32:47]
  v_mfma_f32_32x32x16_bf16 a[48:63], v[96:99], v[144:147], a[48:63]
  buffer_load_dwordx4 v[88:91], v26, s[40:43], s63 offen offset:3072 sc1
  s_waitcnt lgkmcnt(2)
  s_waitcnt vmcnt(33)
  v_mfma_f32_32x32x16_bf16 a[0:15], v[100:103], v[124:127], a[0:15]
  ds_read_b128 v[140:143], v19 offset:40960
  ds_read_b128 v[144:147], v19 offset:45056
  v_mfma_f32_32x32x16_bf16 a[16:31], v[100:103], v[128:131], a[16:31]
  s_waitcnt vmcnt(14)
  v_cmp_eq_u32 s[64:65], s44, v5
  s_nop 1
  s_bitcmp1_b32 s64, 4
  s_cbranch_scc1 L_go_68
  s_mov_b32 s70, 0
L_gs_67:
  buffer_load_dword v5, v9, s[40:43], s66 offen sc1
  s_waitcnt vmcnt(0)
  v_cmp_eq_u32 s[64:65], s44, v5
  s_nop 1
  s_bitcmp1_b32 s64, 4
  s_cbranch_scc1 L_go_68
  s_add_u32 s70, s70, 1
  s_cmp_lt_u32 s70, 20000
  s_cbranch_scc1 L_gs_67
L_go_68:
  v_mfma_f32_32x32x16_bf16 a[32:47], v[104:107], v[124:127], a[32:47]
  s_add_u32 s60, s54, 8
  s_and_b32 s60, s60, 15
  s_lshl_b32 s60, s60, 12
  v_mfma_f32_32x32x16_bf16 a[48:63], v[104:107], v[128:131], a[48:63]
  buffer_load_dwordx4 v[92:95], v25, s[40:43], s60 offen offset:0 sc1
  buffer_load_dwordx4 v[96:99], v26, s[40:43], s60 offen offset:0 sc1
  s_waitcnt lgkmcnt(2)
  v_mfma_f32_32x32x16_bf16 a[0:15], v[108:111], v[132:135], a[0:15]
  s_barrier
  v_mfma_f32_32x32x16_bf16 a[16:31], v[108:111], v[136:139], a[16:31]
  ds_read_b128 v[124:127], v16 offset:49152
  ds_read_b128 v[128:131], v16 offset:53248
  v_mfma_f32_32x32x16_bf16 a[32:47], v[112:115], v[132:135], a[32:47]
  buffer_load_dwordx4 v[100:103], v25, s[40:43], s60 offen offset:1024 sc1
  v_mfma_f32_32x32x16_bf16 a[48:63], v[112:115], v[136:139], a[48:63]
  buffer_load_dwordx4 v[104:107], v26, s[40:43], s60 offen offset:1024 sc1
  s_waitcnt lgkmcnt(2)
  v_mfma_f32_32x32x16_bf16 a[0:15], v[116:119], v[140:143], a[0:15]
  ds_read_b128 v[132:135], v17 offset:49152
  ds_read_b128 v[136:139], v17 offset:53248
  buffer_load_dwordx4 v[108:111], v25, s[40:43], s60 offen offset:2048 sc1
  buffer_load_dwordx4 v[112:115], v26, s[40:43], s60 offen offset:2048 sc1
  v_mfma_f32_32x32x16_bf16 a[16:31], v[116:119], v[144:147], a[16:31]
  s_add_u32 s58, s54, 12
  s_and_b32 s58, s58, 15
  s_lshl_b32 s58, s58, 7
  s_add_u32 s58, s58, s55
  s_add_u32 m0, s57, 32768
  s_add_u32 s56, s58, 0
  buffer_load_dwordx4 v14, s[24:27], s56 offen lds
  v_mfma_f32_32x32x16_bf16 a[32:47], v[120:123], v[140:143], a[32:47]
  s_add_u32 m0, s57, 33792
  s_add_u32 s56, s58, 32768
  buffer_load_dwordx4 v15, s[24:27], s56 offen lds
  v_mfma_f32_32x32x16_bf16 a[48:63], v[120:123], v[144:147], a[48:63]
  s_add_u32 m0, s57, 34816
  s_add_u32 s56, s58, 65536
  buffer_load_dwordx4 v14, s[24:27], s56 offen lds
  s_add_u32 m0, s57, 35840
  s_add_u32 s56, s58, 98304
  buffer_load_dwordx4 v15, s[24:27], s56 offen lds
  s_waitcnt lgkmcnt(2)
  v_mfma_f32_32x32x16_bf16 a[0:15], v[28:31], v[124:127], a[0:15]
  ds_read_b128 v[140:143], v18 offset:49152
  ds_read_b128 v[144:147], v18 offset:53248
  v_mfma_f32_32x32x16_bf16 a[16:31], v[28:31], v[128:131], a[16:31]
  buffer_load_dword v5, v9, s[40:43], s66 offen sc1
  v_mfma_f32_32x32x16_bf16 a[32:47], v[32:35], v[124:127], a[32:47]
  buffer_load_dwordx4 v[116:119], v25, s[40:43], s60 offen offset:3072 sc1
  v_mfma_f32_32x32x16_bf16 a[48:63], v[32:35], v[128:131], a[48:63]
  buffer_load_dwordx4 v[120:123], v26, s[40:43], s60 offen offset:3072 sc1
  s_waitcnt lgkmcnt(2)
  v_mfma_f32_32x32x16_bf16 a[0:15], v[36:39], v[132:135], a[0:15]
  ds_read_b128 v[124:127], v19 offset:49152
  ds_read_b128 v[128:131], v19 offset:53248
  v_mfma_f32_32x32x16_bf16 a[16:31], v[36:39], v[136:139], a[16:31]
  s_add_u32 s61, s54, 9
  s_and_b32 s61, s61, 15
  s_lshl_b32 s61, s61, 12
  v_mfma_f32_32x32x16_bf16 a[32:47], v[40:43], v[132:135], a[32:47]
  buffer_load_dwordx4 v[28:31], v25, s[40:43], s61 offen offset:0 sc1
  v_mfma_f32_32x32x16_bf16 a[48:63], v[40:43], v[136:139], a[48:63]
  buffer_load_dwordx4 v[32:35], v26, s[40:43], s61 offen offset:0 sc1
  s_waitcnt lgkmcnt(2)
  v_mfma_f32_32x32x16_bf16 a[0:15], v[44:47], v[140:143], a[0:15]
  s_barrier
  v_mfma_f32_32x32x16_bf16 a[16:31], v[44:47], v[144:147], a[16:31]
  ds_read_b128 v[132:135], v20 offset:0
  ds_read_b128 v[136:139], v20 offset:4096
  v_mfma_f32_32x32x16_bf16 a[32:47], v[48:51], v[140:143], a[32:47]
  buffer_load_dwordx4 v[36:39], v25, s[40:43], s61 offen offset:1024 sc1
  v_mfma_f32_32x32x16_bf16 a[48:63], v[48:51], v[144:147], a[48:63]
  buffer_load_dwordx4 v[40:43], v26, s[40:43], s61 offen offset:1024 sc1
  s_waitcnt lgkmcnt(2)
  s_waitcnt vmcnt(29)
  v_mfma_f32_32x32x16_bf16 a[0:15], v[52:55], v[124:127], a[0:15]
  ds_read_b128 v[140:143], v21 offset:0
  ds_read_b128 v[144:147], v21 offset:4096
  buffer_load_dwordx4 v[44:47], v25, s[40:43], s61 offen offset:2048 sc1
  buffer_load_dwordx4 v[48:51], v26, s[40:43], s61 offen offset:2048 sc1
  v_mfma_f32_32x32x16_bf16 a[16:31], v[52:55], v[128:131], a[16:31]
  s_add_u32 s58, s54, 13
  s_and_b32 s58, s58, 15
  s_lshl_b32 s58, s58, 7
  s_add_u32 s58, s58, s55
  s_add_u32 m0, s57, 40960
  s_add_u32 s56, s58, 0
  buffer_load_dwordx4 v14, s[24:27], s56 offen lds
  v_mfma_f32_32x32x16_bf16 a[32:47], v[56:59], v[124:127], a[32:47]
  s_add_u32 m0, s57, 41984
  s_add_u32 s56, s58, 32768
  buffer_load_dwordx4 v15, s[24:27], s56 offen lds
  v_mfma_f32_32x32x16_bf16 a[48:63], v[56:59], v[128:131], a[48:63]
  s_add_u32 m0, s57, 43008
  s_add_u32 s56, s58, 65536
  buffer_load_dwordx4 v14, s[24:27], s56 offen lds
  s_add_u32 m0, s57, 44032
  s_add_u32 s56, s58, 98304
  buffer_load_dwordx4 v15, s[24:27], s56 offen lds
  s_waitcnt lgkmcnt(2)
  s_waitcnt vmcnt(33)
  v_mfma_f32_32x32x16_bf16 a[0:15], v[60:63], v[132:135], a[0:15]
  ds_read_b128 v[124:127], v22 offset:0
  ds_read_b128 v[128:131], v22 offset:4096
  v_mfma_f32_32x32x16_bf16 a[16:31], v[60:63], v[136:139], a[16:31]
  buffer_load_dwordx4 v[52:55], v25, s[40:43], s61 offen offset:3072 sc1
  v_mfma_f32_32x32x16_bf16 a[32:47], v[64:67], v[132:135], a[32:47]
  v_mfma_f32_32x32x16_bf16 a[48:63], v[64:67], v[136:139], a[48:63]
  buffer_load_dwordx4 v[56:59], v26, s[40:43], s61 offen offset:3072 sc1
  s_waitcnt lgkmcnt(2)
  s_waitcnt vmcnt(33)
  v_mfma_f32_32x32x16_bf16 a[0:15], v[68:71], v[140:143], a[0:15]
  ds_read_b128 v[132:135], v23 offset:0
  ds_read_b128 v[136:139], v23 offset:4096
  v_mfma_f32_32x32x16_bf16 a[16:31], v[68:71], v[144:147], a[16:31]
  s_waitcnt vmcnt(14)
  v_cmp_eq_u32 s[64:65], s44, v5
  s_nop 1
  s_bitcmp1_b32 s64, 5
  s_cbranch_scc1 L_go_70
  s_mov_b32 s70, 0
L_gs_69:
  buffer_load_dword v5, v9, s[40:43], s66 offen sc1
  s_waitcnt vmcnt(0)
  v_cmp_eq_u32 s[64:65], s44, v5
  s_nop 1
  s_bitcmp1_b32 s64, 5
  s_cbranch_scc1 L_go_70
  s_add_u32 s70, s70, 1
  s_cmp_lt_u32 s70, 20000
  s_cbranch_scc1 L_gs_69
L_go_70:
  v_mfma_f32_32x32x16_bf16 a[32:47], v[72:75], v[140:143], a[32:47]
  s_add_u32 s62, s54, 10
  s_and_b32 s62, s62, 15
  s_lshl_b32 s62, s62, 12
  v_mfma_f32_32x32x16_bf16 a[48:63], v[72:75], v[144:147], a[48:63]
  buffer_load_dwordx4 v[60:63], v25, s[40:43], s62 offen offset:0 sc1
  buffer_load_dwordx4 v[64:67], v26, s[40:43], s62 offen offset:0 sc1
  s_waitcnt lgkmcnt(2)
  v_mfma_f32_32x32x16_bf16 a[0:15], v[76:79], v[124:127], a[0:15]
  s_barrier
  v_mfma_f32_32x32x16_bf16 a[16:31], v[76:79], v[128:131], a[16:31]
  ds_read_b128 v[140:143], v16 offset:0
  ds_read_b128 v[144:147], v16 offset:4096
  v_mfma_f32_32x32x16_bf16 a[32:47], v[80:83], v[124:127], a[32:47]
  buffer_load_dwordx4 v[68:71], v25, s[40:43], s62 offen offset:1024 sc1
  v_mfma_f32_32x32x16_bf16 a[48:63], v[80:83], v[128:131], a[48:63]
  buffer_load_dwordx4 v[72:75], v26, s[40:43], s62 offen offset:1024 sc1
  s_waitcnt lgkmcnt(2)
  v_mfma_f32_32x32x16_bf16 a[0:15], v[84:87], v[132:135], a[0:15]
  ds_read_b128 v[124:127], v17 offset:0
  ds_read_b128 v[128:131], v17 offset:4096
  buffer_load_dwordx4 v[76:79], v25, s[40:43], s62 offen offset:2048 sc1
  buffer_load_dwordx4 v[80:83], v26, s[40:43], s62 offen offset:2048 sc1
  v_mfma_f32_32x32x16_bf16 a[16:31], v[84:87], v[136:139], a[16:31]
  s_add_u32 s58, s54, 14
  s_and_b32 s58, s58, 15
  s_lshl_b32 s58, s58, 7
  s_add_u32 s58, s58, s55
  s_add_u32 m0, s57, 49152
  s_add_u32 s56, s58, 0
  buffer_load_dwordx4 v14, s[24:27], s56 offen lds
  v_mfma_f32_32x32x16_bf16 a[32:47], v[88:91], v[132:135], a[32:47]
  s_add_u32 m0, s57, 50176
  s_add_u32 s56, s58, 32768
  buffer_load_dwordx4 v15, s[24:27], s56 offen lds
  v_mfma_f32_32x32x16_bf16 a[48:63], v[88:91], v[136:139], a[48:63]
  s_add_u32 m0, s57, 51200
  s_add_u32 s56, s58, 65536
  buffer_load_dwordx4 v14, s[24:27], s56 offen lds
  s_add_u32 m0, s57, 52224
  s_add_u32 s56, s58, 98304
  buffer_load_dwordx4 v15, s[24:27], s56 offen lds
  s_waitcnt lgkmcnt(2)
  v_mfma_f32_32x32x16_bf16 a[0:15], v[92:95], v[140:143], a[0:15]
  ds_read_b128 v[132:135], v18 offset:0
  ds_read_b128 v[136:139], v18 offset:4096
  v_mfma_f32_32x32x16_bf16 a[16:31], v[92:95], v[144:147], a[16:31]
  buffer_load_dword v5, v9, s[40:43], s66 offen sc1
  v_mfma_f32_32x32x16_bf16 a[32:47], v[96:99], v[140:143], a[32:47]
  buffer_load_dwordx4 v[84:87], v25, s[40:43], s62 offen offset:3072 sc1
  v_mfma_f32_32x32x16_bf16 a[48:63], v[96:99], v[144:147], a[48:63]
  buffer_load_dwordx4 v[88:91], v26, s[40:43], s62 offen offset:3072 sc1
  s_waitcnt lgkmcnt(2)
  v_mfma_f32_32x32x16_bf16 a[0:15], v[100:103], v[124:127], a[0:15]
  ds_read_b128 v[140:143], v19 offset:0
  ds_read_b128 v[144:147], v19 offset:4096
  v_mfma_f32_32x32x16_bf16 a[16:31], v[100:103], v[128:131], a[16:31]
  s_add_u32 s63, s54, 11
  s_and_b32 s63, s63, 15
  s_lshl_b32 s63, s63, 12
  v_mfma_f32_32x32x16_bf16 a[32:47], v[104:107], v[124:127], a[32:47]
  buffer_load_dwordx4 v[92:95], v25, s[40:43], s63 offen offset:0 sc1
  v_mfma_f32_32x32x16_bf16 a[48:63], v[104:107], v[128:131], a[48:63]
  buffer_load_dwordx4 v[96:99], v26, s[40:43], s63 offen offset:0 sc1
  s_waitcnt lgkmcnt(2)
  v_mfma_f32_32x32x16_bf16 a[0:15], v[108:111], v[132:135], a[0:15]
  s_barrier
  v_mfma_f32_32x32x16_bf16 a[16:31], v[108:111], v[136:139], a[16:31]
  ds_read_b128 v[124:127], v16 offset:8192
  ds_read_b128 v[128:131], v16 offset:12288
  v_mfma_f32_32x32x16_bf16 a[32:47], v[112:115], v[132:135], a[32:47]
  buffer_load_dwordx4 v[100:103], v25, s[40:43], s63 offen offset:1024 sc1
  v_mfma_f32_32x32x16_bf16 a[48:63], v[112:115], v[136:139], a[48:63]
  buffer_load_dwordx4 v[104:107], v26, s[40:43], s63 offen offset:1024 sc1
  s_waitcnt lgkmcnt(2)
  s_waitcnt vmcnt(29)
  v_mfma_f32_32x32x16_bf16 a[0:15], v[116:119], v[140:143], a[0:15]
  ds_read_b128 v[132:135], v17 offset:8192
  ds_read_b128 v[136:139], v17 offset:12288
  buffer_load_dwordx4 v[108:111], v25, s[40:43], s63 offen offset:2048 sc1
  buffer_load_dwordx4 v[112:115], v26, s[40:43], s63 offen offset:2048 sc1
  v_mfma_f32_32x32x16_bf16 a[16:31], v[116:119], v[144:147], a[16:31]
  s_add_u32 s58, s54, 15
  s_and_b32 s58, s58, 15
  s_lshl_b32 s58, s58, 7
  s_add_u32 s58, s58, s55
  s_add_u32 m0, s67, 0
  s_add_u32 s56, s58, 0
  buffer_load_dwordx4 v14, s[24:27], s56 offen lds
  v_mfma_f32_32x32x16_bf16 a[32:47], v[120:123], v[140:143], a[32:47]
  s_add_u32 m0, s67, 1024
  s_add_u32 s56, s58, 32768
  buffer_load_dwordx4 v15, s[24:27], s56 offen lds
  v_mfma_f32_32x32x16_bf16 a[48:63], v[120:123], v[144:147], a[48:63]
  s_add_u32 m0, s67, 2048
  s_add_u32 s56, s58, 65536
  buffer_load_dwordx4 v14, s[24:27], s56 offen lds
  s_add_u32 m0, s67, 3072
  s_add_u32 s56, s58, 98304
  buffer_load_dwordx4 v15, s[24:27], s56 offen lds
  s_waitcnt lgkmcnt(2)
  s_waitcnt vmcnt(33)
  v_mfma_f32_32x32x16_bf16 a[0:15], v[28:31], v[124:127], a[0:15]
  ds_read_b128 v[140:143], v18 offset:8192
  ds_read_b128 v[144:147], v18 offset:12288
  v_mfma_f32_32x32x16_bf16 a[16:31], v[28:31], v[128:131], a[16:31]
  buffer_load_dwordx4 v[116:119], v25, s[40:43], s63 offen offset:3072 sc1
  v_mfma_f32_32x32x16_bf16 a[32:47], v[32:35], v[124:127], a[32:47]
  v_mfma_f32_32x32x16_bf16 a[48:63], v[32:35], v[128:131], a[48:63]
  buffer_load_dwordx4 v[120:123], v26, s[40:43], s63 offen offset:3072 sc1
  s_waitcnt lgkmcnt(2)
  s_waitcnt vmcnt(33)
  v_mfma_f32_32x32x16_bf16 a[0:15], v[36:39], v[132:135], a[0:15]
  ds_read_b128 v[124:127], v19 offset:8192
  ds_read_b128 v[128:131], v19 offset:12288
  v_mfma_f32_32x32x16_bf16 a[16:31], v[36:39], v[136:139], a[16:31]
  s_waitcnt vmcnt(14)
  v_cmp_eq_u32 s[64:65], s44, v5
  s_nop 1
  s_bitcmp1_b32 s64, 6
  s_cbranch_scc1 L_go_72
  s_mov_b32 s70, 0
L_gs_71:
  buffer_load_dword v5, v9, s[40:43], s66 offen sc1
  s_waitcnt vmcnt(0)
  v_cmp_eq_u32 s[64:65], s44, v5
  s_nop 1
  s_bitcmp1_b32 s64, 6
  s_cbranch_scc1 L_go_72
  s_add_u32 s70, s70, 1
  s_cmp_lt_u32 s70, 20000
  s_cbranch_scc1 L_gs_71
L_go_72:
  v_mfma_f32_32x32x16_bf16 a[32:47], v[40:43], v[132:135], a[32:47]
  s_add_u32 s60, s54, 12
  s_and_b32 s60, s60, 15
  s_lshl_b32 s60, s60, 12
  v_mfma_f32_32x32x16_bf16 a[48:63], v[40:43], v[136:139], a[48:63]
  buffer_load_dwordx4 v[28:31], v25, s[40:43], s60 offen offset:0 sc1
  buffer_load_dwordx4 v[32:35], v26, s[40:43], s60 offen offset:0 sc1
  s_waitcnt lgkmcnt(2)
  v_mfma_f32_32x32x16_bf16 a[0:15], v[44:47], v[140:143], a[0:15]
  s_barrier
  v_mfma_f32_32x32x16_bf16 a[16:31], v[44:47], v[144:147], a[16:31]
  ds_read_b128 v[132:135], v16 offset:16384
  ds_read_b128 v[136:139], v16 offset:20480
  v_mfma_f32_32x32x16_bf16 a[32:47], v[48:51], v[140:143], a[32:47]
  buffer_load_dwordx4 v[36:39], v25, s[40:43], s60 offen offset:1024 sc1
  v_mfma_f32_32x32x16_bf16 a[48:63], v[48:51], v[144:147], a[48:63]
  buffer_load_dwordx4 v[40:43], v26, s[40:43], s60 offen offset:1024 sc1
  s_waitcnt lgkmcnt(2)
  v_mfma_f32_32x32x16_bf16 a[0:15], v[52:55], v[124:127], a[0:15]
  ds_read_b128 v[140:143], v17 offset:16384
  ds_read_b128 v[144:147], v17 offset:20480
  v_mfma_f32_32x32x16_bf16 a[16:31], v[52:55], v[128:131], a[16:31]
  buffer_load_dwordx4 v[44:47], v25, s[40:43], s60 offen offset:2048 sc1
  v_mfma_f32_32x32x16_bf16 a[32:47], v[56:59], v[124:127], a[32:47]
  v_mfma_f32_32x32x16_bf16 a[48:63], v[56:59], v[128:131], a[48:63]
  buffer_load_dwordx4 v[48:51], v26, s[40:43], s60 offen offset:2048 sc1
  s_waitcnt lgkmcnt(2)
  v_mfma_f32_32x32x16_bf16 a[0:15], v[60:63], v[132:135], a[0:15]
  ds_read_b128 v[124:127], v18 offset:16384
  ds_read_b128 v[128:131], v18 offset:20480
  v_mfma_f32_32x32x16_bf16 a[16:31], v[60:63], v[136:139], a[16:31]
  buffer_load_dword v5, v9, s[40:43], s66 offen sc1
  v_mfma_f32_32x32x16_bf16 a[32:47], v[64:67], v[132:135], a[32:47]
  buffer_load_dwordx4 v[52:55], v25, s[40:43], s60 offen offset:3072 sc1
  v_mfma_f32_32x32x16_bf16 a[48:63], v[64:67], v[136:139], a[48:63]
  buffer_load_dwordx4 v[56:59], v26, s[40:43], s60 offen offset:3072 sc1
  s_waitcnt lgkmcnt(2)
  v_mfma_f32_32x32x16_bf16 a[0:15], v[68:71], v[140:143], a[0:15]
  ds_read_b128 v[132:135], v19 offset:16384
  ds_read_b128 v[136:139], v19 offset:20480
  v_mfma_f32_32x32x16_bf16 a[16:31], v[68:71], v[144:147], a[16:31]
  s_add_u32 s61, s54, 13
  s_and_b32 s61, s61, 15
  s_lshl_b32 s61, s61, 12
  v_mfma_f32_32x32x16_bf16 a[32:47], v[72:75], v[140:143], a[32:47]
  buffer_load_dwordx4 v[60:63], v25, s[40:43], s61 offen offset:0 sc1
  v_mfma_f32_32x32x16_bf16 a[48:63], v[72:75], v[144:147], a[48:63]
  buffer_load_dwordx4 v[64:67], v26, s[40:43], s61 offen offset:0 sc1
  s_waitcnt lgkmcnt(2)
  v_mfma_f32_32x32x16_bf16 a[0:15], v[76:79], v[124:127], a[0:15]
  s_barrier
  v_mfma_f32_32x32x16_bf16 a[16:31], v[76:79], v[128:131], a[16:31]
  ds_read_b128 v[140:143], v16 offset:24576
  ds_read_b128 v[144:147], v16 offset:28672
  v_mfma_f32_32x32x16_bf16 a[32:47], v[80:83], v[124:127], a[32:47]
  buffer_load_dwordx4 v[68:71], v25, s[40:43], s61 offen offset:1024 sc1
  v_mfma_f32_32x32x16_bf16 a[48:63], v[80:83], v[128:131], a[48:63]
  buffer_load_dwordx4 v[72:75], v26, s[40:43], s61 offen offset:1024 sc1
  s_waitcnt lgkmcnt(2)
  s_waitcnt vmcnt(25)
  v_mfma_f32_32x32x16_bf16 a[0:15], v[84:87], v[132:135], a[0:15]
  ds_read_b128 v[124:127], v17 offset:24576
  ds_read_b128 v[128:131], v17 offset:28672
  v_mfma_f32_32x32x16_bf16 a[16:31], v[84:87], v[136:139], a[16:31]
  buffer_load_dwordx4 v[76:79], v25, s[40:43], s61 offen offset:2048 sc1
  v_mfma_f32_32x32x16_bf16 a[32:47], v[88:91], v[132:135], a[32:47]
  v_mfma_f32_32x32x16_bf16 a[48:63], v[88:91], v[136:139], a[48:63]
  buffer_load_dwordx4 v[80:83], v26, s[40:43], s61 offen offset:2048 sc1
  s_waitcnt lgkmcnt(2)
  s_waitcnt vmcnt(25)
  v_mfma_f32_32x32x16_bf16 a[0:15], v[92:95], v[140:143], a[0:15]
  ds_read_b128 v[132:135], v18 offset:24576
  ds_read_b128 v[136:139], v18 offset:28672
  v_mfma_f32_32x32x16_bf16 a[16:31], v[92:95], v[144:147], a[16:31]
  buffer_load_dwordx4 v[84:87], v25, s[40:43], s61 offen offset:3072 sc1
  v_mfma_f32_32x32x16_bf16 a[32:47], v[96:99], v[140:143], a[32:47]
  v_mfma_f32_32x32x16_bf16 a[48:63], v[96:99], v[144:147], a[48:63]
  buffer_load_dwordx4 v[88:91], v26, s[40:43], s61 offen offset:3072 sc1
  s_waitcnt lgkmcnt(2)
  s_waitcnt vmcnt(25)
  v_mfma_f32_32x32x16_bf16 a[0:15], v[100:103], v[124:127], a[0:15]
  ds_read_b128 v[140:143], v19 offset:24576
  ds_read_b128 v[144:147], v19 offset:28672
  v_mfma_f32_32x32x16_bf16 a[16:31], v[100:103], v[128:131], a[16:31]
  s_waitcnt vmcnt(10)
  v_cmp_eq_u32 s[64:65], s44, v5
  s_nop 1
  s_bitcmp1_b32 s64, 7
  s_cbranch_scc1 L_go_74
  s_mov_b32 s70, 0
L_gs_73:
  buffer_load_dword v5, v9, s[40:43], s66 offen sc1
  s_waitcnt vmcnt(0)
  v_cmp_eq_u32 s[64:65], s44, v5
  s_nop 1
  s_bitcmp1_b32 s64, 7
  s_cbranch_scc1 L_go_74
  s_add_u32 s70, s70, 1
  s_cmp_lt_u32 s70, 20000
  s_cbranch_scc1 L_gs_73
L_go_74:
  v_mfma_f32_32x32x16_bf16 a[32:47], v[104:107], v[124:127], a[32:47]
  s_add_u32 s62, s54, 14
  s_and_b32 s62, s62, 15
  s_lshl_b32 s62, s62, 12
  v_mfma_f32_32x32x16_bf16 a[48:63], v[104:107], v[128:131], a[48:63]
  buffer_load_dwordx4 v[92:95], v25, s[40:43], s62 offen offset:0 sc1
  buffer_load_dwordx4 v[96:99], v26, s[40:43], s62 offen offset:0 sc1
  s_waitcnt lgkmcnt(2)
  v_mfma_f32_32x32x16_bf16 a[0:15], v[108:111], v[132:135], a[0:15]
  s_barrier
  v_mfma_f32_32x32x16_bf16 a[16:31], v[108:111], v[136:139], a[16:31]
  ds_read_b128 v[124:127], v16 offset:32768
  ds_read_b128 v[128:131], v16 offset:36864
  v_mfma_f32_32x32x16_bf16 a[32:47], v[112:115], v[132:135], a[32:47]
  buffer_load_dwordx4 v[100:103], v25, s[40:43], s62 offen offset:1024 sc1
  v_mfma_f32_32x32x16_bf16 a[48:63], v[112:115], v[136:139], a[48:63]
  buffer_load_dwordx4 v[104:107], v26, s[40:43], s62 offen offset:1024 sc1
  s_waitcnt lgkmcnt(2)
  v_mfma_f32_32x32x16_bf16 a[0:15], v[116:119], v[140:143], a[0:15]
  ds_read_b128 v[132:135], v17 offset:32768
  ds_read_b128 v[136:139], v17 offset:36864
  v_mfma_f32_32x32x16_bf16 a[16:31], v[116:119], v[144:147], a[16:31]
  buffer_load_dwordx4 v[108:111], v25, s[40:43], s62 offen offset:2048 sc1
  v_mfma_f32_32x32x16_bf16 a[32:47], v[120:123], v[140:143], a[32:47]
  v_mfma_f32_32x32x16_bf16 a[48:63], v[120:123], v[144:147], a[48:63]
  buffer_load_dwordx4 v[112:115], v26, s[40:43], s62 offen offset:2048 sc1
  s_waitcnt lgkmcnt(2)
  v_mfma_f32_32x32x16_bf16 a[0:15], v[28:31], v[124:127], a[0:15]
  ds_read_b128 v[140:143], v18 offset:32768
  ds_read_b128 v[144:147], v18 offset:36864
  v_mfma_f32_32x32x16_bf16 a[16:31], v[28:31], v[128:131], a[16:31]
  buffer_load_dwordx4 v[116:119], v25, s[40:43], s62 offen offset:3072 sc1
  v_mfma_f32_32x32x16_bf16 a[32:47], v[32:35], v[124:127], a[32:47]
  v_mfma_f32_32x32x16_bf16 a[48:63], v[32:35], v[128:131], a[48:63]
  buffer_load_dwordx4 v[120:123], v26, s[40:43], s62 offen offset:3072 sc1
  s_waitcnt lgkmcnt(2)
  v_mfma_f32_32x32x16_bf16 a[0:15], v[36:39], v[132:135], a[0:15]
  ds_read_b128 v[124:127], v19 offset:32768
  ds_read_b128 v[128:131], v19 offset:36864
  v_mfma_f32_32x32x16_bf16 a[16:31], v[36:39], v[136:139], a[16:31]
  s_add_u32 s63, s54, 15
  s_and_b32 s63, s63, 15
  s_lshl_b32 s63, s63, 12
  v_mfma_f32_32x32x16_bf16 a[32:47], v[40:43], v[132:135], a[32:47]
  buffer_load_dwordx4 v[28:31], v25, s[40:43], s63 offen offset:0 sc1
  v_mfma_f32_32x32x16_bf16 a[48:63], v[40:43], v[136:139], a[48:63]
  buffer_load_dwordx4 v[32:35], v26, s[40:43], s63 offen offset:0 sc1
  s_waitcnt lgkmcnt(2)
  v_mfma_f32_32x32x16_bf16 a[0:15], v[44:47], v[140:143], a[0:15]
  s_barrier
  ds_read_b128 v[132:135], v16 offset:40960
  ds_read_b128 v[136:139], v16 offset:45056
  buffer_load_dwordx4 v[36:39], v25, s[40:43], s63 offen offset:1024 sc1
  v_mfma_f32_32x32x16_bf16 a[16:31], v[44:47], v[144:147], a[16:31]
  buffer_load_dwordx4 v[40:43], v26, s[40:43], s63 offen offset:1024 sc1
  v_mfma_f32_32x32x16_bf16 a[32:47], v[48:51], v[140:143], a[32:47]
  v_lshrrev_b32 v164, 3, v1
  v_mul_u32_u24 v164, 896, v164
  v_lshrrev_b32 v165, 4, v1
  v_and_b32 v165, 1, v165
  v_lshlrev_b32 v165, 2, v165
  v_and_b32 v166, 7, v1
  v_xor_b32 v166, v166, v165
  v_lshlrev_b32 v166, 4, v166
  v_add_u32 v27, v164, v166
  s_lshl_b32 s101, s49, 7
  s_mul_i32 s100, s45, 7168
  s_add_u32 s101, s101, s100
  s_lshl_b32 s100, s45, 10
  v_mfma_f32_32x32x16_bf16 a[48:63], v[48:51], v[144:147], a[48:63]
  s_waitcnt lgkmcnt(2)
  s_waitcnt vmcnt(20)
  v_mfma_f32_32x32x16_bf16 a[0:15], v[52:55], v[124:127], a[0:15]
  ds_read_b128 v[140:143], v17 offset:40960
  ds_read_b128 v[144:147], v17 offset:45056
  v_mfma_f32_32x32x16_bf16 a[16:31], v[52:55], v[128:131], a[16:31]
  buffer_load_dwordx4 v[44:47], v25, s[40:43], s63 offen offset:2048 sc1
  v_mfma_f32_32x32x16_bf16 a[32:47], v[56:59], v[124:127], a[32:47]
  v_mfma_f32_32x32x16_bf16 a[48:63], v[56:59], v[128:131], a[48:63]
  buffer_load_dwordx4 v[48:51], v26, s[40:43], s63 offen offset:2048 sc1
  s_waitcnt lgkmcnt(2)
  s_waitcnt vmcnt(20)
  v_mfma_f32_32x32x16_bf16 a[0:15], v[60:63], v[132:135], a[0:15]
  ds_read_b128 v[124:127], v18 offset:40960
  ds_read_b128 v[128:131], v18 offset:45056
  v_mfma_f32_32x32x16_bf16 a[16:31], v[60:63], v[136:139], a[16:31]
  buffer_load_dwordx4 v[52:55], v25, s[40:43], s63 offen offset:3072 sc1
  v_mfma_f32_32x32x16_bf16 a[32:47], v[64:67], v[132:135], a[32:47]
  v_mfma_f32_32x32x16_bf16 a[48:63], v[64:67], v[136:139], a[48:63]
  buffer_load_dwordx4 v[56:59], v26, s[40:43], s63 offen offset:3072 sc1
  s_waitcnt lgkmcnt(2)
  s_waitcnt vmcnt(20)
  v_mfma_f32_32x32x16_bf16 a[0:15], v[68:71], v[140:143], a[0:15]
  ds_read_b128 v[132:135], v19 offset:40960
  v_mfma_f32_32x32x16_bf16 a[16:31], v[68:71], v[144:147], a[16:31]
  v_mfma_f32_32x32x16_bf16 a[32:47], v[72:75], v[140:143], a[32:47]
  ds_read_b128 v[136:139], v19 offset:45056
  v_mfma_f32_32x32x16_bf16 a[48:63], v[72:75], v[144:147], a[48:63]
  s_waitcnt lgkmcnt(2)
  s_waitcnt vmcnt(18)
  v_mfma_f32_32x32x16_bf16 a[0:15], v[76:79], v[124:127], a[0:15]
  s_barrier
  ds_read_b128 v[140:143], v16 offset:49152
  v_mfma_f32_32x32x16_bf16 a[16:31], v[76:79], v[128:131], a[16:31]
  ds_read_b128 v[144:147], v16 offset:53248
  v_mfma_f32_32x32x16_bf16 a[32:47], v[80:83], v[124:127], a[32:47]
  s_lshr_b32 s50, s48, 1
  s_lshl_b32 s50, s50, 2
  s_lshl_b32 s66, s49, 1
  s_add_u32 s66, s66, s52
  s_lshl_b32 s66, s66, 7
  s_add_u32 s66, s66, s50
  s_add_u32 s66, s66, 24576
  v_mov_b32 v9, 0
  buffer_load_dword v5, v9, s[40:43], s66 offen sc1
  v_mfma_f32_32x32x16_bf16 a[48:63], v[80:83], v[128:131], a[48:63]
  s_waitcnt lgkmcnt(2)
  s_waitcnt vmcnt(17)
  v_mfma_f32_32x32x16_bf16 a[0:15], v[84:87], v[132:135], a[0:15]
  ds_read_b128 v[124:127], v17 offset:49152
  v_mfma_f32_32x32x16_bf16 a[16:31], v[84:87], v[136:139], a[16:31]
  v_mfma_f32_32x32x16_bf16 a[32:47], v[88:91], v[132:135], a[32:47]
  ds_read_b128 v[128:131], v17 offset:53248
  v_mfma_f32_32x32x16_bf16 a[48:63], v[88:91], v[136:139], a[48:63]
  s_waitcnt lgkmcnt(2)
  s_waitcnt vmcnt(15)
  v_mfma_f32_32x32x16_bf16 a[0:15], v[92:95], v[140:143], a[0:15]
  ds_read_b128 v[132:135], v18 offset:49152
  v_mfma_f32_32x32x16_bf16 a[16:31], v[92:95], v[144:147], a[16:31]
  v_mfma_f32_32x32x16_bf16 a[32:47], v[96:99], v[140:143], a[32:47]
  ds_read_b128 v[136:139], v18 offset:53248
  v_mfma_f32_32x32x16_bf16 a[48:63], v[96:99], v[144:147], a[48:63]
  s_waitcnt lgkmcnt(2)
  s_waitcnt vmcnt(13)
  v_mfma_f32_32x32x16_bf16 a[0:15], v[100:103], v[124:127], a[0:15]
  ds_read_b128 v[140:143], v19 offset:49152
  v_mfma_f32_32x32x16_bf16 a[16:31], v[100:103], v[128:131], a[16:31]
  v_mfma_f32_32x32x16_bf16 a[32:47], v[104:107], v[124:127], a[32:47]
  ds_read_b128 v[144:147], v19 offset:53248
  v_mfma_f32_32x32x16_bf16 a[48:63], v[104:107], v[128:131], a[48:63]
  s_waitcnt lgkmcnt(2)
  s_waitcnt vmcnt(11)
  v_mfma_f32_32x32x16_bf16 a[0:15], v[108:111], v[132:135], a[0:15]
  s_barrier
  v_mfma_f32_32x32x16_bf16 a[16:31], v[108:111], v[136:139], a[16:31]
  v_mfma_f32_32x32x16_bf16 a[32:47], v[112:115], v[132:135], a[32:47]
  ds_read_b128 v[124:127], v20 offset:0
  v_mfma_f32_32x32x16_bf16 a[48:63], v[112:115], v[136:139], a[48:63]
  ds_read_b128 v[128:131], v20 offset:4096
  s_waitcnt lgkmcnt(2)
  s_waitcnt vmcnt(9)
  v_mfma_f32_32x32x16_bf16 a[0:15], v[116:119], v[140:143], a[0:15]
  ds_read_b128 v[132:135], v21 offset:0
  ds_read_b128 v[136:139], v21 offset:4096
  v_mfma_f32_32x32x16_bf16 a[16:31], v[116:119], v[144:147], a[16:31]
  v_mfma_f32_32x32x16_bf16 a[32:47], v[120:123], v[140:143], a[32:47]
  s_waitcnt vmcnt(0)
  v_cmp_eq_u32 s[64:65], s44, v5
  s_nop 1
  s_bitcmp1_b32 s64, 0
  s_cbranch_scc1 L_go_76
  s_mov_b32 s70, 0
L_gs_75:
  buffer_load_dword v5, v9, s[40:43], s66 offen sc1
  s_waitcnt vmcnt(0)
  v_cmp_eq_u32 s[64:65], s44, v5
  s_nop 1
  s_bitcmp1_b32 s64, 0
  s_cbranch_scc1 L_go_76
  s_add_u32 s70, s70, 1
  s_cmp_lt_u32 s70, 20000
  s_cbranch_scc1 L_gs_75
L_go_76:
  s_lshl_b32 s50, s48, 1
  s_add_u32 s50, s50, s53
  s_mul_i32 s50, s50, 28
  s_lshl_b32 s51, s49, 2
  s_add_u32 s50, s50, s51
  s_lshl_b32 s51, s52, 1
  s_add_u32 s50, s50, s51
  s_lshl_b32 s69, s50, 11
  s_add_u32 s50, s69, 9437184
  buffer_load_dwordx4 v[148:151], v2, s[40:43], s50 offen offset:0 sc1
  buffer_load_dwordx4 v[152:155], v2, s[40:43], s50 offen offset:1024 sc1
  buffer_load_dwordx4 v[156:159], v2, s[40:43], s50 offen offset:2048 sc1
  buffer_load_dwordx4 v[160:163], v2, s[40:43], s50 offen offset:3072 sc1
  v_mfma_f32_32x32x16_bf16 a[48:63], v[120:123], v[144:147], a[48:63]
  s_waitcnt lgkmcnt(2)
  v_mfma_f32_32x32x16_bf16 a[0:15], v[28:31], v[124:127], a[0:15]
  ds_read_b128 v[140:143], v22 offset:0
  v_mfma_f32_32x32x16_bf16 a[16:31], v[28:31], v[128:131], a[16:31]
  v_mfma_f32_32x32x16_bf16 a[32:47], v[32:35], v[124:127], a[32:47]
  ds_read_b128 v[144:147], v22 offset:4096
  v_mfma_f32_32x32x16_bf16 a[48:63], v[32:35], v[128:131], a[48:63]
  s_waitcnt lgkmcnt(2)
  v_mfma_f32_32x32x16_bf16 a[0:15], v[36:39], v[132:135], a[0:15]
  ds_read_b128 v[124:127], v23 offset:0
  v_mfma_f32_32x32x16_bf16 a[16:31], v[36:39], v[136:139], a[16:31]
  v_mfma_f32_32x32x16_bf16 a[32:47], v[40:43], v[132:135], a[32:47]
  ds_read_b128 v[128:131], v23 offset:4096
  v_mfma_f32_32x32x16_bf16 a[48:63], v[40:43], v[136:139], a[48:63]
  s_waitcnt lgkmcnt(2)
  v_mfma_f32_32x32x16_bf16 a[0:15], v[44:47], v[140:143], a[0:15]
  v_mfma_f32_32x32x16_bf16 a[16:31], v[44:47], v[144:147], a[16:31]
  v_mfma_f32_32x32x16_bf16 a[32:47], v[48:51], v[140:143], a[32:47]
  v_mfma_f32_32x32x16_bf16 a[48:63], v[48:51], v[144:147], a[48:63]
  s_waitcnt lgkmcnt(0)
  v_mfma_f32_32x32x16_bf16 a[0:15], v[52:55], v[124:127], a[0:15]
  v_mfma_f32_32x32x16_bf16 a[16:31], v[52:55], v[128:131], a[16:31]
  v_mfma_f32_32x32x16_bf16 a[32:47], v[56:59], v[124:127], a[32:47]
  v_mfma_f32_32x32x16_bf16 a[48:63], v[56:59], v[128:131], a[48:63]
  s_barrier
  s_lshl_b32 s50, s45, 13
  s_add_u32 s50, s50, 131072
  v_add_u32 v10, s50, v2
  s_xor_b32 s51, s45, 2
  s_lshl_b32 s51, s51, 13
  s_add_u32 s51, s51, 131072
  v_add_u32 v11, s51, v2
  s_cmp_eq_u32 s53, 0
  s_cbranch_scc1 L_x_77
  ds_write_b128 v10, a[0:3] offset:0
  ds_write_b128 v10, a[4:7] offset:1024
  ds_write_b128 v10, a[8:11] offset:2048
  ds_write_b128 v10, a[12:15] offset:3072
  ds_write_b128 v10, a[32:35] offset:4096
  ds_write_b128 v10, a[36:39] offset:5120
  ds_write_b128 v10, a[40:43] offset:6144
  ds_write_b128 v10, a[44:47] offset:7168
  v_accvgpr_read_b32 v28, a16
  v_accvgpr_read_b32 v29, a17
  v_accvgpr_read_b32 v30, a18
  v_accvgpr_read_b32 v31, a19
  v_accvgpr_read_b32 v32, a20
  v_accvgpr_read_b32 v33, a21
  v_accvgpr_read_b32 v34, a22
  v_accvgpr_read_b32 v35, a23
  v_accvgpr_read_b32 v36, a24
  v_accvgpr_read_b32 v37, a25
  v_accvgpr_read_b32 v38, a26
  v_accvgpr_read_b32 v39, a27
  v_accvgpr_read_b32 v40, a28
  v_accvgpr_read_b32 v41, a29
  v_accvgpr_read_b32 v42, a30
  v_accvgpr_read_b32 v43, a31
  v_accvgpr_read_b32 v44, a48
  v_accvgpr_read_b32 v45, a49
  v_accvgpr_read_b32 v46, a50
  v_accvgpr_read_b32 v47, a51
  v_accvgpr_read_b32 v48, a52
  v_accvgpr_read_b32 v49, a53
  v_accvgpr_read_b32 v50, a54
  v_accvgpr_read_b32 v51, a55
  v_accvgpr_read_b32 v52, a56
  v_accvgpr_read_b32 v53, a57
  v_accvgpr_read_b32 v54, a58
  v_accvgpr_read_b32 v55, a59
  v_accvgpr_read_b32 v56, a60
  v_accvgpr_read_b32 v57, a61
  v_accvgpr_read_b32 v58, a62
  v_accvgpr_read_b32 v59, a63
  s_branch L_x_78
L_x_77:
  ds_write_b128 v10, a[16:19] offset:0
  ds_write_b128 v10, a[20:23] offset:1024
  ds_write_b128 v10, a[24:27] offset:2048
  ds_write_b128 v10, a[28:31] offset:3072
  ds_write_b128 v10, a[48:51] offset:4096
  ds_write_b128 v10, a[52:55] offset:5120
  ds_write_b128 v10, a[56:59] offset:6144
  ds_write_b128 v10, a[60:63] offset:7168
  v_accvgpr_read_b32 v28, a0
  v_accvgpr_read_b32 v29, a1
  v_accvgpr_read_b32 v30, a2
  v_accvgpr_read_b32 v31, a3
  v_accvgpr_read_b32 v32, a4
  v_accvgpr_read_b32 v33, a5
  v_accvgpr_read_b32 v34, a6
  v_accvgpr_read_b32 v35, a7
  v_accvgpr_read_b32 v36, a8
  v_accvgpr_read_b32 v37, a9
  v_accvgpr_read_b32 v38, a10
  v_accvgpr_read_b32 v39, a11
  v_accvgpr_read_b32 v40, a12
  v_accvgpr_read_b32 v41, a13
  v_accvgpr_read_b32 v42, a14
  v_accvgpr_read_b32 v43, a15
  v_accvgpr_read_b32 v44, a32
  v_accvgpr_read_b32 v45, a33
  v_accvgpr_read_b32 v46, a34
  v_accvgpr_read_b32 v47, a35
  v_accvgpr_read_b32 v48, a36
  v_accvgpr_read_b32 v49, a37
  v_accvgpr_read_b32 v50, a38
  v_accvgpr_read_b32 v51, a39
  v_accvgpr_read_b32 v52, a40
  v_accvgpr_read_b32 v53, a41
  v_accvgpr_read_b32 v54, a42
  v_accvgpr_read_b32 v55, a43
  v_accvgpr_read_b32 v56, a44
  v_accvgpr_read_b32 v57, a45
  v_accvgpr_read_b32 v58, a46
  v_accvgpr_read_b32 v59, a47
L_x_78:
  s_add_u32 m0, s100, 0
  s_add_u32 s98, s101, 0
  buffer_load_dwordx4 v27, s[32:35], s98 offen lds
  s_add_u32 m0, s100, 57344
  s_add_u32 s98, s101, 401408
  buffer_load_dwordx4 v27, s[32:35], s98 offen lds
  s_add_u32 m0, s100, 4096
  s_add_u32 s98, s101, 28672
  buffer_load_dwordx4 v27, s[32:35], s98 offen lds
  s_waitcnt vmcnt(3)
  v_lshlrev_b32 v92, 16, v24
  v_lshlrev_b32 v96, 16, v148
  v_and_b32 v97, 0xffff0000, v148
  v_lshlrev_b32 v98, 16, v149
  v_and_b32 v99, 0xffff0000, v149
  v_lshlrev_b32 v100, 16, v150
  v_and_b32 v101, 0xffff0000, v150
  v_lshlrev_b32 v102, 16, v151
  v_and_b32 v103, 0xffff0000, v151
  v_lshlrev_b32 v104, 16, v152
  v_and_b32 v105, 0xffff0000, v152
  v_lshlrev_b32 v106, 16, v153
  v_and_b32 v107, 0xffff0000, v153
  s_add_u32 m0, s100, 61440
  s_add_u32 s98, s101, 430080
  buffer_load_dwordx4 v27, s[32:35], s98 offen lds
  v_lshlrev_b32 v108, 16, v154
  v_and_b32 v109, 0xffff0000, v154
  v_lshlrev_b32 v110, 16, v155
  v_and_b32 v111, 0xffff0000, v155
  v_lshlrev_b32 v112, 16, v156
  v_and_b32 v113, 0xffff0000, v156
  v_lshlrev_b32 v114, 16, v157
  v_and_b32 v115, 0xffff0000, v157
  v_lshlrev_b32 v116, 16, v158
  v_and_b32 v117, 0xffff0000, v158
  v_lshlrev_b32 v118, 16, v159
  v_and_b32 v119, 0xffff0000, v159
  s_add_u32 m0, s100, 8192
  s_add_u32 s98, s101, 57344
  buffer_load_dwordx4 v27, s[32:35], s98 offen lds
  v_lshlrev_b32 v120, 16, v160
  v_and_b32 v121, 0xffff0000, v160
  v_lshlrev_b32 v122, 16, v161
  v_and_b32 v123, 0xffff0000, v161
  v_lshlrev_b32 v124, 16, v162
  v_and_b32 v125, 0xffff0000, v162
  v_lshlrev_b32 v126, 16, v163
  v_and_b32 v127, 0xffff0000, v163
  v_pk_add_f32 v[28:29], v[28:29], v[92:93] op_sel_hi:[1,0]
  v_pk_add_f32 v[30:31], v[30:31], v[92:93] op_sel_hi:[1,0]
  v_pk_add_f32 v[32:33], v[32:33], v[92:93] op_sel_hi:[1,0]
  v_pk_add_f32 v[34:35], v[34:35], v[92:93] op_sel_hi:[1,0]
  s_add_u32 m0, s100, 65536
  s_add_u32 s98, s101, 458752
  buffer_load_dwordx4 v27, s[32:35], s98 offen lds
  v_pk_add_f32 v[36:37], v[36:37], v[92:93] op_sel_hi:[1,0]
  v_pk_add_f32 v[38:39], v[38:39], v[92:93] op_sel_hi:[1,0]
  v_pk_add_f32 v[40:41], v[40:41], v[92:93] op_sel_hi:[1,0]
  v_pk_add_f32 v[42:43], v[42:43], v[92:93] op_sel_hi:[1,0]
  v_pk_add_f32 v[44:45], v[44:45], v[92:93] op_sel_hi:[1,0]
  v_pk_add_f32 v[46:47], v[46:47], v[92:93] op_sel_hi:[1,0]
  v_pk_add_f32 v[48:49], v[48:49], v[92:93] op_sel_hi:[1,0]
  v_pk_add_f32 v[50:51], v[50:51], v[92:93] op_sel_hi:[1,0]
  v_pk_add_f32 v[52:53], v[52:53], v[92:93] op_sel_hi:[1,0]
  v_pk_add_f32 v[54:55], v[54:55], v[92:93] op_sel_hi:[1,0]
  v_pk_add_f32 v[56:57], v[56:57], v[92:93] op_sel_hi:[1,0]
  v_pk_add_f32 v[58:59], v[58:59], v[92:93] op_sel_hi:[1,0]
  s_add_u32 m0, s100, 12288
  s_add_u32 s98, s101, 86016
  buffer_load_dwordx4 v27, s[32:35], s98 offen lds
  s_waitcnt lgkmcnt(0)
  s_barrier
  ds_read_b128 v[60:63], v11 offset:0
  ds_read_b128 v[64:67], v11 offset:1024
  ds_read_b128 v[68:71], v11 offset:2048
  ds_read_b128 v[72:75], v11 offset:3072
  ds_read_b128 v[76:79], v11 offset:4096
  ds_read_b128 v[80:83], v11 offset:5120
  ds_read_b128 v[84:87], v11 offset:6144
  ds_read_b128 v[88:91], v11 offset:7168
  s_add_u32 s50, s69, 17825792
  s_waitcnt lgkmcnt(4)
  v_pk_add_f32 v[28:29], v[28:29], v[60:61]
  v_pk_add_f32 v[30:31], v[30:31], v[62:63]
  v_pk_add_f32 v[32:33], v[32:33], v[64:65]
  v_pk_add_f32 v[34:35], v[34:35], v[66:67]
  s_add_u32 m0, s100, 69632
  s_add_u32 s98, s101, 487424
  buffer_load_dwordx4 v27, s[32:35], s98 offen lds
  v_pk_add_f32 v[36:37], v[36:37], v[68:69]
  v_pk_add_f32 v[38:39], v[38:39], v[70:71]
  v_pk_add_f32 v[40:41], v[40:41], v[72:73]
  v_pk_add_f32 v[42:43], v[42:43], v[74:75]
  v_pk_mul_f32 v[28:29], v[28:29], v[96:97]
  v_pk_mul_f32 v[30:31], v[30:31], v[98:99]
  v_pk_mul_f32 v[32:33], v[32:33], v[100:101]
  v_pk_mul_f32 v[34:35], v[34:35], v[102:103]
  v_pk_mul_f32 v[36:37], v[36:37], v[104:105]
  v_pk_mul_f32 v[38:39], v[38:39], v[106:107]
  v_pk_mul_f32 v[40:41], v[40:41], v[108:109]
  v_pk_mul_f32 v[42:43], v[42:43], v[110:111]
  s_add_u32 m0, s100, 16384
  s_add_u32 s98, s101, 114688
  buffer_load_dwordx4 v27, s[32:35], s98 offen lds
  v_cvt_pk_bf16_f32 v148, v28, v29
  v_cvt_pk_bf16_f32 v149, v30, v31
  v_cvt_pk_bf16_f32 v150, v32, v33
  v_cvt_pk_bf16_f32 v151, v34, v35
  v_cvt_pk_bf16_f32 v152, v36, v37
  v_cvt_pk_bf16_f32 v153, v38, v39
  v_cvt_pk_bf16_f32 v154, v40, v41
  v_cvt_pk_bf16_f32 v155, v42, v43
  buffer_store_dwordx4 v[148:151], v2, s[40:43], s50 offen offset:0 sc1
  buffer_store_dwordx4 v[152:155], v2, s[40:43], s50 offen offset:1024 sc1
  s_waitcnt lgkmcnt(0)
  v_pk_add_f32 v[44:45], v[44:45], v[76:77]
  v_pk_add_f32 v[46:47], v[46:47], v[78:79]
  v_pk_add_f32 v[48:49], v[48:49], v[80:81]
  v_pk_add_f32 v[50:51], v[50:51], v[82:83]
  v_pk_add_f32 v[52:53], v[52:53], v[84:85]
  v_pk_add_f32 v[54:55], v[54:55], v[86:87]
  v_pk_add_f32 v[56:57], v[56:57], v[88:89]
  v_pk_add_f32 v[58:59], v[58:59], v[90:91]
  v_pk_mul_f32 v[44:45], v[44:45], v[112:113]
  v_pk_mul_f32 v[46:47], v[46:47], v[114:115]
  v_pk_mul_f32 v[48:49], v[48:49], v[116:117]
  v_pk_mul_f32 v[50:51], v[50:51], v[118:119]
  s_add_u32 m0, s100, 73728
  s_add_u32 s98, s101, 516096
  buffer_load_dwordx4 v27, s[32:35], s98 offen lds
  v_pk_mul_f32 v[52:53], v[52:53], v[120:121]
  v_pk_mul_f32 v[54:55], v[54:55], v[122:123]
  v_pk_mul_f32 v[56:57], v[56:57], v[124:125]
  v_pk_mul_f32 v[58:59], v[58:59], v[126:127]
  v_cvt_pk_bf16_f32 v156, v44, v45
  v_cvt_pk_bf16_f32 v157, v46, v47
  v_cvt_pk_bf16_f32 v158, v48, v49
  v_cvt_pk_bf16_f32 v159, v50, v51
  v_cvt_pk_bf16_f32 v160, v52, v53
  v_cvt_pk_bf16_f32 v161, v54, v55
  v_cvt_pk_bf16_f32 v162, v56, v57
  v_cvt_pk_bf16_f32 v163, v58, v59
  buffer_store_dwordx4 v[156:159], v2, s[40:43], s50 offen offset:2048 sc1
  buffer_store_dwordx4 v[160:163], v2, s[40:43], s50 offen offset:3072 sc1
  s_lshl_b32 s55, s48, 7
  s_lshl_b32 s50, s49, 2
  s_add_u32 s55, s55, s50
  s_add_u32 s55, s55, 20480
  s_add_u32 m0, s100, 20480
  s_add_u32 s98, s101, 143360
  buffer_load_dwordx4 v27, s[32:35], s98 offen lds
  s_add_u32 m0, s100, 77824
  s_add_u32 s98, s101, 544768
  buffer_load_dwordx4 v27, s[32:35], s98 offen lds
  s_add_u32 m0, s100, 24576
  s_add_u32 s98, s101, 172032
  buffer_load_dwordx4 v27, s[32:35], s98 offen lds
  s_add_u32 m0, s100, 81920
  s_add_u32 s98, s101, 573440
  buffer_load_dwordx4 v27, s[32:35], s98 offen lds
  s_add_u32 m0, s100, 28672
  s_add_u32 s98, s101, 200704
  buffer_load_dwordx4 v27, s[32:35], s98 offen lds
  s_add_u32 m0, s100, 86016
  s_add_u32 s98, s101, 602112
  buffer_load_dwordx4 v27, s[32:35], s98 offen lds
  s_add_u32 m0, s100, 32768
  s_add_u32 s98, s101, 229376
  buffer_load_dwordx4 v27, s[32:35], s98 offen lds
  s_add_u32 m0, s100, 90112
  s_add_u32 s98, s101, 630784
  buffer_load_dwordx4 v27, s[32:35], s98 offen lds
  s_waitcnt vmcnt(8)
  s_barrier
  s_cmp_lg_u32 s45, 0
  s_cbranch_scc1 L_nf_79
  v_mov_b32 v5, s44
  v_mov_b32 v6, 0
  s_mov_b64 exec, 1
  buffer_store_dword v5, v6, s[40:43], s55 offen sc1
  s_mov_b64 exec, -1
L_nf_79:
  s_add_u32 m0, s100, 36864
  s_add_u32 s98, s101, 258048
  buffer_load_dwordx4 v27, s[32:35], s98 offen lds
  s_add_u32 m0, s100, 94208
  s_add_u32 s98, s101, 659456
  buffer_load_dwordx4 v27, s[32:35], s98 offen lds
  s_add_u32 m0, s100, 40960
  s_add_u32 s98, s101, 286720
  buffer_load_dwordx4 v27, s[32:35], s98 offen lds
  s_add_u32 m0, s100, 98304
  s_add_u32 s98, s101, 688128
  buffer_load_dwordx4 v27, s[32:35], s98 offen lds
  s_add_u32 m0, s100, 45056
  s_add_u32 s98, s101, 315392
  buffer_load_dwordx4 v27, s[32:35], s98 offen lds
  s_add_u32 m0, s100, 102400
  s_add_u32 s98, s101, 716800
  buffer_load_dwordx4 v27, s[32:35], s98 offen lds
  s_add_u32 m0, s100, 49152
  s_add_u32 s98, s101, 344064
  buffer_load_dwordx4 v27, s[32:35], s98 offen lds
  s_add_u32 m0, s100, 106496
  s_add_u32 s98, s101, 745472
  buffer_load_dwordx4 v27, s[32:35], s98 offen lds
  s_add_u32 m0, s100, 53248
  s_add_u32 s98, s101, 372736
  buffer_load_dwordx4 v27, s[32:35], s98 offen lds
  s_add_u32 m0, s100, 110592
  s_add_u32 s98, s101, 774144
  buffer_load_dwordx4 v27, s[32:35], s98 offen lds
  s_branch L_ip_80
L_skipD:
  s_mov_b32 s50, 0
  s_sub_u32 s51, s47, 28
  s_lshl_b32 s51, s51, 2
  s_add_u32 s51, s51, s45
  s_lshl_b32 s51, s51, 12
  s_add_u32 s50, s50, s51
  s_add_u32 s50, s50, 0
  v_lshlrev_b32 v251, 6, v1
  s_mov_b32 s51, 13
L_il_81:
  buffer_load_dword v252, v251, s[32:35], s50 offen
  s_add_u32 s50, s50, 65536
  s_sub_u32 s51, s51, 1
  s_cmp_lg_u32 s51, 0
  s_cbranch_scc1 L_il_81
  s_waitcnt vmcnt(0)
L_ip_80:
  s_cmp_ge_u32 s47, 28
  s_cbranch_scc1 L_skipE
  s_mul_i32 s50, s47, 37
  s_lshr_b32 s50, s50, 8
  s_mul_i32 s51, s50, 7
  s_sub_u32 s49, s47, s51
  s_lshl_b32 s48, s46, 2
  s_add_u32 s48, s48, s50
  s_and_b32 s52, s45, 1
  s_lshl_b32 s50, s48, 1
  s_add_u32 s52, s52, s50
  s_lshr_b32 s53, s45, 1
  v_lshrrev_b32 v10, 3, v1
  v_mul_u32_u24 v10, 896, v10
  v_lshrrev_b32 v11, 4, v1
  v_and_b32 v11, 1, v11
  v_lshlrev_b32 v11, 2, v11
  v_and_b32 v12, 7, v1
  v_xor_b32 v12, v12, v11
  v_lshlrev_b32 v12, 4, v12
  v_add_u32 v14, v10, v12
  s_mov_b32 s54, 0
  s_lshl_b32 s55, s49, 7
  s_mul_i32 s58, s52, 28
  s_mul_i32 s50, s53, 14
  s_add_u32 s58, s58, s50
  s_lshl_b32 s58, s58, 11
  s_add_u32 s58, s58, 17825792
  s_mul_i32 s51, s53, 57344
  v_lshrrev_b32 v10, 2, v1
  v_and_b32 v10, 3, v10
  v_lshlrev_b32 v11, 2, v4
  v_add_u32 v11, v11, v10
  v_lshlrev_b32 v11, 7, v11
  v_lshrrev_b32 v12, 4, v1
  v_and_b32 v12, 1, v12
  v_lshlrev_b32 v12, 5, v12
  v_add_u32 v11, v11, v12
  v_and_b32 v12, 3, v1
  v_lshlrev_b32 v12, 3, v12
  v_add_u32 v11, v11, v12
  v_lshrrev_b32 v10, 1, v10
  v_lshlrev_b32 v10, 6, v10
  v_add_u32 v11, s51, v11
  v_add_u32 v24, v11, v10
  v_xor_b32 v10, 64, v10
  v_add_u32 v25, v11, v10
  s_lshl_b32 s55, s48, 7
  s_add_u32 s55, s55, 20480
  v_min_u32 v9, 6, v1
  v_lshlrev_b32 v9, 2, v9
  s_cmp_lg_u32 s45, 0
  s_cbranch_scc1 L_po_84
  buffer_load_dword v5, v9, s[40:43], s55 offen sc1
  s_sleep 1
  buffer_load_dword v6, v9, s[40:43], s55 offen sc1
  s_sleep 1
  buffer_load_dword v7, v9, s[40:43], s55 offen sc1
  s_sleep 1
  buffer_load_dword v8, v9, s[40:43], s55 offen sc1
  s_mov_b32 s70, 0
L_poll_82:
  s_waitcnt vmcnt(3)
  v_cmp_ne_u32 vcc, s44, v5
  s_cbranch_vccz L_pd_83
  buffer_load_dword v5, v9, s[40:43], s55 offen sc1
  s_waitcnt vmcnt(3)
  v_cmp_ne_u32 vcc, s44, v6
  s_cbranch_vccz L_pd_83
  buffer_load_dword v6, v9, s[40:43], s55 offen sc1
  s_waitcnt vmcnt(3)
  v_cmp_ne_u32 vcc, s44, v7
  s_cbranch_vccz L_pd_83
  buffer_load_dword v7, v9, s[40:43], s55 offen sc1
  s_waitcnt vmcnt(3)
  v_cmp_ne_u32 vcc, s44, v8
  s_cbranch_vccz L_pd_83
  buffer_load_dword v8, v9, s[40:43], s55 offen sc1
  s_add_u32 s70, s70, 1
  s_cmp_lt_u32 s70, 20000
  s_cbranch_scc1 L_poll_82
  s_branch L_pd_83
L_po_84:
L_pd_83:
  s_barrier
  s_mov_b32 s54, 0
  s_cmp_ge_u32 s54, 14
  s_cselect_b32 s50, 14, 0
  s_sub_u32 s54, s54, s50
  s_lshl_b32 s59, s54, 11
  s_add_u32 s59, s59, s58
  s_add_u32 s54, s54, 1
  buffer_load_dwordx4 v[28:31], v2, s[40:43], s59 offen offset:0 sc1
  buffer_load_dwordx4 v[32:35], v2, s[40:43], s59 offen offset:1024 sc1
  s_cmp_ge_u32 s54, 14
  s_cselect_b32 s50, 14, 0
  s_sub_u32 s54, s54, s50
  s_lshl_b32 s59, s54, 11
  s_add_u32 s59, s59, s58
  s_add_u32 s54, s54, 1
  buffer_load_dwordx4 v[36:39], v2, s[40:43], s59 offen offset:0 sc1
  buffer_load_dwordx4 v[40:43], v2, s[40:43], s59 offen offset:1024 sc1
  s_cmp_ge_u32 s54, 14
  s_cselect_b32 s50, 14, 0
  s_sub_u32 s54, s54, s50
  s_lshl_b32 s59, s54, 11
  s_add_u32 s59, s59, s58
  s_add_u32 s54, s54, 1
  buffer_load_dwordx4 v[44:47], v2, s[40:43], s59 offen offset:0 sc1
  buffer_load_dwordx4 v[48:51], v2, s[40:43], s59 offen offset:1024 sc1
  s_waitcnt vmcnt(6)
  s_barrier
  ds_read_b64_tr_b16 v[172:173], v24 offset:0
  ds_read_b64_tr_b16 v[174:175], v24 offset:1024
  ds_read_b64_tr_b16 v[176:177], v25 offset:0
  ds_read_b64_tr_b16 v[178:179], v25 offset:1024
  ds_read_b64_tr_b16 v[180:181], v24 offset:2048
  ds_read_b64_tr_b16 v[182:183], v24 offset:3072
  ds_read_b64_tr_b16 v[184:185], v25 offset:2048
  ds_read_b64_tr_b16 v[186:187], v25 offset:3072
  s_waitcnt lgkmcnt(4)
  s_waitcnt vmcnt(5)
  v_mfma_f32_32x32x16_bf16 v[140:155], v[172:175], v[28:31], 0
  s_cmp_ge_u32 s54, 14
  s_cselect_b32 s50, 14, 0
  s_sub_u32 s54, s54, s50
  s_lshl_b32 s59, s54, 11
  s_add_u32 s59, s59, s58
  s_add_u32 s54, s54, 1
  buffer_load_dwordx4 v[52:55], v2, s[40:43], s59 offen offset:0 sc1
  v_mfma_f32_32x32x16_bf16 v[156:171], v[176:179], v[28:31], 0
  ds_read_b64_tr_b16 v[188:189], v24 offset:4096
  ds_read_b64_tr_b16 v[190:191], v24 offset:5120
  ds_read_b64_tr_b16 v[192:193], v25 offset:4096
  ds_read_b64_tr_b16 v[194:195], v25 offset:5120
  s_waitcnt lgkmcnt(4)
  s_waitcnt vmcnt(5)
  v_mfma_f32_32x32x16_bf16 v[140:155], v[180:183], v[32:35], v[140:155]
  buffer_load_dwordx4 v[56:59], v2, s[40:43], s59 offen offset:1024 sc1
  ds_read_b64_tr_b16 v[172:173], v24 offset:6144
  ds_read_b64_tr_b16 v[174:175], v24 offset:7168
  v_mfma_f32_32x32x16_bf16 v[156:171], v[184:187], v[32:35], v[156:171]
  ds_read_b64_tr_b16 v[176:177], v25 offset:6144
  ds_read_b64_tr_b16 v[178:179], v25 offset:7168
  s_waitcnt lgkmcnt(4)
  s_waitcnt vmcnt(5)
  v_mfma_f32_32x32x16_bf16 v[140:155], v[188:191], v[36:39], v[140:155]
  s_cmp_ge_u32 s54, 14
  s_cselect_b32 s50, 14, 0
  s_sub_u32 s54, s54, s50
  s_lshl_b32 s59, s54, 11
  s_add_u32 s59, s59, s58
  s_add_u32 s54, s54, 1
  buffer_load_dwordx4 v[60:63], v2, s[40:43], s59 offen offset:0 sc1
  v_mfma_f32_32x32x16_bf16 v[156:171], v[192:195], v[36:39], v[156:171]
  ds_read_b64_tr_b16 v[180:181], v24 offset:8192
  ds_read_b64_tr_b16 v[182:183], v24 offset:9216
  ds_read_b64_tr_b16 v[184:185], v25 offset:8192
  ds_read_b64_tr_b16 v[186:187], v25 offset:9216
  s_waitcnt lgkmcnt(4)
  s_waitcnt vmcnt(5)
  v_mfma_f32_32x32x16_bf16 v[140:155], v[172:175], v[40:43], v[140:155]
  buffer_load_dwordx4 v[64:67], v2, s[40:43], s59 offen offset:1024 sc1
  ds_read_b64_tr_b16 v[188:189], v24 offset:10240
  ds_read_b64_tr_b16 v[190:191], v24 offset:11264
  v_mfma_f32_32x32x16_bf16 v[156:171], v[176:179], v[40:43], v[156:171]
  ds_read_b64_tr_b16 v[192:193], v25 offset:10240
  ds_read_b64_tr_b16 v[194:195], v25 offset:11264
  s_waitcnt lgkmcnt(4)
  s_waitcnt vmcnt(5)
  v_mfma_f32_32x32x16_bf16 v[140:155], v[180:183], v[44:47], v[140:155]
  s_cmp_ge_u32 s54, 14
  s_cselect_b32 s50, 14, 0
  s_sub_u32 s54, s54, s50
  s_lshl_b32 s59, s54, 11
  s_add_u32 s59, s59, s58
  s_add_u32 s54, s54, 1
  buffer_load_dwordx4 v[68:71], v2, s[40:43], s59 offen offset:0 sc1
  v_mfma_f32_32x32x16_bf16 v[156:171], v[184:187], v[44:47], v[156:171]
  ds_read_b64_tr_b16 v[172:173], v24 offset:12288
  ds_read_b64_tr_b16 v[174:175], v24 offset:13312
  ds_read_b64_tr_b16 v[176:177], v25 offset:12288
  ds_read_b64_tr_b16 v[178:179], v25 offset:13312
  s_waitcnt lgkmcnt(4)
  s_waitcnt vmcnt(5)
  v_mfma_f32_32x32x16_bf16 v[140:155], v[188:191], v[48:51], v[140:155]
  buffer_load_dwordx4 v[72:75], v2, s[40:43], s59 offen offset:1024 sc1
  ds_read_b64_tr_b16 v[180:181], v24 offset:14336
  ds_read_b64_tr_b16 v[182:183], v24 offset:15360
  v_mfma_f32_32x32x16_bf16 v[156:171], v[192:195], v[48:51], v[156:171]
  ds_read_b64_tr_b16 v[184:185], v25 offset:14336
  ds_read_b64_tr_b16 v[186:187], v25 offset:15360
  s_waitcnt lgkmcnt(4)
  s_waitcnt vmcnt(5)
  v_mfma_f32_32x32x16_bf16 v[140:155], v[172:175], v[52:55], v[140:155]
  s_cmp_ge_u32 s54, 14
  s_cselect_b32 s50, 14, 0
  s_sub_u32 s54, s54, s50
  s_lshl_b32 s59, s54, 11
  s_add_u32 s59, s59, s58
  s_add_u32 s54, s54, 1
  buffer_load_dwordx4 v[76:79], v2, s[40:43], s59 offen offset:0 sc1
  v_mfma_f32_32x32x16_bf16 v[156:171], v[176:179], v[52:55], v[156:171]
  ds_read_b64_tr_b16 v[188:189], v24 offset:16384
  ds_read_b64_tr_b16 v[190:191], v24 offset:17408
  ds_read_b64_tr_b16 v[192:193], v25 offset:16384
  ds_read_b64_tr_b16 v[194:195], v25 offset:17408
  s_waitcnt lgkmcnt(4)
  s_waitcnt vmcnt(5)
  v_mfma_f32_32x32x16_bf16 v[140:155], v[180:183], v[56:59], v[140:155]
  buffer_load_dwordx4 v[80:83], v2, s[40:43], s59 offen offset:1024 sc1
  ds_read_b64_tr_b16 v[172:173], v24 offset:18432
  ds_read_b64_tr_b16 v[174:175], v24 offset:19456
  v_mfma_f32_32x32x16_bf16 v[156:171], v[184:187], v[56:59], v[156:171]
  ds_read_b64_tr_b16 v[176:177], v25 offset:18432
  ds_read_b64_tr_b16 v[178:179], v25 offset:19456
  s_waitcnt lgkmcnt(4)
  s_waitcnt vmcnt(5)
  v_mfma_f32_32x32x16_bf16 v[140:155], v[188:191], v[60:63], v[140:155]
  s_cmp_ge_u32 s54, 14
  s_cselect_b32 s50, 14, 0
  s_sub_u32 s54, s54, s50
  s_lshl_b32 s59, s54, 11
  s_add_u32 s59, s59, s58
  s_add_u32 s54, s54, 1
  buffer_load_dwordx4 v[84:87], v2, s[40:43], s59 offen offset:0 sc1
  v_mfma_f32_32x32x16_bf16 v[156:171], v[192:195], v[60:63], v[156:171]
  ds_read_b64_tr_b16 v[180:181], v24 offset:20480
  ds_read_b64_tr_b16 v[182:183], v24 offset:21504
  ds_read_b64_tr_b16 v[184:185], v25 offset:20480
  ds_read_b64_tr_b16 v[186:187], v25 offset:21504
  s_waitcnt lgkmcnt(4)
  s_waitcnt vmcnt(5)
  v_mfma_f32_32x32x16_bf16 v[140:155], v[172:175], v[64:67], v[140:155]
  buffer_load_dwordx4 v[88:91], v2, s[40:43], s59 offen offset:1024 sc1
  ds_read_b64_tr_b16 v[188:189], v24 offset:22528
  ds_read_b64_tr_b16 v[190:191], v24 offset:23552
  v_mfma_f32_32x32x16_bf16 v[156:171], v[176:179], v[64:67], v[156:171]
  ds_read_b64_tr_b16 v[192:193], v25 offset:22528
  ds_read_b64_tr_b16 v[194:195], v25 offset:23552
  s_waitcnt lgkmcnt(4)
  s_waitcnt vmcnt(5)
  v_mfma_f32_32x32x16_bf16 v[140:155], v[180:183], v[68:71], v[140:155]
  s_cmp_ge_u32 s54, 14
  s_cselect_b32 s50, 14, 0
  s_sub_u32 s54, s54, s50
  s_lshl_b32 s59, s54, 11
  s_add_u32 s59, s59, s58
  s_add_u32 s54, s54, 1
  buffer_load_dwordx4 v[92:95], v2, s[40:43], s59 offen offset:0 sc1
  v_mfma_f32_32x32x16_bf16 v[156:171], v[184:187], v[68:71], v[156:171]
  ds_read_b64_tr_b16 v[172:173], v24 offset:24576
  ds_read_b64_tr_b16 v[174:175], v24 offset:25600
  ds_read_b64_tr_b16 v[176:177], v25 offset:24576
  ds_read_b64_tr_b16 v[178:179], v25 offset:25600
  s_waitcnt lgkmcnt(4)
  s_waitcnt vmcnt(5)
  v_mfma_f32_32x32x16_bf16 v[140:155], v[188:191], v[72:75], v[140:155]
  buffer_load_dwordx4 v[96:99], v2, s[40:43], s59 offen offset:1024 sc1
  ds_read_b64_tr_b16 v[180:181], v24 offset:26624
  ds_read_b64_tr_b16 v[182:183], v24 offset:27648
  v_mfma_f32_32x32x16_bf16 v[156:171], v[192:195], v[72:75], v[156:171]
  ds_read_b64_tr_b16 v[184:185], v25 offset:26624
  ds_read_b64_tr_b16 v[186:187], v25 offset:27648
  s_waitcnt lgkmcnt(4)
  s_waitcnt vmcnt(5)
  v_mfma_f32_32x32x16_bf16 v[140:155], v[172:175], v[76:79], v[140:155]
  s_cmp_ge_u32 s54, 14
  s_cselect_b32 s50, 14, 0
  s_sub_u32 s54, s54, s50
  s_lshl_b32 s59, s54, 11
  s_add_u32 s59, s59, s58
  s_add_u32 s54, s54, 1
  buffer_load_dwordx4 v[100:103], v2, s[40:43], s59 offen offset:0 sc1
  v_mfma_f32_32x32x16_bf16 v[156:171], v[176:179], v[76:79], v[156:171]
  ds_read_b64_tr_b16 v[188:189], v24 offset:28672
  ds_read_b64_tr_b16 v[190:191], v24 offset:29696
  ds_read_b64_tr_b16 v[192:193], v25 offset:28672
  ds_read_b64_tr_b16 v[194:195], v25 offset:29696
  s_waitcnt lgkmcnt(4)
  s_waitcnt vmcnt(5)
  v_mfma_f32_32x32x16_bf16 v[140:155], v[180:183], v[80:83], v[140:155]
  buffer_load_dwordx4 v[104:107], v2, s[40:43], s59 offen offset:1024 sc1
  ds_read_b64_tr_b16 v[172:173], v24 offset:30720
  ds_read_b64_tr_b16 v[174:175], v24 offset:31744
  v_mfma_f32_32x32x16_bf16 v[156:171], v[184:187], v[80:83], v[156:171]
  ds_read_b64_tr_b16 v[176:177], v25 offset:30720
  ds_read_b64_tr_b16 v[178:179], v25 offset:31744
  s_waitcnt lgkmcnt(4)
  s_waitcnt vmcnt(5)
  v_mfma_f32_32x32x16_bf16 v[140:155], v[188:191], v[84:87], v[140:155]
  s_cmp_ge_u32 s54, 14
  s_cselect_b32 s50, 14, 0
  s_sub_u32 s54, s54, s50
  s_lshl_b32 s59, s54, 11
  s_add_u32 s59, s59, s58
  s_add_u32 s54, s54, 1
  buffer_load_dwordx4 v[108:111], v2, s[40:43], s59 offen offset:0 sc1
  v_mfma_f32_32x32x16_bf16 v[156:171], v[192:195], v[84:87], v[156:171]
  ds_read_b64_tr_b16 v[180:181], v24 offset:32768
  ds_read_b64_tr_b16 v[182:183], v24 offset:33792
  ds_read_b64_tr_b16 v[184:185], v25 offset:32768
  ds_read_b64_tr_b16 v[186:187], v25 offset:33792
  s_waitcnt lgkmcnt(4)
  s_waitcnt vmcnt(5)
  v_mfma_f32_32x32x16_bf16 v[140:155], v[172:175], v[88:91], v[140:155]
  buffer_load_dwordx4 v[112:115], v2, s[40:43], s59 offen offset:1024 sc1
  ds_read_b64_tr_b16 v[188:189], v24 offset:34816
  ds_read_b64_tr_b16 v[190:191], v24 offset:35840
  v_mfma_f32_32x32x16_bf16 v[156:171], v[176:179], v[88:91], v[156:171]
  ds_read_b64_tr_b16 v[192:193], v25 offset:34816
  ds_read_b64_tr_b16 v[194:195], v25 offset:35840
  s_waitcnt lgkmcnt(4)
  s_waitcnt vmcnt(5)
  v_mfma_f32_32x32x16_bf16 v[140:155], v[180:183], v[92:95], v[140:155]
  s_cmp_ge_u32 s54, 14
  s_cselect_b32 s50, 14, 0
  s_sub_u32 s54, s54, s50
  s_lshl_b32 s59, s54, 11
  s_add_u32 s59, s59, s58
  s_add_u32 s54, s54, 1
  buffer_load_dwordx4 v[116:119], v2, s[40:43], s59 offen offset:0 sc1
  v_mfma_f32_32x32x16_bf16 v[156:171], v[184:187], v[92:95], v[156:171]
  ds_read_b64_tr_b16 v[172:173], v24 offset:36864
  ds_read_b64_tr_b16 v[174:175], v24 offset:37888
  ds_read_b64_tr_b16 v[176:177], v25 offset:36864
  ds_read_b64_tr_b16 v[178:179], v25 offset:37888
  s_waitcnt lgkmcnt(4)
  s_waitcnt vmcnt(5)
  v_mfma_f32_32x32x16_bf16 v[140:155], v[188:191], v[96:99], v[140:155]
  buffer_load_dwordx4 v[120:123], v2, s[40:43], s59 offen offset:1024 sc1
  ds_read_b64_tr_b16 v[180:181], v24 offset:38912
  ds_read_b64_tr_b16 v[182:183], v24 offset:39936
  v_mfma_f32_32x32x16_bf16 v[156:171], v[192:195], v[96:99], v[156:171]
  ds_read_b64_tr_b16 v[184:185], v25 offset:38912
  ds_read_b64_tr_b16 v[186:187], v25 offset:39936
  s_waitcnt lgkmcnt(4)
  s_waitcnt vmcnt(5)
  v_mfma_f32_32x32x16_bf16 v[140:155], v[172:175], v[100:103], v[140:155]
  s_cmp_ge_u32 s54, 14
  s_cselect_b32 s50, 14, 0
  s_sub_u32 s54, s54, s50
  s_lshl_b32 s59, s54, 11
  s_add_u32 s59, s59, s58
  s_add_u32 s54, s54, 1
  buffer_load_dwordx4 v[124:127], v2, s[40:43], s59 offen offset:0 sc1
  v_mfma_f32_32x32x16_bf16 v[156:171], v[176:179], v[100:103], v[156:171]
  ds_read_b64_tr_b16 v[188:189], v24 offset:40960
  ds_read_b64_tr_b16 v[190:191], v24 offset:41984
  ds_read_b64_tr_b16 v[192:193], v25 offset:40960
  ds_read_b64_tr_b16 v[194:195], v25 offset:41984
  s_waitcnt lgkmcnt(4)
  s_waitcnt vmcnt(5)
  v_mfma_f32_32x32x16_bf16 v[140:155], v[180:183], v[104:107], v[140:155]
  buffer_load_dwordx4 v[128:131], v2, s[40:43], s59 offen offset:1024 sc1
  ds_read_b64_tr_b16 v[172:173], v24 offset:43008
  ds_read_b64_tr_b16 v[174:175], v24 offset:44032
  v_mfma_f32_32x32x16_bf16 v[156:171], v[184:187], v[104:107], v[156:171]
  ds_read_b64_tr_b16 v[176:177], v25 offset:43008
  ds_read_b64_tr_b16 v[178:179], v25 offset:44032
  s_waitcnt lgkmcnt(4)
  s_waitcnt vmcnt(5)
  v_mfma_f32_32x32x16_bf16 v[140:155], v[188:191], v[108:111], v[140:155]
  s_cmp_ge_u32 s54, 14
  s_cselect_b32 s50, 14, 0
  s_sub_u32 s54, s54, s50
  s_lshl_b32 s59, s54, 11
  s_add_u32 s59, s59, s58
  s_add_u32 s54, s54, 1
  buffer_load_dwordx4 v[132:135], v2, s[40:43], s59 offen offset:0 sc1
  v_mfma_f32_32x32x16_bf16 v[156:171], v[192:195], v[108:111], v[156:171]
  ds_read_b64_tr_b16 v[180:181], v24 offset:45056
  ds_read_b64_tr_b16 v[182:183], v24 offset:46080
  ds_read_b64_tr_b16 v[184:185], v25 offset:45056
  ds_read_b64_tr_b16 v[186:187], v25 offset:46080
  s_waitcnt lgkmcnt(4)
  s_waitcnt vmcnt(5)
  v_mfma_f32_32x32x16_bf16 v[140:155], v[172:175], v[112:115], v[140:155]
  buffer_load_dwordx4 v[136:139], v2, s[40:43], s59 offen offset:1024 sc1
  ds_read_b64_tr_b16 v[188:189], v24 offset:47104
  ds_read_b64_tr_b16 v[190:191], v24 offset:48128
  v_mfma_f32_32x32x16_bf16 v[156:171], v[176:179], v[112:115], v[156:171]
  ds_read_b64_tr_b16 v[192:193], v25 offset:47104
  ds_read_b64_tr_b16 v[194:195], v25 offset:48128
  s_waitcnt lgkmcnt(4)
  s_waitcnt vmcnt(5)
  v_mfma_f32_32x32x16_bf16 v[140:155], v[180:183], v[116:119], v[140:155]
  ds_read_b64_tr_b16 v[172:173], v24 offset:49152
  ds_read_b64_tr_b16 v[174:175], v24 offset:50176
  ds_read_b64_tr_b16 v[176:177], v25 offset:49152
  ds_read_b64_tr_b16 v[178:179], v25 offset:50176
  v_mfma_f32_32x32x16_bf16 v[156:171], v[184:187], v[116:119], v[156:171]
  s_lshl_b32 s50, s49, 1
  s_add_u32 s50, s50, s53
  s_mul_i32 s51, s52, 14
  s_add_u32 s50, s50, s51
  s_lshl_b32 s55, s50, 11
  s_add_u32 s55, s55, 7340032
  buffer_load_dwordx4 v[16:19], v2, s[40:43], s55 offen offset:0 sc1
  buffer_load_dwordx4 v[20:23], v2, s[40:43], s55 offen offset:1024 sc1
  s_waitcnt lgkmcnt(4)
  s_waitcnt vmcnt(6)
  v_mfma_f32_32x32x16_bf16 v[140:155], v[188:191], v[120:123], v[140:155]
  ds_read_b64_tr_b16 v[180:181], v24 offset:51200
  ds_read_b64_tr_b16 v[182:183], v24 offset:52224
  v_mfma_f32_32x32x16_bf16 v[156:171], v[192:195], v[120:123], v[156:171]
  ds_read_b64_tr_b16 v[184:185], v25 offset:51200
  ds_read_b64_tr_b16 v[186:187], v25 offset:52224
  s_waitcnt lgkmcnt(4)
  s_waitcnt vmcnt(5)
  v_mfma_f32_32x32x16_bf16 v[140:155], v[172:175], v[124:127], v[140:155]
  ds_read_b64_tr_b16 v[188:189], v24 offset:53248
  ds_read_b64_tr_b16 v[190:191], v24 offset:54272
  v_mfma_f32_32x32x16_bf16 v[156:171], v[176:179], v[124:127], v[156:171]
  ds_read_b64_tr_b16 v[192:193], v25 offset:53248
  ds_read_b64_tr_b16 v[194:195], v25 offset:54272
  s_waitcnt lgkmcnt(4)
  s_waitcnt vmcnt(4)
  v_mfma_f32_32x32x16_bf16 v[140:155], v[180:183], v[128:131], v[140:155]
  ds_read_b64_tr_b16 v[172:173], v24 offset:55296
  ds_read_b64_tr_b16 v[174:175], v24 offset:56320
  v_mfma_f32_32x32x16_bf16 v[156:171], v[184:187], v[128:131], v[156:171]
  ds_read_b64_tr_b16 v[176:177], v25 offset:55296
  ds_read_b64_tr_b16 v[178:179], v25 offset:56320
  s_waitcnt lgkmcnt(4)
  s_waitcnt vmcnt(3)
  v_mfma_f32_32x32x16_bf16 v[140:155], v[188:191], v[132:135], v[140:155]
  v_mfma_f32_32x32x16_bf16 v[156:171], v[192:195], v[132:135], v[156:171]
  s_waitcnt lgkmcnt(0)
  s_waitcnt vmcnt(2)
  v_mfma_f32_32x32x16_bf16 v[140:155], v[172:175], v[136:139], v[140:155]
  v_mfma_f32_32x32x16_bf16 v[156:171], v[176:179], v[136:139], v[156:171]
  s_lshl_b32 s50, s45, 12
  s_add_u32 s50, s50, 114688
  v_add_u32 v10, s50, v2
  s_xor_b32 s51, s45, 2
  s_lshl_b32 s51, s51, 12
  s_add_u32 s51, s51, 114688
  v_add_u32 v11, s51, v2
  s_cmp_lt_u32 s45, 2
  s_cbranch_scc1 L_x_85
  s_nop 1
  ds_write_b128 v10, v[140:143] offset:0
  ds_write_b128 v10, v[144:147] offset:1024
  ds_write_b128 v10, v[148:151] offset:2048
  ds_write_b128 v10, v[152:155] offset:3072
  s_nop 1
  v_pk_mul_f32 v[140:141], v[156:157], 1.0 op_sel_hi:[1,0]
  v_pk_mul_f32 v[142:143], v[158:159], 1.0 op_sel_hi:[1,0]
  v_pk_mul_f32 v[144:145], v[160:161], 1.0 op_sel_hi:[1,0]
  v_pk_mul_f32 v[146:147], v[162:163], 1.0 op_sel_hi:[1,0]
  v_pk_mul_f32 v[148:149], v[164:165], 1.0 op_sel_hi:[1,0]
  v_pk_mul_f32 v[150:151], v[166:167], 1.0 op_sel_hi:[1,0]
  v_pk_mul_f32 v[152:153], v[168:169], 1.0 op_sel_hi:[1,0]
  v_pk_mul_f32 v[154:155], v[170:171], 1.0 op_sel_hi:[1,0]
  s_branch L_x_86
L_x_85:
  s_nop 2
  ds_write_b128 v10, v[156:159] offset:0
  ds_write_b128 v10, v[160:163] offset:1024
  ds_write_b128 v10, v[164:167] offset:2048
  ds_write_b128 v10, v[168:171] offset:3072
L_x_86:
  s_waitcnt lgkmcnt(0)
  s_barrier
  ds_read_b128 v[156:159], v11 offset:0
  ds_read_b128 v[160:163], v11 offset:1024
  ds_read_b128 v[164:167], v11 offset:2048
  ds_read_b128 v[168:171], v11 offset:3072
  s_waitcnt vmcnt(0)
  v_lshlrev_b32 v36, 16, v16
  v_and_b32 v37, 0xffff0000, v16
  v_lshlrev_b32 v38, 16, v17
  v_and_b32 v39, 0xffff0000, v17
  v_lshlrev_b32 v40, 16, v18
  v_and_b32 v41, 0xffff0000, v18
  v_lshlrev_b32 v42, 16, v19
  v_and_b32 v43, 0xffff0000, v19
  v_lshlrev_b32 v44, 16, v20
  v_and_b32 v45, 0xffff0000, v20
  v_lshlrev_b32 v46, 16, v21
  v_and_b32 v47, 0xffff0000, v21
  v_lshlrev_b32 v48, 16, v22
  v_and_b32 v49, 0xffff0000, v22
  v_lshlrev_b32 v50, 16, v23
  v_and_b32 v51, 0xffff0000, v23
  v_pk_add_f32 v[140:141], v[140:141], v[36:37]
  v_pk_add_f32 v[142:143], v[142:143], v[38:39]
  v_pk_add_f32 v[144:145], v[144:145], v[40:41]
  v_pk_add_f32 v[146:147], v[146:147], v[42:43]
  v_pk_add_f32 v[148:149], v[148:149], v[44:45]
  v_pk_add_f32 v[150:151], v[150:151], v[46:47]
  v_pk_add_f32 v[152:153], v[152:153], v[48:49]
  v_pk_add_f32 v[154:155], v[154:155], v[50:51]
  s_waitcnt lgkmcnt(0)
  v_pk_add_f32 v[140:141], v[140:141], v[156:157]
  v_pk_add_f32 v[142:143], v[142:143], v[158:159]
  v_pk_add_f32 v[144:145], v[144:145], v[160:161]
  v_pk_add_f32 v[146:147], v[146:147], v[162:163]
  v_pk_add_f32 v[148:149], v[148:149], v[164:165]
  v_pk_add_f32 v[150:151], v[150:151], v[166:167]
  v_pk_add_f32 v[152:153], v[152:153], v[168:169]
  v_pk_add_f32 v[154:155], v[154:155], v[170:171]
  v_cvt_pk_bf16_f32 v28, v140, v141
  v_cvt_pk_bf16_f32 v29, v142, v143
  v_cvt_pk_bf16_f32 v30, v144, v145
  v_cvt_pk_bf16_f32 v31, v146, v147
  v_cvt_pk_bf16_f32 v32, v148, v149
  v_cvt_pk_bf16_f32 v33, v150, v151
  v_cvt_pk_bf16_f32 v34, v152, v153
  v_cvt_pk_bf16_f32 v35, v154, v155
  v_permlane32_swap_b32 v28, v30
  v_permlane32_swap_b32 v29, v31
  v_permlane32_swap_b32 v32, v34
  v_permlane32_swap_b32 v33, v35
  v_mul_u32_u24 v15, 896, v3
  v_lshlrev_b32 v26, 4, v4
  v_add_u32 v15, v15, v26
  s_mul_i32 s54, s52, 28672
  s_lshl_b32 s50, s49, 7
  s_add_u32 s54, s54, s50
  s_lshl_b32 s50, s53, 6
  s_add_u32 s54, s54, s50
  buffer_store_dwordx4 v[28:31], v15, s[36:39], s54 offen offset:0
  buffer_store_dwordx4 v[32:35], v15, s[36:39], s54 offen offset:32
L_skipE:
  s_cmp_lg_u32 s2, 0
  s_cbranch_scc1 L_noepoch
  s_cmp_lg_u32 s45, 0
  s_cbranch_scc1 L_noepoch
  v_mov_b32 v5, s44
  v_mov_b32 v6, 0
  s_mov_b64 exec, 1
  buffer_store_dword v5, v6, s[40:43], 0 offen sc1
  s_mov_b64 exec, -1
L_noepoch:
L_end:
  s_endpgm
L_code_end:
.section .rodata,"a"
.p2align 6
.amdhsa_kernel sequential_preLN__sliding_block__mixer_gmlp__prompt_kernel
  .amdhsa_next_free_vgpr 512
  .amdhsa_next_free_sgpr 102
  .amdhsa_accum_offset 256
  .amdhsa_group_segment_fixed_size 0
  .amdhsa_kernarg_size 88
  .amdhsa_user_sgpr_count 2
  .amdhsa_user_sgpr_kernarg_segment_ptr 1
  .amdhsa_system_sgpr_workgroup_id_x 1
.end_amdhsa_kernel
```
